```python
import torch

def _softmax(x, axis=-1):
    return torch.softmax(x, dim=axis)

def _gelu(x):
    return torch.nn.functional.gelu(x, approximate='tanh')

def _silu(x):
    return torch.nn.functional.silu(x)

def _sigmoid(x):
    return torch.sigmoid(x)

def _layernorm(x, axis=-1, eps=1e-05):
    m = x.mean(dim=axis, keepdim=True)
    v = x.var(dim=axis, keepdim=True, unbiased=False)
    return (x - m) / torch.sqrt(v + eps)

def _scatter_add(tgt, idx, src, axis=0):
    return tgt.clone().index_add_(axis, idx, src)

def _segment_sum(src, seg, n):
    out = torch.zeros((n,) + src.shape[1:], dtype=src.dtype)
    return out.index_add_(0, seg, src)

def _pad(x, pw):
    flat = tuple((v for pair in reversed(pw) for v in pair))
    return torch.nn.functional.pad(x, flat)
kernel_name = 'adaLN_cond__grouped_kv_mqa__glu_gated_reglu__prompt'

def setup_inputs():

    _w = lambda a: (lambda t: t.to(torch.bfloat16) if t.is_floating_point() else t)(torch.as_tensor(a))

    def _A_setup():
        B, S, D, H = (1, 2048, 1024, 32)
        Dh = D // H
        return {'x': _w((lambda *s: torch.randn(*s, dtype=torch.bfloat16) * 0.05)(B, S, D)), 'wq': _w((lambda *s: torch.randn(*s, dtype=torch.bfloat16) * 0.05)(D, H * Dh)), 'wk': _w((lambda *s: torch.randn(*s, dtype=torch.bfloat16) * 0.05)(D, Dh)), 'wv': _w((lambda *s: torch.randn(*s, dtype=torch.bfloat16) * 0.05)(D, Dh)), 'wo': _w((lambda *s: torch.randn(*s, dtype=torch.bfloat16) * 0.05)(H * Dh, D))}
    _A_in = _A_setup()

    def _B_setup():
        B, S, D, F = (1, 2048, 1024, 3584)
        return {'x': _w((lambda *s: torch.randn(*s, dtype=torch.bfloat16) * 0.05)(B, S, D)), 'W_gate': _w((lambda *s: torch.randn(*s, dtype=torch.bfloat16) * 0.8)(D, F) * (2.0 / D) ** 0.5), 'W_up': _w((lambda *s: torch.randn(*s, dtype=torch.bfloat16) * 0.8)(D, F) * (2.0 / D) ** 0.5), 'W_down': _w((lambda *s: torch.randn(*s, dtype=torch.bfloat16) * 0.8)(F, D) * (1.0 / F) ** 0.5)}
    _B_in = _B_setup()
    return {'A_x': _A_in['x'], 'A_wq': _A_in['wq'], 'A_wk': _A_in['wk'], 'A_wv': _A_in['wv'], 'A_wo': _A_in['wo'], 'B_x': _B_in['x'], 'B_W_gate': _B_in['W_gate'], 'B_W_up': _B_in['W_up'], 'B_W_down': _B_in['W_down'], 'c': _w((lambda *s: torch.randn(*s, dtype=torch.bfloat16) * 0.1)(1, 1024) * 8.0), 'w_mod': _w((lambda *s: torch.randn(*s, dtype=torch.bfloat16) * 0.1)(1024, 6 * 1024) * 1024 ** (-0.5) * 8.0)}

def reference(A_x, A_wq, A_wk, A_wv, A_wo, B_x, B_W_gate, B_W_up, B_W_down, c, w_mod):

    def _A_ref(x, wq, wk, wv, wo):
        B, S, D = x.shape
        H = 32
        Dh = D // H
        q = (lambda x, *d: x.permute(*d))((x @ wq).reshape(B, S, H, Dh), 0, 2, 1, 3)
        k = x @ wk
        v = x @ wv
        scores = torch.einsum('bhqd,bkd->bhqk', q, k) * Dh ** (-0.5)
        p = _softmax(scores, axis=-1)
        o = torch.einsum('bhqk,bkd->bhqd', p, v)
        return (lambda x, *d: x.permute(*d))(o, 0, 2, 1, 3).reshape(B, S, H * Dh) @ wo

    def _B_ref(x, W_gate, W_up, W_down):
        gate = torch.einsum('bsd,df->bsf', x, W_gate)
        up = torch.einsum('bsd,df->bsf', x, W_up)
        gate = gate * (lambda x, dt: x.to(dt))(gate > 0, gate.dtype)
        h = gate * up
        return torch.einsum('bsf,fd->bsd', h, W_down)
    x = A_x
    mod = (_silu(c) @ w_mod).reshape(c.shape[0], 6, 1, -1)
    sa, ca, ga, sb, cb, gb = (mod[:, 0].clone(), mod[:, 1].clone(), mod[:, 2].clone(), mod[:, 3].clone(), mod[:, 4].clone(), mod[:, 5].clone())
    h = _layernorm(x, axis=-1) * (1 + ca) + sa
    x = x + ga * _A_ref(h, A_wq, A_wk, A_wv, A_wo)
    h = _layernorm(x, axis=-1) * (1 + cb) + sb
    x = x + gb * _B_ref(h, B_W_gate, B_W_up, B_W_down)
    return x
```

```asm
; @launch kernel=k1_kernel grid=(256,1,1) block=(256,1,1) lds=16384
; @launch kernel=k2_kernel grid=(256,1,1) block=(512,1,1) lds=107520
; @launch kernel=k3_kernel grid=(256,1,1) block=(576,1,1) lds=134144
; @launch kernel=k4_kernel grid=(256,1,1) block=(512,1,1) lds=86016
; @launch kernel=k5_kernel grid=(256,1,1) block=(512,1,1) lds=149504
; @launch kernel=k6_kernel grid=(256,1,1) block=(512,1,1) lds=90112
.amdgcn_target "amdgcn-amd-amdhsa--gfx950"
.text
.globl k1_kernel
.p2align 8
.type k1_kernel,@function
k1_kernel:
s_cmp_ge_u32 s2, 256
s_cbranch_scc1 k1_kernel_end
s_load_dwordx4 s[4:7], s[0:1], 72
s_load_dwordx2 s[8:9], s[0:1], 104
s_load_dwordx2 s[10:11], s[0:1], 0
s_load_dwordx2 s[36:37], s[0:1], 8
s_load_dwordx4 s[40:43], s[0:1], 16
s_cmp_lt_u32 s2, 128
s_cbranch_scc1 k1_kernel_ln
s_sub_u32 s2, s2, 128
s_lshr_b32 s3, s2, 4
s_lshl_b32 s3, s3, 3
s_and_b32 s12, s2, 7
s_add_u32 s3, s3, s12
s_lshl_b32 s3, s3, 1
s_bfe_u32 s12, s2, 0x10003
s_add_u32 s33, s3, s12
s_cmp_ge_u32 s33, 64
s_cselect_b32 s3, 32, 0
s_add_u32 s33, s33, s3
v_lshrrev_b32 v1, 2, v0
v_and_b32 v2, 3, v0
v_lshlrev_b32 v3, 3, v0
s_movk_i32 s3, 12288
v_mul_lo_u32 v4, v1, s3
v_lshl_add_u32 v4, v2, 4, v4
s_lshl_b32 s3, s33, 6
v_add_u32 v4, s3, v4
s_waitcnt lgkmcnt(0)
s_mov_b32 s12, s4
s_and_b32 s13, s5, 0xffff
s_mov_b32 s14, 2048
s_mov_b32 s15, 0x00020000
s_mov_b32 s16, s6
s_and_b32 s17, s7, 0xffff
s_mov_b32 s18, 12582912
s_mov_b32 s19, 0x00020000
s_mov_b32 s24, s8
s_and_b32 s25, s9, 0xffff
s_mov_b32 s26, 67108864
s_mov_b32 s27, 0x00020000
buffer_load_dwordx2 v[8:9], v3, s[12:15], 0 offen
s_mov_b32 s3, 0
buffer_load_dwordx4 v[64:67], v4, s[16:19], s3 offen
s_add_u32 s3, s3, 786432
buffer_load_dwordx4 v[68:71], v4, s[16:19], s3 offen
s_add_u32 s3, s3, 786432
buffer_load_dwordx4 v[72:75], v4, s[16:19], s3 offen
s_add_u32 s3, s3, 786432
buffer_load_dwordx4 v[76:79], v4, s[16:19], s3 offen
s_add_u32 s3, s3, 786432
buffer_load_dwordx4 v[80:83], v4, s[16:19], s3 offen
s_add_u32 s3, s3, 786432
buffer_load_dwordx4 v[84:87], v4, s[16:19], s3 offen
s_add_u32 s3, s3, 786432
buffer_load_dwordx4 v[88:91], v4, s[16:19], s3 offen
s_add_u32 s3, s3, 786432
buffer_load_dwordx4 v[92:95], v4, s[16:19], s3 offen
s_add_u32 s3, s3, 786432
buffer_load_dwordx4 v[96:99], v4, s[16:19], s3 offen
s_add_u32 s3, s3, 786432
buffer_load_dwordx4 v[100:103], v4, s[16:19], s3 offen
s_add_u32 s3, s3, 786432
buffer_load_dwordx4 v[104:107], v4, s[16:19], s3 offen
s_add_u32 s3, s3, 786432
buffer_load_dwordx4 v[108:111], v4, s[16:19], s3 offen
s_add_u32 s3, s3, 786432
buffer_load_dwordx4 v[112:115], v4, s[16:19], s3 offen
s_add_u32 s3, s3, 786432
buffer_load_dwordx4 v[116:119], v4, s[16:19], s3 offen
s_add_u32 s3, s3, 786432
buffer_load_dwordx4 v[120:123], v4, s[16:19], s3 offen
s_add_u32 s3, s3, 786432
buffer_load_dwordx4 v[124:127], v4, s[16:19], s3 offen
s_waitcnt vmcnt(16)
s_mov_b32 s3, 0xbfb8aa3b
v_lshlrev_b32 v32, 16, v8
v_and_b32 v33, 0xffff0000, v8
v_lshlrev_b32 v34, 16, v9
v_and_b32 v35, 0xffff0000, v9
v_mul_f32 v48, s3, v32
v_mul_f32 v49, s3, v33
v_mul_f32 v50, s3, v34
v_mul_f32 v51, s3, v35
v_exp_f32 v48, v48
v_exp_f32 v49, v49
v_exp_f32 v50, v50
v_exp_f32 v51, v51
s_nop 0
v_add_f32 v48, 1.0, v48
v_add_f32 v49, 1.0, v49
v_add_f32 v50, 1.0, v50
v_add_f32 v51, 1.0, v51
v_rcp_f32 v48, v48
v_rcp_f32 v49, v49
v_rcp_f32 v50, v50
v_rcp_f32 v51, v51
s_nop 0
v_mul_f32 v32, v32, v48
v_mul_f32 v33, v33, v49
v_mul_f32 v34, v34, v50
v_mul_f32 v35, v35, v51
v_cvt_pk_bf16_f32 v8, v32, v33
v_cvt_pk_bf16_f32 v9, v34, v35
s_cmp_eq_u32 s2, 0
s_cbranch_scc0 k1_kernel_nosc
s_mov_b32 s3, 49152
buffer_store_dwordx2 v[8:9], v3, s[24:27], s3 offen sc1
k1_kernel_nosc:
v_lshlrev_b32 v32, 16, v8
v_and_b32 v33, 0xffff0000, v8
v_lshlrev_b32 v34, 16, v9
v_and_b32 v35, 0xffff0000, v9
v_lshlrev_b32 v5, 4, v0
ds_write_b128 v5, v[32:35] offset:12288
s_waitcnt lgkmcnt(0)
s_barrier
v_lshlrev_b32 v5, 2, v1
ds_read_b32 v32, v5 offset:12288
ds_read_b32 v33, v5 offset:12544
ds_read_b32 v34, v5 offset:12800
ds_read_b32 v35, v5 offset:13056
ds_read_b32 v36, v5 offset:13312
ds_read_b32 v37, v5 offset:13568
ds_read_b32 v38, v5 offset:13824
ds_read_b32 v39, v5 offset:14080
ds_read_b32 v40, v5 offset:14336
ds_read_b32 v41, v5 offset:14592
ds_read_b32 v42, v5 offset:14848
ds_read_b32 v43, v5 offset:15104
ds_read_b32 v44, v5 offset:15360
ds_read_b32 v45, v5 offset:15616
ds_read_b32 v46, v5 offset:15872
ds_read_b32 v47, v5 offset:16128
s_waitcnt lgkmcnt(0)
v_mov_b32 v16, 0
v_mov_b32 v17, 0
v_mov_b32 v18, 0
v_mov_b32 v19, 0
v_mov_b32 v20, 0
v_mov_b32 v21, 0
v_mov_b32 v22, 0
v_mov_b32 v23, 0
s_waitcnt vmcnt(15)
v_lshlrev_b32 v24, 16, v64
v_and_b32 v25, 0xffff0000, v64
v_fmac_f32 v16, v32, v24
v_fmac_f32 v17, v32, v25
v_lshlrev_b32 v24, 16, v65
v_and_b32 v25, 0xffff0000, v65
v_fmac_f32 v18, v32, v24
v_fmac_f32 v19, v32, v25
v_lshlrev_b32 v24, 16, v66
v_and_b32 v25, 0xffff0000, v66
v_fmac_f32 v20, v32, v24
v_fmac_f32 v21, v32, v25
v_lshlrev_b32 v24, 16, v67
v_and_b32 v25, 0xffff0000, v67
v_fmac_f32 v22, v32, v24
v_fmac_f32 v23, v32, v25
s_waitcnt vmcnt(14)
v_lshlrev_b32 v24, 16, v68
v_and_b32 v25, 0xffff0000, v68
v_fmac_f32 v16, v33, v24
v_fmac_f32 v17, v33, v25
v_lshlrev_b32 v24, 16, v69
v_and_b32 v25, 0xffff0000, v69
v_fmac_f32 v18, v33, v24
v_fmac_f32 v19, v33, v25
v_lshlrev_b32 v24, 16, v70
v_and_b32 v25, 0xffff0000, v70
v_fmac_f32 v20, v33, v24
v_fmac_f32 v21, v33, v25
v_lshlrev_b32 v24, 16, v71
v_and_b32 v25, 0xffff0000, v71
v_fmac_f32 v22, v33, v24
v_fmac_f32 v23, v33, v25
s_waitcnt vmcnt(13)
v_lshlrev_b32 v24, 16, v72
v_and_b32 v25, 0xffff0000, v72
v_fmac_f32 v16, v34, v24
v_fmac_f32 v17, v34, v25
v_lshlrev_b32 v24, 16, v73
v_and_b32 v25, 0xffff0000, v73
v_fmac_f32 v18, v34, v24
v_fmac_f32 v19, v34, v25
v_lshlrev_b32 v24, 16, v74
v_and_b32 v25, 0xffff0000, v74
v_fmac_f32 v20, v34, v24
v_fmac_f32 v21, v34, v25
v_lshlrev_b32 v24, 16, v75
v_and_b32 v25, 0xffff0000, v75
v_fmac_f32 v22, v34, v24
v_fmac_f32 v23, v34, v25
s_waitcnt vmcnt(12)
v_lshlrev_b32 v24, 16, v76
v_and_b32 v25, 0xffff0000, v76
v_fmac_f32 v16, v35, v24
v_fmac_f32 v17, v35, v25
v_lshlrev_b32 v24, 16, v77
v_and_b32 v25, 0xffff0000, v77
v_fmac_f32 v18, v35, v24
v_fmac_f32 v19, v35, v25
v_lshlrev_b32 v24, 16, v78
v_and_b32 v25, 0xffff0000, v78
v_fmac_f32 v20, v35, v24
v_fmac_f32 v21, v35, v25
v_lshlrev_b32 v24, 16, v79
v_and_b32 v25, 0xffff0000, v79
v_fmac_f32 v22, v35, v24
v_fmac_f32 v23, v35, v25
s_waitcnt vmcnt(11)
v_lshlrev_b32 v24, 16, v80
v_and_b32 v25, 0xffff0000, v80
v_fmac_f32 v16, v36, v24
v_fmac_f32 v17, v36, v25
v_lshlrev_b32 v24, 16, v81
v_and_b32 v25, 0xffff0000, v81
v_fmac_f32 v18, v36, v24
v_fmac_f32 v19, v36, v25
v_lshlrev_b32 v24, 16, v82
v_and_b32 v25, 0xffff0000, v82
v_fmac_f32 v20, v36, v24
v_fmac_f32 v21, v36, v25
v_lshlrev_b32 v24, 16, v83
v_and_b32 v25, 0xffff0000, v83
v_fmac_f32 v22, v36, v24
v_fmac_f32 v23, v36, v25
s_waitcnt vmcnt(10)
v_lshlrev_b32 v24, 16, v84
v_and_b32 v25, 0xffff0000, v84
v_fmac_f32 v16, v37, v24
v_fmac_f32 v17, v37, v25
v_lshlrev_b32 v24, 16, v85
v_and_b32 v25, 0xffff0000, v85
v_fmac_f32 v18, v37, v24
v_fmac_f32 v19, v37, v25
v_lshlrev_b32 v24, 16, v86
v_and_b32 v25, 0xffff0000, v86
v_fmac_f32 v20, v37, v24
v_fmac_f32 v21, v37, v25
v_lshlrev_b32 v24, 16, v87
v_and_b32 v25, 0xffff0000, v87
v_fmac_f32 v22, v37, v24
v_fmac_f32 v23, v37, v25
s_waitcnt vmcnt(9)
v_lshlrev_b32 v24, 16, v88
v_and_b32 v25, 0xffff0000, v88
v_fmac_f32 v16, v38, v24
v_fmac_f32 v17, v38, v25
v_lshlrev_b32 v24, 16, v89
v_and_b32 v25, 0xffff0000, v89
v_fmac_f32 v18, v38, v24
v_fmac_f32 v19, v38, v25
v_lshlrev_b32 v24, 16, v90
v_and_b32 v25, 0xffff0000, v90
v_fmac_f32 v20, v38, v24
v_fmac_f32 v21, v38, v25
v_lshlrev_b32 v24, 16, v91
v_and_b32 v25, 0xffff0000, v91
v_fmac_f32 v22, v38, v24
v_fmac_f32 v23, v38, v25
s_waitcnt vmcnt(8)
v_lshlrev_b32 v24, 16, v92
v_and_b32 v25, 0xffff0000, v92
v_fmac_f32 v16, v39, v24
v_fmac_f32 v17, v39, v25
v_lshlrev_b32 v24, 16, v93
v_and_b32 v25, 0xffff0000, v93
v_fmac_f32 v18, v39, v24
v_fmac_f32 v19, v39, v25
v_lshlrev_b32 v24, 16, v94
v_and_b32 v25, 0xffff0000, v94
v_fmac_f32 v20, v39, v24
v_fmac_f32 v21, v39, v25
v_lshlrev_b32 v24, 16, v95
v_and_b32 v25, 0xffff0000, v95
v_fmac_f32 v22, v39, v24
v_fmac_f32 v23, v39, v25
s_waitcnt vmcnt(7)
v_lshlrev_b32 v24, 16, v96
v_and_b32 v25, 0xffff0000, v96
v_fmac_f32 v16, v40, v24
v_fmac_f32 v17, v40, v25
v_lshlrev_b32 v24, 16, v97
v_and_b32 v25, 0xffff0000, v97
v_fmac_f32 v18, v40, v24
v_fmac_f32 v19, v40, v25
v_lshlrev_b32 v24, 16, v98
v_and_b32 v25, 0xffff0000, v98
v_fmac_f32 v20, v40, v24
v_fmac_f32 v21, v40, v25
v_lshlrev_b32 v24, 16, v99
v_and_b32 v25, 0xffff0000, v99
v_fmac_f32 v22, v40, v24
v_fmac_f32 v23, v40, v25
s_waitcnt vmcnt(6)
v_lshlrev_b32 v24, 16, v100
v_and_b32 v25, 0xffff0000, v100
v_fmac_f32 v16, v41, v24
v_fmac_f32 v17, v41, v25
v_lshlrev_b32 v24, 16, v101
v_and_b32 v25, 0xffff0000, v101
v_fmac_f32 v18, v41, v24
v_fmac_f32 v19, v41, v25
v_lshlrev_b32 v24, 16, v102
v_and_b32 v25, 0xffff0000, v102
v_fmac_f32 v20, v41, v24
v_fmac_f32 v21, v41, v25
v_lshlrev_b32 v24, 16, v103
v_and_b32 v25, 0xffff0000, v103
v_fmac_f32 v22, v41, v24
v_fmac_f32 v23, v41, v25
s_waitcnt vmcnt(5)
v_lshlrev_b32 v24, 16, v104
v_and_b32 v25, 0xffff0000, v104
v_fmac_f32 v16, v42, v24
v_fmac_f32 v17, v42, v25
v_lshlrev_b32 v24, 16, v105
v_and_b32 v25, 0xffff0000, v105
v_fmac_f32 v18, v42, v24
v_fmac_f32 v19, v42, v25
v_lshlrev_b32 v24, 16, v106
v_and_b32 v25, 0xffff0000, v106
v_fmac_f32 v20, v42, v24
v_fmac_f32 v21, v42, v25
v_lshlrev_b32 v24, 16, v107
v_and_b32 v25, 0xffff0000, v107
v_fmac_f32 v22, v42, v24
v_fmac_f32 v23, v42, v25
s_waitcnt vmcnt(4)
v_lshlrev_b32 v24, 16, v108
v_and_b32 v25, 0xffff0000, v108
v_fmac_f32 v16, v43, v24
v_fmac_f32 v17, v43, v25
v_lshlrev_b32 v24, 16, v109
v_and_b32 v25, 0xffff0000, v109
v_fmac_f32 v18, v43, v24
v_fmac_f32 v19, v43, v25
v_lshlrev_b32 v24, 16, v110
v_and_b32 v25, 0xffff0000, v110
v_fmac_f32 v20, v43, v24
v_fmac_f32 v21, v43, v25
v_lshlrev_b32 v24, 16, v111
v_and_b32 v25, 0xffff0000, v111
v_fmac_f32 v22, v43, v24
v_fmac_f32 v23, v43, v25
s_waitcnt vmcnt(3)
v_lshlrev_b32 v24, 16, v112
v_and_b32 v25, 0xffff0000, v112
v_fmac_f32 v16, v44, v24
v_fmac_f32 v17, v44, v25
v_lshlrev_b32 v24, 16, v113
v_and_b32 v25, 0xffff0000, v113
v_fmac_f32 v18, v44, v24
v_fmac_f32 v19, v44, v25
v_lshlrev_b32 v24, 16, v114
v_and_b32 v25, 0xffff0000, v114
v_fmac_f32 v20, v44, v24
v_fmac_f32 v21, v44, v25
v_lshlrev_b32 v24, 16, v115
v_and_b32 v25, 0xffff0000, v115
v_fmac_f32 v22, v44, v24
v_fmac_f32 v23, v44, v25
s_waitcnt vmcnt(2)
v_lshlrev_b32 v24, 16, v116
v_and_b32 v25, 0xffff0000, v116
v_fmac_f32 v16, v45, v24
v_fmac_f32 v17, v45, v25
v_lshlrev_b32 v24, 16, v117
v_and_b32 v25, 0xffff0000, v117
v_fmac_f32 v18, v45, v24
v_fmac_f32 v19, v45, v25
v_lshlrev_b32 v24, 16, v118
v_and_b32 v25, 0xffff0000, v118
v_fmac_f32 v20, v45, v24
v_fmac_f32 v21, v45, v25
v_lshlrev_b32 v24, 16, v119
v_and_b32 v25, 0xffff0000, v119
v_fmac_f32 v22, v45, v24
v_fmac_f32 v23, v45, v25
s_waitcnt vmcnt(1)
v_lshlrev_b32 v24, 16, v120
v_and_b32 v25, 0xffff0000, v120
v_fmac_f32 v16, v46, v24
v_fmac_f32 v17, v46, v25
v_lshlrev_b32 v24, 16, v121
v_and_b32 v25, 0xffff0000, v121
v_fmac_f32 v18, v46, v24
v_fmac_f32 v19, v46, v25
v_lshlrev_b32 v24, 16, v122
v_and_b32 v25, 0xffff0000, v122
v_fmac_f32 v20, v46, v24
v_fmac_f32 v21, v46, v25
v_lshlrev_b32 v24, 16, v123
v_and_b32 v25, 0xffff0000, v123
v_fmac_f32 v22, v46, v24
v_fmac_f32 v23, v46, v25
s_waitcnt vmcnt(0)
v_lshlrev_b32 v24, 16, v124
v_and_b32 v25, 0xffff0000, v124
v_fmac_f32 v16, v47, v24
v_fmac_f32 v17, v47, v25
v_lshlrev_b32 v24, 16, v125
v_and_b32 v25, 0xffff0000, v125
v_fmac_f32 v18, v47, v24
v_fmac_f32 v19, v47, v25
v_lshlrev_b32 v24, 16, v126
v_and_b32 v25, 0xffff0000, v126
v_fmac_f32 v20, v47, v24
v_fmac_f32 v21, v47, v25
v_lshlrev_b32 v24, 16, v127
v_and_b32 v25, 0xffff0000, v127
v_fmac_f32 v22, v47, v24
v_fmac_f32 v23, v47, v25
v_lshlrev_b32 v5, 7, v1
v_lshl_add_u32 v5, v2, 5, v5
ds_write_b128 v5, v[16:19]
ds_write_b128 v5, v[20:23] offset:16
s_waitcnt lgkmcnt(0)
s_barrier
v_and_b32 v6, 31, v0
v_lshrrev_b32 v7, 5, v0
v_lshlrev_b32 v5, 10, v7
v_lshl_add_u32 v5, v6, 2, v5
ds_read_b32 v16, v5 offset:0
ds_read_b32 v17, v5 offset:128
ds_read_b32 v18, v5 offset:256
ds_read_b32 v19, v5 offset:384
ds_read_b32 v20, v5 offset:512
ds_read_b32 v21, v5 offset:640
ds_read_b32 v22, v5 offset:768
ds_read_b32 v23, v5 offset:896
s_waitcnt lgkmcnt(0)
v_add_f32 v16, v16, v17
v_add_f32 v16, v16, v18
v_add_f32 v16, v16, v19
v_add_f32 v16, v16, v20
v_add_f32 v16, v16, v21
v_add_f32 v16, v16, v22
v_add_f32 v16, v16, v23
v_lshlrev_b32 v5, 7, v7
v_lshl_add_u32 v5, v6, 2, v5
ds_write_b32 v5, v16 offset:8192
s_waitcnt lgkmcnt(0)
s_barrier
v_cmp_gt_u32 vcc, 32, v0
s_and_saveexec_b64 s[20:21], vcc
s_cbranch_execz k1_kernel_end
v_lshlrev_b32 v5, 2, v0
ds_read_b32 v16, v5 offset:8192
ds_read_b32 v17, v5 offset:8320
ds_read_b32 v18, v5 offset:8448
ds_read_b32 v19, v5 offset:8576
ds_read_b32 v20, v5 offset:8704
ds_read_b32 v21, v5 offset:8832
ds_read_b32 v22, v5 offset:8960
ds_read_b32 v23, v5 offset:9088
s_waitcnt lgkmcnt(0)
v_add_f32 v16, v16, v17
v_add_f32 v16, v16, v18
v_add_f32 v16, v16, v19
v_add_f32 v16, v16, v20
v_add_f32 v16, v16, v21
v_add_f32 v16, v16, v22
v_add_f32 v16, v16, v23
v_cvt_pk_bf16_f32 v16, v16, v16
v_lshlrev_b32 v16, 16, v16
s_lshr_b32 s3, s33, 5
s_cmp_eq_u32 s3, 1
s_cbranch_scc1 k1_kernel_plus1
s_cmp_eq_u32 s3, 4
s_cbranch_scc0 k1_kernel_st
k1_kernel_plus1:
v_add_f32 v16, 1.0, v16
v_cvt_pk_bf16_f32 v16, v16, v16
v_lshlrev_b32 v16, 16, v16
k1_kernel_st:
s_lshl_b32 s3, s33, 7
s_add_u32 s3, s3, 0
buffer_store_dword v16, v5, s[24:27], s3 offen
v_lshrrev_b32 v17, 16, v16
v_lshlrev_b32 v6, 1, v0
s_lshl_b32 s3, s33, 6
s_add_u32 s3, s3, 32768
buffer_store_short v17, v6, s[24:27], s3 offen
s_endpgm
k1_kernel_ln:
v_lshrrev_b32 v1, 6, v0
v_and_b32 v2, 63, v0
v_readfirstlane_b32 s32, v1
v_and_b32 v3, 15, v2
v_lshrrev_b32 v4, 4, v2
s_mov_b32 s34, s2
v_lshlrev_b32 v5, 11, v3
v_lshl_add_u32 v5, v4, 4, v5
s_lshl_b32 s3, s34, 15
s_lshl_b32 s12, s32, 9
s_add_u32 s3, s3, s12
v_add_u32 v5, s3, v5
s_waitcnt lgkmcnt(0)
s_mov_b32 s12, s10
s_and_b32 s13, s11, 0xffff
s_mov_b32 s14, 4194304
s_mov_b32 s15, 0x00020000
s_mov_b32 s24, s8
s_and_b32 s25, s9, 0xffff
s_mov_b32 s26, 67108864
s_mov_b32 s27, 0x00020000
buffer_load_dwordx4 v[64:67], v5, s[12:15], 0 offen offset:0
buffer_load_dwordx4 v[68:71], v5, s[12:15], 0 offen offset:64
buffer_load_dwordx4 v[72:75], v5, s[12:15], 0 offen offset:128
buffer_load_dwordx4 v[76:79], v5, s[12:15], 0 offen offset:192
buffer_load_dwordx4 v[80:83], v5, s[12:15], 0 offen offset:256
buffer_load_dwordx4 v[84:87], v5, s[12:15], 0 offen offset:320
buffer_load_dwordx4 v[88:91], v5, s[12:15], 0 offen offset:384
buffer_load_dwordx4 v[92:95], v5, s[12:15], 0 offen offset:448
s_mov_b32 s16, s36
s_and_b32 s17, s37, 0xffff
s_mov_b32 s18, 2097152
s_mov_b32 s19, 0x00020000
s_lshl_b32 s30, s34, 14
s_lshl_b32 s3, s32, 12
s_add_u32 s30, s30, s3
v_lshlrev_b32 v8, 4, v2
s_lshl_b32 s3, s32, 10
s_add_u32 m0, s3, 4096
s_nop 0
buffer_load_dwordx4 v8, s[16:19], s30 offen lds
s_add_u32 s30, s30, 1024
buffer_load_dwordx4 v8, s[16:19], s30 offen lds
s_add_u32 s30, s30, 1024
buffer_load_dwordx4 v8, s[16:19], s30 offen lds
s_add_u32 s30, s30, 1024
buffer_load_dwordx4 v8, s[16:19], s30 offen lds
s_add_u32 s30, s30, 1024
s_cmp_eq_u32 s32, 1
s_cbranch_scc0 k1_kernel_nokv
s_cmp_ge_u32 s34, 64
s_cselect_b32 s16, s42, s40
s_cselect_b32 s17, s43, s41
s_and_b32 s17, s17, 0xffff
s_mov_b32 s18, 65536
s_and_b32 s30, s34, 63
s_lshl_b32 s30, s30, 10
buffer_load_dwordx4 v8, s[16:19], s30 offen lds
k1_kernel_nokv:
v_mov_b32 v6, 0
v_lshlrev_b32 v7, 2, v2
s_lshl_b32 s3, s34, 7
s_add_u32 s3, s3, 262144
s_cmp_eq_u32 s32, 0
s_cbranch_scc0 k1_kernel_nz
s_mov_b32 exec_hi, 0
buffer_store_dword v6, v7, s[24:27], s3 offen
s_mov_b32 exec_hi, -1
k1_kernel_nz:
v_mov_b32 v16, 0
v_mov_b32 v17, 0
v_mov_b32 v18, 0
v_mov_b32 v19, 0
s_waitcnt vmcnt(11)
v_lshlrev_b32 v24, 16, v64
v_and_b32 v25, 0xffff0000, v64
v_add_f32 v16, v16, v24
v_add_f32 v17, v17, v25
v_fmac_f32 v18, v24, v24
v_fmac_f32 v19, v25, v25
v_lshlrev_b32 v24, 16, v65
v_and_b32 v25, 0xffff0000, v65
v_add_f32 v16, v16, v24
v_add_f32 v17, v17, v25
v_fmac_f32 v18, v24, v24
v_fmac_f32 v19, v25, v25
v_lshlrev_b32 v24, 16, v66
v_and_b32 v25, 0xffff0000, v66
v_add_f32 v16, v16, v24
v_add_f32 v17, v17, v25
v_fmac_f32 v18, v24, v24
v_fmac_f32 v19, v25, v25
v_lshlrev_b32 v24, 16, v67
v_and_b32 v25, 0xffff0000, v67
v_add_f32 v16, v16, v24
v_add_f32 v17, v17, v25
v_fmac_f32 v18, v24, v24
v_fmac_f32 v19, v25, v25
s_waitcnt vmcnt(10)
v_lshlrev_b32 v24, 16, v68
v_and_b32 v25, 0xffff0000, v68
v_add_f32 v16, v16, v24
v_add_f32 v17, v17, v25
v_fmac_f32 v18, v24, v24
v_fmac_f32 v19, v25, v25
v_lshlrev_b32 v24, 16, v69
v_and_b32 v25, 0xffff0000, v69
v_add_f32 v16, v16, v24
v_add_f32 v17, v17, v25
v_fmac_f32 v18, v24, v24
v_fmac_f32 v19, v25, v25
v_lshlrev_b32 v24, 16, v70
v_and_b32 v25, 0xffff0000, v70
v_add_f32 v16, v16, v24
v_add_f32 v17, v17, v25
v_fmac_f32 v18, v24, v24
v_fmac_f32 v19, v25, v25
v_lshlrev_b32 v24, 16, v71
v_and_b32 v25, 0xffff0000, v71
v_add_f32 v16, v16, v24
v_add_f32 v17, v17, v25
v_fmac_f32 v18, v24, v24
v_fmac_f32 v19, v25, v25
s_waitcnt vmcnt(9)
v_lshlrev_b32 v24, 16, v72
v_and_b32 v25, 0xffff0000, v72
v_add_f32 v16, v16, v24
v_add_f32 v17, v17, v25
v_fmac_f32 v18, v24, v24
v_fmac_f32 v19, v25, v25
v_lshlrev_b32 v24, 16, v73
v_and_b32 v25, 0xffff0000, v73
v_add_f32 v16, v16, v24
v_add_f32 v17, v17, v25
v_fmac_f32 v18, v24, v24
v_fmac_f32 v19, v25, v25
v_lshlrev_b32 v24, 16, v74
v_and_b32 v25, 0xffff0000, v74
v_add_f32 v16, v16, v24
v_add_f32 v17, v17, v25
v_fmac_f32 v18, v24, v24
v_fmac_f32 v19, v25, v25
v_lshlrev_b32 v24, 16, v75
v_and_b32 v25, 0xffff0000, v75
v_add_f32 v16, v16, v24
v_add_f32 v17, v17, v25
v_fmac_f32 v18, v24, v24
v_fmac_f32 v19, v25, v25
s_waitcnt vmcnt(8)
v_lshlrev_b32 v24, 16, v76
v_and_b32 v25, 0xffff0000, v76
v_add_f32 v16, v16, v24
v_add_f32 v17, v17, v25
v_fmac_f32 v18, v24, v24
v_fmac_f32 v19, v25, v25
v_lshlrev_b32 v24, 16, v77
v_and_b32 v25, 0xffff0000, v77
v_add_f32 v16, v16, v24
v_add_f32 v17, v17, v25
v_fmac_f32 v18, v24, v24
v_fmac_f32 v19, v25, v25
v_lshlrev_b32 v24, 16, v78
v_and_b32 v25, 0xffff0000, v78
v_add_f32 v16, v16, v24
v_add_f32 v17, v17, v25
v_fmac_f32 v18, v24, v24
v_fmac_f32 v19, v25, v25
v_lshlrev_b32 v24, 16, v79
v_and_b32 v25, 0xffff0000, v79
v_add_f32 v16, v16, v24
v_add_f32 v17, v17, v25
v_fmac_f32 v18, v24, v24
v_fmac_f32 v19, v25, v25
s_waitcnt vmcnt(7)
v_lshlrev_b32 v24, 16, v80
v_and_b32 v25, 0xffff0000, v80
v_add_f32 v16, v16, v24
v_add_f32 v17, v17, v25
v_fmac_f32 v18, v24, v24
v_fmac_f32 v19, v25, v25
v_lshlrev_b32 v24, 16, v81
v_and_b32 v25, 0xffff0000, v81
v_add_f32 v16, v16, v24
v_add_f32 v17, v17, v25
v_fmac_f32 v18, v24, v24
v_fmac_f32 v19, v25, v25
v_lshlrev_b32 v24, 16, v82
v_and_b32 v25, 0xffff0000, v82
v_add_f32 v16, v16, v24
v_add_f32 v17, v17, v25
v_fmac_f32 v18, v24, v24
v_fmac_f32 v19, v25, v25
v_lshlrev_b32 v24, 16, v83
v_and_b32 v25, 0xffff0000, v83
v_add_f32 v16, v16, v24
v_add_f32 v17, v17, v25
v_fmac_f32 v18, v24, v24
v_fmac_f32 v19, v25, v25
s_waitcnt vmcnt(6)
v_lshlrev_b32 v24, 16, v84
v_and_b32 v25, 0xffff0000, v84
v_add_f32 v16, v16, v24
v_add_f32 v17, v17, v25
v_fmac_f32 v18, v24, v24
v_fmac_f32 v19, v25, v25
v_lshlrev_b32 v24, 16, v85
v_and_b32 v25, 0xffff0000, v85
v_add_f32 v16, v16, v24
v_add_f32 v17, v17, v25
v_fmac_f32 v18, v24, v24
v_fmac_f32 v19, v25, v25
v_lshlrev_b32 v24, 16, v86
v_and_b32 v25, 0xffff0000, v86
v_add_f32 v16, v16, v24
v_add_f32 v17, v17, v25
v_fmac_f32 v18, v24, v24
v_fmac_f32 v19, v25, v25
v_lshlrev_b32 v24, 16, v87
v_and_b32 v25, 0xffff0000, v87
v_add_f32 v16, v16, v24
v_add_f32 v17, v17, v25
v_fmac_f32 v18, v24, v24
v_fmac_f32 v19, v25, v25
s_waitcnt vmcnt(5)
v_lshlrev_b32 v24, 16, v88
v_and_b32 v25, 0xffff0000, v88
v_add_f32 v16, v16, v24
v_add_f32 v17, v17, v25
v_fmac_f32 v18, v24, v24
v_fmac_f32 v19, v25, v25
v_lshlrev_b32 v24, 16, v89
v_and_b32 v25, 0xffff0000, v89
v_add_f32 v16, v16, v24
v_add_f32 v17, v17, v25
v_fmac_f32 v18, v24, v24
v_fmac_f32 v19, v25, v25
v_lshlrev_b32 v24, 16, v90
v_and_b32 v25, 0xffff0000, v90
v_add_f32 v16, v16, v24
v_add_f32 v17, v17, v25
v_fmac_f32 v18, v24, v24
v_fmac_f32 v19, v25, v25
v_lshlrev_b32 v24, 16, v91
v_and_b32 v25, 0xffff0000, v91
v_add_f32 v16, v16, v24
v_add_f32 v17, v17, v25
v_fmac_f32 v18, v24, v24
v_fmac_f32 v19, v25, v25
s_waitcnt vmcnt(4)
v_lshlrev_b32 v24, 16, v92
v_and_b32 v25, 0xffff0000, v92
v_add_f32 v16, v16, v24
v_add_f32 v17, v17, v25
v_fmac_f32 v18, v24, v24
v_fmac_f32 v19, v25, v25
v_lshlrev_b32 v24, 16, v93
v_and_b32 v25, 0xffff0000, v93
v_add_f32 v16, v16, v24
v_add_f32 v17, v17, v25
v_fmac_f32 v18, v24, v24
v_fmac_f32 v19, v25, v25
v_lshlrev_b32 v24, 16, v94
v_and_b32 v25, 0xffff0000, v94
v_add_f32 v16, v16, v24
v_add_f32 v17, v17, v25
v_fmac_f32 v18, v24, v24
v_fmac_f32 v19, v25, v25
v_lshlrev_b32 v24, 16, v95
v_and_b32 v25, 0xffff0000, v95
v_add_f32 v16, v16, v24
v_add_f32 v17, v17, v25
v_fmac_f32 v18, v24, v24
v_fmac_f32 v19, v25, v25
v_add_f32 v16, v16, v17
v_add_f32 v17, v18, v19
v_mov_b32 v18, v16
v_mov_b32 v19, v17
s_nop 1
v_permlane16_swap_b32 v16, v18
v_permlane16_swap_b32 v17, v19
s_nop 1
v_add_f32 v16, v16, v18
v_add_f32 v17, v17, v19
v_mov_b32 v18, v16
v_mov_b32 v19, v17
s_nop 1
v_permlane32_swap_b32 v16, v18
v_permlane32_swap_b32 v17, v19
s_nop 1
v_add_f32 v16, v16, v18
v_add_f32 v17, v17, v19
v_lshlrev_b32 v6, 3, v3
s_lshl_b32 s3, s32, 7
v_add_u32 v7, s3, v6
ds_write_b64 v7, v[16:17]
s_waitcnt lgkmcnt(0)
s_barrier
ds_read_b64 v[26:27], v6 offset:0
ds_read_b64 v[28:29], v6 offset:128
ds_read_b64 v[30:31], v6 offset:256
ds_read_b64 v[32:33], v6 offset:384
s_waitcnt lgkmcnt(0)
v_add_f32 v16, v26, v28
v_add_f32 v17, v27, v29
v_add_f32 v18, v30, v32
v_add_f32 v19, v31, v33
v_add_f32 v16, v16, v18
v_add_f32 v17, v17, v19
s_mov_b32 s3, 0x3a800000
s_mov_b32 s12, 0x3727c5ac
v_mul_f32 v16, s3, v16
v_mul_f32 v17, s3, v17
v_fma_f32 v17, -v16, v16, v17
v_max_f32 v17, 0, v17
v_add_f32 v17, s12, v17
v_rsq_f32 v17, v17
s_nop 0
v_mul_f32 v16, v16, v17
v_sub_f32 v16, 0, v16
v_lshlrev_b32 v5, 4, v2
s_lshl_b32 s3, s34, 10
v_add_u32 v5, s3, v5
s_lshl_b32 s3, s32, 20
s_add_u32 s3, s3, 4194304
v_lshlrev_b32 v24, 16, v64
v_and_b32 v25, 0xffff0000, v64
v_fma_f32 v24, v24, v17, v16
v_fma_f32 v25, v25, v17, v16
v_cvt_pk_bf16_f32 v64, v24, v25
v_lshlrev_b32 v24, 16, v65
v_and_b32 v25, 0xffff0000, v65
v_fma_f32 v24, v24, v17, v16
v_fma_f32 v25, v25, v17, v16
v_cvt_pk_bf16_f32 v65, v24, v25
v_lshlrev_b32 v24, 16, v66
v_and_b32 v25, 0xffff0000, v66
v_fma_f32 v24, v24, v17, v16
v_fma_f32 v25, v25, v17, v16
v_cvt_pk_bf16_f32 v66, v24, v25
v_lshlrev_b32 v24, 16, v67
v_and_b32 v25, 0xffff0000, v67
v_fma_f32 v24, v24, v17, v16
v_fma_f32 v25, v25, v17, v16
v_cvt_pk_bf16_f32 v67, v24, v25
buffer_store_dwordx4 v[64:67], v5, s[24:27], s3 offen sc1
s_add_u32 s3, s3, 131072
v_lshlrev_b32 v24, 16, v68
v_and_b32 v25, 0xffff0000, v68
v_fma_f32 v24, v24, v17, v16
v_fma_f32 v25, v25, v17, v16
v_cvt_pk_bf16_f32 v68, v24, v25
v_lshlrev_b32 v24, 16, v69
v_and_b32 v25, 0xffff0000, v69
v_fma_f32 v24, v24, v17, v16
v_fma_f32 v25, v25, v17, v16
v_cvt_pk_bf16_f32 v69, v24, v25
v_lshlrev_b32 v24, 16, v70
v_and_b32 v25, 0xffff0000, v70
v_fma_f32 v24, v24, v17, v16
v_fma_f32 v25, v25, v17, v16
v_cvt_pk_bf16_f32 v70, v24, v25
v_lshlrev_b32 v24, 16, v71
v_and_b32 v25, 0xffff0000, v71
v_fma_f32 v24, v24, v17, v16
v_fma_f32 v25, v25, v17, v16
v_cvt_pk_bf16_f32 v71, v24, v25
buffer_store_dwordx4 v[68:71], v5, s[24:27], s3 offen sc1
s_add_u32 s3, s3, 131072
v_lshlrev_b32 v24, 16, v72
v_and_b32 v25, 0xffff0000, v72
v_fma_f32 v24, v24, v17, v16
v_fma_f32 v25, v25, v17, v16
v_cvt_pk_bf16_f32 v72, v24, v25
v_lshlrev_b32 v24, 16, v73
v_and_b32 v25, 0xffff0000, v73
v_fma_f32 v24, v24, v17, v16
v_fma_f32 v25, v25, v17, v16
v_cvt_pk_bf16_f32 v73, v24, v25
v_lshlrev_b32 v24, 16, v74
v_and_b32 v25, 0xffff0000, v74
v_fma_f32 v24, v24, v17, v16
v_fma_f32 v25, v25, v17, v16
v_cvt_pk_bf16_f32 v74, v24, v25
v_lshlrev_b32 v24, 16, v75
v_and_b32 v25, 0xffff0000, v75
v_fma_f32 v24, v24, v17, v16
v_fma_f32 v25, v25, v17, v16
v_cvt_pk_bf16_f32 v75, v24, v25
buffer_store_dwordx4 v[72:75], v5, s[24:27], s3 offen sc1
s_add_u32 s3, s3, 131072
v_lshlrev_b32 v24, 16, v76
v_and_b32 v25, 0xffff0000, v76
v_fma_f32 v24, v24, v17, v16
v_fma_f32 v25, v25, v17, v16
v_cvt_pk_bf16_f32 v76, v24, v25
v_lshlrev_b32 v24, 16, v77
v_and_b32 v25, 0xffff0000, v77
v_fma_f32 v24, v24, v17, v16
v_fma_f32 v25, v25, v17, v16
v_cvt_pk_bf16_f32 v77, v24, v25
v_lshlrev_b32 v24, 16, v78
v_and_b32 v25, 0xffff0000, v78
v_fma_f32 v24, v24, v17, v16
v_fma_f32 v25, v25, v17, v16
v_cvt_pk_bf16_f32 v78, v24, v25
v_lshlrev_b32 v24, 16, v79
v_and_b32 v25, 0xffff0000, v79
v_fma_f32 v24, v24, v17, v16
v_fma_f32 v25, v25, v17, v16
v_cvt_pk_bf16_f32 v79, v24, v25
buffer_store_dwordx4 v[76:79], v5, s[24:27], s3 offen sc1
s_add_u32 s3, s3, 131072
v_lshlrev_b32 v24, 16, v80
v_and_b32 v25, 0xffff0000, v80
v_fma_f32 v24, v24, v17, v16
v_fma_f32 v25, v25, v17, v16
v_cvt_pk_bf16_f32 v80, v24, v25
v_lshlrev_b32 v24, 16, v81
v_and_b32 v25, 0xffff0000, v81
v_fma_f32 v24, v24, v17, v16
v_fma_f32 v25, v25, v17, v16
v_cvt_pk_bf16_f32 v81, v24, v25
v_lshlrev_b32 v24, 16, v82
v_and_b32 v25, 0xffff0000, v82
v_fma_f32 v24, v24, v17, v16
v_fma_f32 v25, v25, v17, v16
v_cvt_pk_bf16_f32 v82, v24, v25
v_lshlrev_b32 v24, 16, v83
v_and_b32 v25, 0xffff0000, v83
v_fma_f32 v24, v24, v17, v16
v_fma_f32 v25, v25, v17, v16
v_cvt_pk_bf16_f32 v83, v24, v25
buffer_store_dwordx4 v[80:83], v5, s[24:27], s3 offen sc1
s_add_u32 s3, s3, 131072
v_lshlrev_b32 v24, 16, v84
v_and_b32 v25, 0xffff0000, v84
v_fma_f32 v24, v24, v17, v16
v_fma_f32 v25, v25, v17, v16
v_cvt_pk_bf16_f32 v84, v24, v25
v_lshlrev_b32 v24, 16, v85
v_and_b32 v25, 0xffff0000, v85
v_fma_f32 v24, v24, v17, v16
v_fma_f32 v25, v25, v17, v16
v_cvt_pk_bf16_f32 v85, v24, v25
v_lshlrev_b32 v24, 16, v86
v_and_b32 v25, 0xffff0000, v86
v_fma_f32 v24, v24, v17, v16
v_fma_f32 v25, v25, v17, v16
v_cvt_pk_bf16_f32 v86, v24, v25
v_lshlrev_b32 v24, 16, v87
v_and_b32 v25, 0xffff0000, v87
v_fma_f32 v24, v24, v17, v16
v_fma_f32 v25, v25, v17, v16
v_cvt_pk_bf16_f32 v87, v24, v25
buffer_store_dwordx4 v[84:87], v5, s[24:27], s3 offen sc1
s_add_u32 s3, s3, 131072
v_lshlrev_b32 v24, 16, v88
v_and_b32 v25, 0xffff0000, v88
v_fma_f32 v24, v24, v17, v16
v_fma_f32 v25, v25, v17, v16
v_cvt_pk_bf16_f32 v88, v24, v25
v_lshlrev_b32 v24, 16, v89
v_and_b32 v25, 0xffff0000, v89
v_fma_f32 v24, v24, v17, v16
v_fma_f32 v25, v25, v17, v16
v_cvt_pk_bf16_f32 v89, v24, v25
v_lshlrev_b32 v24, 16, v90
v_and_b32 v25, 0xffff0000, v90
v_fma_f32 v24, v24, v17, v16
v_fma_f32 v25, v25, v17, v16
v_cvt_pk_bf16_f32 v90, v24, v25
v_lshlrev_b32 v24, 16, v91
v_and_b32 v25, 0xffff0000, v91
v_fma_f32 v24, v24, v17, v16
v_fma_f32 v25, v25, v17, v16
v_cvt_pk_bf16_f32 v91, v24, v25
buffer_store_dwordx4 v[88:91], v5, s[24:27], s3 offen sc1
s_add_u32 s3, s3, 131072
v_lshlrev_b32 v24, 16, v92
v_and_b32 v25, 0xffff0000, v92
v_fma_f32 v24, v24, v17, v16
v_fma_f32 v25, v25, v17, v16
v_cvt_pk_bf16_f32 v92, v24, v25
v_lshlrev_b32 v24, 16, v93
v_and_b32 v25, 0xffff0000, v93
v_fma_f32 v24, v24, v17, v16
v_fma_f32 v25, v25, v17, v16
v_cvt_pk_bf16_f32 v93, v24, v25
v_lshlrev_b32 v24, 16, v94
v_and_b32 v25, 0xffff0000, v94
v_fma_f32 v24, v24, v17, v16
v_fma_f32 v25, v25, v17, v16
v_cvt_pk_bf16_f32 v94, v24, v25
v_lshlrev_b32 v24, 16, v95
v_and_b32 v25, 0xffff0000, v95
v_fma_f32 v24, v24, v17, v16
v_fma_f32 v25, v25, v17, v16
v_cvt_pk_bf16_f32 v95, v24, v25
buffer_store_dwordx4 v[92:95], v5, s[24:27], s3 offen sc1
s_endpgm
k1_kernel_end:
s_endpgm
.section .rodata,"a"
.p2align 6
.amdhsa_kernel k1_kernel
  .amdhsa_next_free_vgpr 128
  .amdhsa_next_free_sgpr 102
  .amdhsa_accum_offset 128
  .amdhsa_group_segment_fixed_size 0
  .amdhsa_kernarg_size 112
  .amdhsa_user_sgpr_count 2
  .amdhsa_user_sgpr_kernarg_segment_ptr 1
  .amdhsa_system_sgpr_workgroup_id_x 1
.end_amdhsa_kernel
.text
.globl k2_kernel
.p2align 8
.type k2_kernel,@function
k2_kernel:
s_cmp_ge_u32 s2, 256
s_cbranch_scc1 k2_kernel_end
s_load_dwordx2 s[4:5], s[0:1], 8
s_load_dwordx2 s[8:9], s[0:1], 104
s_load_dwordx4 s[44:47], s[0:1], 16
s_load_dwordx2 s[58:59], s[0:1], 80
v_lshrrev_b32 v1, 6, v0
v_and_b32 v186, 63, v0
v_readfirstlane_b32 s32, v1
s_and_b32 s3, s2, 7
s_lshr_b32 s10, s2, 3
s_lshr_b32 s35, s3, 1
s_lshl_b32 s35, s35, 2
s_and_b32 s11, s10, 3
s_add_u32 s35, s35, s11
s_and_b32 s36, s3, 1
s_lshl_b32 s36, s36, 3
s_lshr_b32 s11, s10, 2
s_add_u32 s36, s36, s11
s_lshr_b32 s33, s32, 2
s_and_b32 s34, s32, 3
s_bfe_u32 s41, s36, 0x10001
v_lshlrev_b32 v176, 4, v186
s_lshl_b32 s3, s34, 11
s_lshl_b32 s10, s35, 13
s_add_u32 s3, s3, s10
s_lshl_b32 s10, s33, 17
s_add_u32 s3, s3, s10
v_add_u32 v176, s3, v176
s_lshl_b32 s10, s41, 10
v_add_u32 v177, 1024, v176
v_subrev_u32 v177, s10, v177
v_add_u32 v176, s10, v176
v_lshrrev_b32 v2, 3, v186
s_lshl_b32 s3, s32, 3
v_add_u32 v3, s3, v2
v_bfe_u32 v4, v3, 1, 1
v_bfe_u32 v5, v3, 3, 1
v_lshl_or_b32 v4, v5, 1, v4
v_bfe_u32 v5, v186, 1, 2
v_xor_b32 v5, v5, v4
v_and_b32 v6, 1, v186
v_lshl_or_b32 v5, v5, 1, v6
v_lshlrev_b32 v5, 4, v5
v_lshl_add_u32 v178, v3, 11, v5
v_lshrrev_b32 v2, 2, v186
s_lshl_b32 s3, s32, 3
v_add_u32 v3, s3, v2
v_bfe_u32 v4, v3, 3, 1
v_bfe_u32 v5, v186, 1, 1
v_xor_b32 v5, v5, v4
v_and_b32 v6, 1, v186
v_lshl_or_b32 v5, v5, 1, v6
v_lshlrev_b32 v5, 4, v5
v_lshl_add_u32 v179, v3, 6, v5
s_lshl_b32 s42, s32, 9
s_add_u32 s42, s42, 65536
s_lshl_b32 s40, s32, 10
s_waitcnt lgkmcnt(0)
s_add_u32 s12, s8, 4194304
s_addc_u32 s13, s9, 0
s_and_b32 s13, s13, 0xffff
s_mov_b32 s14, 4194304
s_mov_b32 s15, 0x00020000
s_lshl_b32 s3, s36, 7
s_add_u32 s16, s4, s3
s_addc_u32 s17, s5, 0
s_and_b32 s17, s17, 0xffff
s_sub_u32 s18, 2097152, s3
s_mov_b32 s19, 0x00020000
s_mov_b32 s24, s8
s_and_b32 s25, s9, 0xffff
s_mov_b32 s26, 67108864
s_mov_b32 s27, 0x00020000
s_and_b32 s56, s36, 1
s_cmp_eq_u32 s56, 1
s_cselect_b32 s20, s46, s44
s_cselect_b32 s21, s47, s45
s_and_b32 s21, s21, 0xffff
s_mov_b32 s22, 65536
s_mov_b32 s23, 0x00020000
s_mov_b32 s37, 0
s_mov_b32 s39, 0
s_mov_b32 s38, 0
v_and_b32 v2, 15, v186
v_lshrrev_b32 v3, 4, v186
s_add_u32 m0, s40, 0
s_nop 0
buffer_load_dwordx4 v178, s[16:19], s38 offen lds
s_add_u32 s38, s38, 131072
s_add_u32 m0, s42, 0
s_mov_b32 exec_hi, 0
buffer_load_dwordx4 v179, s[20:23], s39 offen lds
s_mov_b32 exec_hi, -1
s_add_u32 s39, s39, 4096
v_lshlrev_b32 v4, 4, v186
s_lshl_b32 s3, s32, 10
s_add_u32 m0, s3, 98304
s_add_u32 s3, s3, 0
buffer_load_dwordx4 v4, s[24:27], s3 offen lds
s_add_u32 m0, s40, 8192
s_nop 0
buffer_load_dwordx4 v178, s[16:19], s38 offen lds
s_add_u32 s38, s38, 131072
s_add_u32 m0, s42, 4096
s_mov_b32 exec_hi, 0
buffer_load_dwordx4 v179, s[20:23], s39 offen lds
s_mov_b32 exec_hi, -1
s_add_u32 s39, s39, 4096
buffer_load_dwordx4 v[64:67], v176, s[12:15], s37 offen
buffer_load_dwordx4 v[68:71], v177, s[12:15], s37 offen
s_add_u32 s37, s37, 262144
s_add_u32 m0, s40, 16384
s_nop 0
buffer_load_dwordx4 v178, s[16:19], s38 offen lds
s_add_u32 s38, s38, 131072
s_add_u32 m0, s42, 8192
s_mov_b32 exec_hi, 0
buffer_load_dwordx4 v179, s[20:23], s39 offen lds
s_mov_b32 exec_hi, -1
s_add_u32 s39, s39, 4096
buffer_load_dwordx4 v[72:75], v176, s[12:15], s37 offen
buffer_load_dwordx4 v[76:79], v177, s[12:15], s37 offen
s_add_u32 s37, s37, 262144
s_add_u32 m0, s40, 24576
s_nop 0
buffer_load_dwordx4 v178, s[16:19], s38 offen lds
s_add_u32 s38, s38, 131072
s_add_u32 m0, s42, 12288
s_mov_b32 exec_hi, 0
buffer_load_dwordx4 v179, s[20:23], s39 offen lds
s_mov_b32 exec_hi, -1
s_add_u32 s39, s39, 4096
buffer_load_dwordx4 v[80:83], v176, s[12:15], s37 offen
buffer_load_dwordx4 v[84:87], v177, s[12:15], s37 offen
s_add_u32 s37, s37, 262144
s_add_u32 m0, s40, 32768
s_nop 0
buffer_load_dwordx4 v178, s[16:19], s38 offen lds
s_add_u32 s38, s38, 131072
s_add_u32 m0, s42, 16384
s_mov_b32 exec_hi, 0
buffer_load_dwordx4 v179, s[20:23], s39 offen lds
s_mov_b32 exec_hi, -1
s_add_u32 s39, s39, 4096
buffer_load_dwordx4 v[88:91], v176, s[12:15], s37 offen
buffer_load_dwordx4 v[92:95], v177, s[12:15], s37 offen
s_add_u32 s37, s37, 262144
s_xor_b32 s55, s33, s41
s_lshl_b32 s55, s55, 4
s_lshl_b32 s3, s34, 5
s_add_u32 s55, s55, s3
s_lshl_b32 s3, s35, 7
s_add_u32 s55, s55, s3
v_bfe_u32 v4, v186, 2, 2
v_lshl_add_u32 v5, v3, 3, v4
v_bfe_u32 v6, v5, 1, 1
v_bfe_u32 v7, v5, 3, 1
v_lshl_or_b32 v6, v7, 1, v6
s_lshl_b32 s3, s33, 5
v_add_u32 v5, s3, v5
v_and_b32 v7, 3, v186
v_lshlrev_b32 v7, 3, v7
v_lshl_add_u32 v7, v5, 7, v7
v_xor_b32 v8, 0, v6
v_lshl_add_u32 v180, v8, 5, v7
v_xor_b32 v8, 1, v6
v_lshl_add_u32 v181, v8, 5, v7
v_xor_b32 v8, 2, v6
v_lshl_add_u32 v182, v8, 5, v7
v_xor_b32 v8, 3, v6
v_lshl_add_u32 v183, v8, 5, v7
v_bfe_u32 v6, v5, 3, 1
v_and_b32 v7, 3, v186
v_lshlrev_b32 v7, 3, v7
v_lshl_add_u32 v7, v5, 6, v7
v_add_u32 v7, 65536, v7
v_xor_b32 v8, 0, v6
v_lshl_add_u32 v184, v8, 5, v7
v_xor_b32 v8, 1, v6
v_lshl_add_u32 v185, v8, 5, v7
v_lshlrev_b32 v8, 5, v3
s_lshl_b32 s3, s33, 7
s_add_u32 s3, s3, 98304
v_add_u32 v187, s3, v8
v_mov_b32 v16, 0
v_mov_b32 v17, 0
v_mov_b32 v18, 0
v_mov_b32 v19, 0
v_mov_b32 v20, 0
v_mov_b32 v21, 0
v_mov_b32 v22, 0
v_mov_b32 v23, 0
v_mov_b32 v24, 0
v_mov_b32 v25, 0
v_mov_b32 v26, 0
v_mov_b32 v27, 0
v_mov_b32 v28, 0
v_mov_b32 v29, 0
v_mov_b32 v30, 0
v_mov_b32 v31, 0
v_mov_b32 v32, 0
v_mov_b32 v33, 0
v_mov_b32 v34, 0
v_mov_b32 v35, 0
v_mov_b32 v36, 0
v_mov_b32 v37, 0
v_mov_b32 v38, 0
v_mov_b32 v39, 0
v_mov_b32 v40, 0
v_mov_b32 v41, 0
v_mov_b32 v42, 0
v_mov_b32 v43, 0
v_mov_b32 v44, 0
v_mov_b32 v45, 0
v_mov_b32 v46, 0
v_mov_b32 v47, 0
v_mov_b32 v48, 0
v_mov_b32 v49, 0
v_mov_b32 v50, 0
v_mov_b32 v51, 0
v_mov_b32 v52, 0
v_mov_b32 v53, 0
v_mov_b32 v54, 0
v_mov_b32 v55, 0
s_waitcnt vmcnt(12)
s_barrier
ds_read_b64_tr_b16 v[128:129], v180 offset:0
ds_read_b64_tr_b16 v[130:131], v180 offset:512
ds_read_b64_tr_b16 v[132:133], v181 offset:0
ds_read_b64_tr_b16 v[134:135], v181 offset:512
ds_read_b64_tr_b16 v[136:137], v182 offset:0
ds_read_b64_tr_b16 v[138:139], v182 offset:512
ds_read_b64_tr_b16 v[140:141], v183 offset:0
ds_read_b64_tr_b16 v[142:143], v183 offset:512
ds_read_b64_tr_b16 v[160:161], v184 offset:0
ds_read_b64_tr_b16 v[162:163], v184 offset:256
ds_read_b64_tr_b16 v[164:165], v185 offset:0
ds_read_b64_tr_b16 v[166:167], v185 offset:256
ds_read_b128 v[188:191], v187 offset:0
ds_read_b128 v[192:195], v187 offset:16
ds_read_b128 v[196:199], v187 offset:4096
ds_read_b128 v[200:203], v187 offset:4112
ds_read_b128 v[204:207], v187 offset:256
ds_read_b128 v[208:211], v187 offset:272
ds_read_b128 v[212:215], v187 offset:4352
ds_read_b128 v[216:219], v187 offset:4368
s_waitcnt lgkmcnt(0)
v_lshlrev_b32 v220, 16, v64
v_and_b32 v221, 0xffff0000, v64
v_lshlrev_b32 v222, 16, v65
v_and_b32 v223, 0xffff0000, v65
v_lshlrev_b32 v224, 16, v66
v_and_b32 v225, 0xffff0000, v66
v_lshlrev_b32 v226, 16, v67
v_and_b32 v227, 0xffff0000, v67
v_pk_fma_f32 v[220:221], v[220:221], v[196:197], v[188:189]
v_pk_fma_f32 v[222:223], v[222:223], v[198:199], v[190:191]
v_pk_fma_f32 v[224:225], v[224:225], v[200:201], v[192:193]
v_pk_fma_f32 v[226:227], v[226:227], v[202:203], v[194:195]
v_cvt_pk_bf16_f32 v64, v220, v221
v_cvt_pk_bf16_f32 v65, v222, v223
v_cvt_pk_bf16_f32 v66, v224, v225
v_cvt_pk_bf16_f32 v67, v226, v227
v_lshlrev_b32 v220, 16, v68
v_and_b32 v221, 0xffff0000, v68
v_lshlrev_b32 v222, 16, v69
v_and_b32 v223, 0xffff0000, v69
v_lshlrev_b32 v224, 16, v70
v_and_b32 v225, 0xffff0000, v70
v_lshlrev_b32 v226, 16, v71
v_and_b32 v227, 0xffff0000, v71
v_pk_fma_f32 v[220:221], v[220:221], v[196:197], v[188:189]
v_pk_fma_f32 v[222:223], v[222:223], v[198:199], v[190:191]
v_pk_fma_f32 v[224:225], v[224:225], v[200:201], v[192:193]
v_pk_fma_f32 v[226:227], v[226:227], v[202:203], v[194:195]
v_cvt_pk_bf16_f32 v68, v220, v221
v_cvt_pk_bf16_f32 v69, v222, v223
v_cvt_pk_bf16_f32 v70, v224, v225
v_cvt_pk_bf16_f32 v71, v226, v227
s_cmp_eq_u32 s33, 0
s_cbranch_scc0 k2_kernel_ordb
s_waitcnt vmcnt(8) lgkmcnt(0)
s_barrier
v_mfma_f32_16x16x32_bf16 v[16:19], v[128:131], v[64:67], v[16:19]
ds_read_b64_tr_b16 v[144:145], v180 offset:8192
ds_read_b64_tr_b16 v[146:147], v180 offset:8704
ds_read_b64_tr_b16 v[148:149], v181 offset:8192
s_add_u32 m0, s40, 40960
s_nop 0
buffer_load_dwordx4 v178, s[16:19], s38 offen lds
s_add_u32 s38, s38, 131072
v_mfma_f32_16x16x32_bf16 v[32:35], v[128:131], v[68:71], v[32:35]
ds_read_b64_tr_b16 v[150:151], v181 offset:8704
ds_read_b64_tr_b16 v[152:153], v182 offset:8192
s_add_u32 m0, s42, 20480
s_mov_b32 exec_hi, 0
buffer_load_dwordx4 v179, s[20:23], s39 offen lds
s_mov_b32 exec_hi, -1
s_add_u32 s39, s39, 4096
v_mfma_f32_16x16x32_bf16 v[20:23], v[132:135], v[64:67], v[20:23]
ds_read_b64_tr_b16 v[154:155], v182 offset:8704
ds_read_b64_tr_b16 v[156:157], v183 offset:8192
ds_read_b64_tr_b16 v[158:159], v183 offset:8704
buffer_load_dwordx4 v[96:99], v176, s[12:15], s37 offen
v_mfma_f32_16x16x32_bf16 v[36:39], v[132:135], v[68:71], v[36:39]
ds_read_b64_tr_b16 v[168:169], v184 offset:4096
ds_read_b64_tr_b16 v[170:171], v184 offset:4352
ds_read_b64_tr_b16 v[172:173], v185 offset:4096
buffer_load_dwordx4 v[100:103], v177, s[12:15], s37 offen
s_add_u32 s37, s37, 262144
v_lshlrev_b32 v220, 16, v72
v_and_b32 v221, 0xffff0000, v72
v_lshlrev_b32 v222, 16, v73
v_and_b32 v223, 0xffff0000, v73
v_lshlrev_b32 v224, 16, v74
v_mfma_f32_16x16x32_bf16 v[24:27], v[136:139], v[64:67], v[24:27]
ds_read_b64_tr_b16 v[174:175], v185 offset:4352
ds_read_b128 v[188:191], v187 offset:512
v_and_b32 v225, 0xffff0000, v74
v_lshlrev_b32 v226, 16, v75
v_and_b32 v227, 0xffff0000, v75
v_pk_fma_f32 v[220:221], v[220:221], v[212:213], v[204:205]
v_pk_fma_f32 v[222:223], v[222:223], v[214:215], v[206:207]
v_mfma_f32_16x16x32_bf16 v[40:43], v[136:139], v[68:71], v[40:43]
ds_read_b128 v[192:195], v187 offset:528
ds_read_b128 v[196:199], v187 offset:4608
ds_read_b128 v[200:203], v187 offset:4624
v_pk_fma_f32 v[224:225], v[224:225], v[216:217], v[208:209]
v_pk_fma_f32 v[226:227], v[226:227], v[218:219], v[210:211]
v_cvt_pk_bf16_f32 v72, v220, v221
v_cvt_pk_bf16_f32 v73, v222, v223
v_mfma_f32_16x16x32_bf16 v[28:31], v[140:143], v[64:67], v[28:31]
v_cvt_pk_bf16_f32 v74, v224, v225
v_cvt_pk_bf16_f32 v75, v226, v227
v_lshlrev_b32 v220, 16, v76
v_and_b32 v221, 0xffff0000, v76
v_lshlrev_b32 v222, 16, v77
v_mfma_f32_16x16x32_bf16 v[44:47], v[140:143], v[68:71], v[44:47]
v_and_b32 v223, 0xffff0000, v77
v_lshlrev_b32 v224, 16, v78
v_and_b32 v225, 0xffff0000, v78
v_lshlrev_b32 v226, 16, v79
v_mfma_f32_16x16x32_bf16 v[48:51], v[160:163], v[64:67], v[48:51]
v_and_b32 v227, 0xffff0000, v79
v_pk_fma_f32 v[220:221], v[220:221], v[212:213], v[204:205]
v_pk_fma_f32 v[222:223], v[222:223], v[214:215], v[206:207]
v_pk_fma_f32 v[224:225], v[224:225], v[216:217], v[208:209]
v_pk_fma_f32 v[226:227], v[226:227], v[218:219], v[210:211]
v_mfma_f32_16x16x32_bf16 v[52:55], v[164:167], v[64:67], v[52:55]
v_cvt_pk_bf16_f32 v76, v220, v221
v_cvt_pk_bf16_f32 v77, v222, v223
v_cvt_pk_bf16_f32 v78, v224, v225
v_cvt_pk_bf16_f32 v79, v226, v227
s_waitcnt vmcnt(8) lgkmcnt(0)
s_barrier
v_mfma_f32_16x16x32_bf16 v[16:19], v[144:147], v[72:75], v[16:19]
ds_read_b64_tr_b16 v[128:129], v180 offset:16384
ds_read_b64_tr_b16 v[130:131], v180 offset:16896
ds_read_b64_tr_b16 v[132:133], v181 offset:16384
s_add_u32 m0, s40, 49152
s_nop 0
buffer_load_dwordx4 v178, s[16:19], s38 offen lds
s_add_u32 s38, s38, 131072
v_mfma_f32_16x16x32_bf16 v[32:35], v[144:147], v[76:79], v[32:35]
ds_read_b64_tr_b16 v[134:135], v181 offset:16896
ds_read_b64_tr_b16 v[136:137], v182 offset:16384
s_add_u32 m0, s42, 24576
s_mov_b32 exec_hi, 0
buffer_load_dwordx4 v179, s[20:23], s39 offen lds
s_mov_b32 exec_hi, -1
s_add_u32 s39, s39, 4096
v_mfma_f32_16x16x32_bf16 v[20:23], v[148:151], v[72:75], v[20:23]
ds_read_b64_tr_b16 v[138:139], v182 offset:16896
ds_read_b64_tr_b16 v[140:141], v183 offset:16384
ds_read_b64_tr_b16 v[142:143], v183 offset:16896
buffer_load_dwordx4 v[104:107], v176, s[12:15], s37 offen
v_mfma_f32_16x16x32_bf16 v[36:39], v[148:151], v[76:79], v[36:39]
ds_read_b64_tr_b16 v[160:161], v184 offset:8192
ds_read_b64_tr_b16 v[162:163], v184 offset:8448
ds_read_b64_tr_b16 v[164:165], v185 offset:8192
buffer_load_dwordx4 v[108:111], v177, s[12:15], s37 offen
s_add_u32 s37, s37, 262144
v_lshlrev_b32 v220, 16, v80
v_and_b32 v221, 0xffff0000, v80
v_lshlrev_b32 v222, 16, v81
v_and_b32 v223, 0xffff0000, v81
v_lshlrev_b32 v224, 16, v82
v_mfma_f32_16x16x32_bf16 v[24:27], v[152:155], v[72:75], v[24:27]
ds_read_b64_tr_b16 v[166:167], v185 offset:8448
ds_read_b128 v[204:207], v187 offset:768
v_and_b32 v225, 0xffff0000, v82
v_lshlrev_b32 v226, 16, v83
v_and_b32 v227, 0xffff0000, v83
v_pk_fma_f32 v[220:221], v[220:221], v[196:197], v[188:189]
v_pk_fma_f32 v[222:223], v[222:223], v[198:199], v[190:191]
v_mfma_f32_16x16x32_bf16 v[40:43], v[152:155], v[76:79], v[40:43]
ds_read_b128 v[208:211], v187 offset:784
ds_read_b128 v[212:215], v187 offset:4864
ds_read_b128 v[216:219], v187 offset:4880
v_pk_fma_f32 v[224:225], v[224:225], v[200:201], v[192:193]
v_pk_fma_f32 v[226:227], v[226:227], v[202:203], v[194:195]
v_cvt_pk_bf16_f32 v80, v220, v221
v_cvt_pk_bf16_f32 v81, v222, v223
v_mfma_f32_16x16x32_bf16 v[28:31], v[156:159], v[72:75], v[28:31]
v_cvt_pk_bf16_f32 v82, v224, v225
v_cvt_pk_bf16_f32 v83, v226, v227
v_lshlrev_b32 v220, 16, v84
v_and_b32 v221, 0xffff0000, v84
v_lshlrev_b32 v222, 16, v85
v_mfma_f32_16x16x32_bf16 v[44:47], v[156:159], v[76:79], v[44:47]
v_and_b32 v223, 0xffff0000, v85
v_lshlrev_b32 v224, 16, v86
v_and_b32 v225, 0xffff0000, v86
v_lshlrev_b32 v226, 16, v87
v_mfma_f32_16x16x32_bf16 v[48:51], v[168:171], v[72:75], v[48:51]
v_and_b32 v227, 0xffff0000, v87
v_pk_fma_f32 v[220:221], v[220:221], v[196:197], v[188:189]
v_pk_fma_f32 v[222:223], v[222:223], v[198:199], v[190:191]
v_pk_fma_f32 v[224:225], v[224:225], v[200:201], v[192:193]
v_pk_fma_f32 v[226:227], v[226:227], v[202:203], v[194:195]
v_mfma_f32_16x16x32_bf16 v[52:55], v[172:175], v[72:75], v[52:55]
v_cvt_pk_bf16_f32 v84, v220, v221
v_cvt_pk_bf16_f32 v85, v222, v223
v_cvt_pk_bf16_f32 v86, v224, v225
v_cvt_pk_bf16_f32 v87, v226, v227
s_waitcnt vmcnt(8) lgkmcnt(0)
s_barrier
v_mfma_f32_16x16x32_bf16 v[16:19], v[128:131], v[80:83], v[16:19]
ds_read_b64_tr_b16 v[144:145], v180 offset:24576
ds_read_b64_tr_b16 v[146:147], v180 offset:25088
ds_read_b64_tr_b16 v[148:149], v181 offset:24576
s_add_u32 m0, s40, 57344
s_nop 0
buffer_load_dwordx4 v178, s[16:19], s38 offen lds
s_add_u32 s38, s38, 131072
v_mfma_f32_16x16x32_bf16 v[32:35], v[128:131], v[84:87], v[32:35]
ds_read_b64_tr_b16 v[150:151], v181 offset:25088
ds_read_b64_tr_b16 v[152:153], v182 offset:24576
s_add_u32 m0, s42, 28672
s_mov_b32 exec_hi, 0
buffer_load_dwordx4 v179, s[20:23], s39 offen lds
s_mov_b32 exec_hi, -1
s_add_u32 s39, s39, 4096
v_mfma_f32_16x16x32_bf16 v[20:23], v[132:135], v[80:83], v[20:23]
ds_read_b64_tr_b16 v[154:155], v182 offset:25088
ds_read_b64_tr_b16 v[156:157], v183 offset:24576
ds_read_b64_tr_b16 v[158:159], v183 offset:25088
buffer_load_dwordx4 v[112:115], v176, s[12:15], s37 offen
v_mfma_f32_16x16x32_bf16 v[36:39], v[132:135], v[84:87], v[36:39]
ds_read_b64_tr_b16 v[168:169], v184 offset:12288
ds_read_b64_tr_b16 v[170:171], v184 offset:12544
ds_read_b64_tr_b16 v[172:173], v185 offset:12288
buffer_load_dwordx4 v[116:119], v177, s[12:15], s37 offen
s_add_u32 s37, s37, 262144
v_lshlrev_b32 v220, 16, v88
v_and_b32 v221, 0xffff0000, v88
v_lshlrev_b32 v222, 16, v89
v_and_b32 v223, 0xffff0000, v89
v_lshlrev_b32 v224, 16, v90
v_mfma_f32_16x16x32_bf16 v[24:27], v[136:139], v[80:83], v[24:27]
ds_read_b64_tr_b16 v[174:175], v185 offset:12544
ds_read_b128 v[188:191], v187 offset:1024
v_and_b32 v225, 0xffff0000, v90
v_lshlrev_b32 v226, 16, v91
v_and_b32 v227, 0xffff0000, v91
v_pk_fma_f32 v[220:221], v[220:221], v[212:213], v[204:205]
v_pk_fma_f32 v[222:223], v[222:223], v[214:215], v[206:207]
v_mfma_f32_16x16x32_bf16 v[40:43], v[136:139], v[84:87], v[40:43]
ds_read_b128 v[192:195], v187 offset:1040
ds_read_b128 v[196:199], v187 offset:5120
ds_read_b128 v[200:203], v187 offset:5136
v_pk_fma_f32 v[224:225], v[224:225], v[216:217], v[208:209]
v_pk_fma_f32 v[226:227], v[226:227], v[218:219], v[210:211]
v_cvt_pk_bf16_f32 v88, v220, v221
v_cvt_pk_bf16_f32 v89, v222, v223
v_mfma_f32_16x16x32_bf16 v[28:31], v[140:143], v[80:83], v[28:31]
v_cvt_pk_bf16_f32 v90, v224, v225
v_cvt_pk_bf16_f32 v91, v226, v227
v_lshlrev_b32 v220, 16, v92
v_and_b32 v221, 0xffff0000, v92
v_lshlrev_b32 v222, 16, v93
v_mfma_f32_16x16x32_bf16 v[44:47], v[140:143], v[84:87], v[44:47]
v_and_b32 v223, 0xffff0000, v93
v_lshlrev_b32 v224, 16, v94
v_and_b32 v225, 0xffff0000, v94
v_lshlrev_b32 v226, 16, v95
v_mfma_f32_16x16x32_bf16 v[48:51], v[160:163], v[80:83], v[48:51]
v_and_b32 v227, 0xffff0000, v95
v_pk_fma_f32 v[220:221], v[220:221], v[212:213], v[204:205]
v_pk_fma_f32 v[222:223], v[222:223], v[214:215], v[206:207]
v_pk_fma_f32 v[224:225], v[224:225], v[216:217], v[208:209]
v_pk_fma_f32 v[226:227], v[226:227], v[218:219], v[210:211]
v_mfma_f32_16x16x32_bf16 v[52:55], v[164:167], v[80:83], v[52:55]
v_cvt_pk_bf16_f32 v92, v220, v221
v_cvt_pk_bf16_f32 v93, v222, v223
v_cvt_pk_bf16_f32 v94, v224, v225
v_cvt_pk_bf16_f32 v95, v226, v227
s_waitcnt vmcnt(8) lgkmcnt(0)
s_barrier
v_mfma_f32_16x16x32_bf16 v[16:19], v[144:147], v[88:91], v[16:19]
ds_read_b64_tr_b16 v[128:129], v180 offset:32768
ds_read_b64_tr_b16 v[130:131], v180 offset:33280
ds_read_b64_tr_b16 v[132:133], v181 offset:32768
s_add_u32 m0, s40, 0
s_nop 0
buffer_load_dwordx4 v178, s[16:19], s38 offen lds
s_add_u32 s38, s38, 131072
v_mfma_f32_16x16x32_bf16 v[32:35], v[144:147], v[92:95], v[32:35]
ds_read_b64_tr_b16 v[134:135], v181 offset:33280
ds_read_b64_tr_b16 v[136:137], v182 offset:32768
s_add_u32 m0, s42, 0
s_mov_b32 exec_hi, 0
buffer_load_dwordx4 v179, s[20:23], s39 offen lds
s_mov_b32 exec_hi, -1
s_add_u32 s39, s39, 4096
v_mfma_f32_16x16x32_bf16 v[20:23], v[148:151], v[88:91], v[20:23]
ds_read_b64_tr_b16 v[138:139], v182 offset:33280
ds_read_b64_tr_b16 v[140:141], v183 offset:32768
ds_read_b64_tr_b16 v[142:143], v183 offset:33280
buffer_load_dwordx4 v[120:123], v176, s[12:15], s37 offen
v_mfma_f32_16x16x32_bf16 v[36:39], v[148:151], v[92:95], v[36:39]
ds_read_b64_tr_b16 v[160:161], v184 offset:16384
ds_read_b64_tr_b16 v[162:163], v184 offset:16640
ds_read_b64_tr_b16 v[164:165], v185 offset:16384
buffer_load_dwordx4 v[124:127], v177, s[12:15], s37 offen
s_add_u32 s37, s37, 262144
v_lshlrev_b32 v220, 16, v96
v_and_b32 v221, 0xffff0000, v96
v_lshlrev_b32 v222, 16, v97
v_and_b32 v223, 0xffff0000, v97
v_lshlrev_b32 v224, 16, v98
v_mfma_f32_16x16x32_bf16 v[24:27], v[152:155], v[88:91], v[24:27]
ds_read_b64_tr_b16 v[166:167], v185 offset:16640
ds_read_b128 v[204:207], v187 offset:1280
v_and_b32 v225, 0xffff0000, v98
v_lshlrev_b32 v226, 16, v99
v_and_b32 v227, 0xffff0000, v99
v_pk_fma_f32 v[220:221], v[220:221], v[196:197], v[188:189]
v_pk_fma_f32 v[222:223], v[222:223], v[198:199], v[190:191]
v_mfma_f32_16x16x32_bf16 v[40:43], v[152:155], v[92:95], v[40:43]
ds_read_b128 v[208:211], v187 offset:1296
ds_read_b128 v[212:215], v187 offset:5376
ds_read_b128 v[216:219], v187 offset:5392
v_pk_fma_f32 v[224:225], v[224:225], v[200:201], v[192:193]
v_pk_fma_f32 v[226:227], v[226:227], v[202:203], v[194:195]
v_cvt_pk_bf16_f32 v96, v220, v221
v_cvt_pk_bf16_f32 v97, v222, v223
v_mfma_f32_16x16x32_bf16 v[28:31], v[156:159], v[88:91], v[28:31]
v_cvt_pk_bf16_f32 v98, v224, v225
v_cvt_pk_bf16_f32 v99, v226, v227
v_lshlrev_b32 v220, 16, v100
v_and_b32 v221, 0xffff0000, v100
v_lshlrev_b32 v222, 16, v101
v_mfma_f32_16x16x32_bf16 v[44:47], v[156:159], v[92:95], v[44:47]
v_and_b32 v223, 0xffff0000, v101
v_lshlrev_b32 v224, 16, v102
v_and_b32 v225, 0xffff0000, v102
v_lshlrev_b32 v226, 16, v103
v_mfma_f32_16x16x32_bf16 v[48:51], v[168:171], v[88:91], v[48:51]
v_and_b32 v227, 0xffff0000, v103
v_pk_fma_f32 v[220:221], v[220:221], v[196:197], v[188:189]
v_pk_fma_f32 v[222:223], v[222:223], v[198:199], v[190:191]
v_pk_fma_f32 v[224:225], v[224:225], v[200:201], v[192:193]
v_pk_fma_f32 v[226:227], v[226:227], v[202:203], v[194:195]
v_mfma_f32_16x16x32_bf16 v[52:55], v[172:175], v[88:91], v[52:55]
v_cvt_pk_bf16_f32 v100, v220, v221
v_cvt_pk_bf16_f32 v101, v222, v223
v_cvt_pk_bf16_f32 v102, v224, v225
v_cvt_pk_bf16_f32 v103, v226, v227
s_waitcnt vmcnt(8) lgkmcnt(0)
s_barrier
v_mfma_f32_16x16x32_bf16 v[16:19], v[128:131], v[96:99], v[16:19]
ds_read_b64_tr_b16 v[144:145], v180 offset:40960
ds_read_b64_tr_b16 v[146:147], v180 offset:41472
ds_read_b64_tr_b16 v[148:149], v181 offset:40960
s_add_u32 m0, s40, 8192
s_nop 0
buffer_load_dwordx4 v178, s[16:19], s38 offen lds
s_add_u32 s38, s38, 131072
v_mfma_f32_16x16x32_bf16 v[32:35], v[128:131], v[100:103], v[32:35]
ds_read_b64_tr_b16 v[150:151], v181 offset:41472
ds_read_b64_tr_b16 v[152:153], v182 offset:40960
s_add_u32 m0, s42, 4096
s_mov_b32 exec_hi, 0
buffer_load_dwordx4 v179, s[20:23], s39 offen lds
s_mov_b32 exec_hi, -1
s_add_u32 s39, s39, 4096
v_mfma_f32_16x16x32_bf16 v[20:23], v[132:135], v[96:99], v[20:23]
ds_read_b64_tr_b16 v[154:155], v182 offset:41472
ds_read_b64_tr_b16 v[156:157], v183 offset:40960
ds_read_b64_tr_b16 v[158:159], v183 offset:41472
buffer_load_dwordx4 v[64:67], v176, s[12:15], s37 offen
v_mfma_f32_16x16x32_bf16 v[36:39], v[132:135], v[100:103], v[36:39]
ds_read_b64_tr_b16 v[168:169], v184 offset:20480
ds_read_b64_tr_b16 v[170:171], v184 offset:20736
ds_read_b64_tr_b16 v[172:173], v185 offset:20480
buffer_load_dwordx4 v[68:71], v177, s[12:15], s37 offen
s_add_u32 s37, s37, 262144
v_lshlrev_b32 v220, 16, v104
v_and_b32 v221, 0xffff0000, v104
v_lshlrev_b32 v222, 16, v105
v_and_b32 v223, 0xffff0000, v105
v_lshlrev_b32 v224, 16, v106
v_mfma_f32_16x16x32_bf16 v[24:27], v[136:139], v[96:99], v[24:27]
ds_read_b64_tr_b16 v[174:175], v185 offset:20736
ds_read_b128 v[188:191], v187 offset:1536
v_and_b32 v225, 0xffff0000, v106
v_lshlrev_b32 v226, 16, v107
v_and_b32 v227, 0xffff0000, v107
v_pk_fma_f32 v[220:221], v[220:221], v[212:213], v[204:205]
v_pk_fma_f32 v[222:223], v[222:223], v[214:215], v[206:207]
v_mfma_f32_16x16x32_bf16 v[40:43], v[136:139], v[100:103], v[40:43]
ds_read_b128 v[192:195], v187 offset:1552
ds_read_b128 v[196:199], v187 offset:5632
ds_read_b128 v[200:203], v187 offset:5648
v_pk_fma_f32 v[224:225], v[224:225], v[216:217], v[208:209]
v_pk_fma_f32 v[226:227], v[226:227], v[218:219], v[210:211]
v_cvt_pk_bf16_f32 v104, v220, v221
v_cvt_pk_bf16_f32 v105, v222, v223
v_mfma_f32_16x16x32_bf16 v[28:31], v[140:143], v[96:99], v[28:31]
v_cvt_pk_bf16_f32 v106, v224, v225
v_cvt_pk_bf16_f32 v107, v226, v227
v_lshlrev_b32 v220, 16, v108
v_and_b32 v221, 0xffff0000, v108
v_lshlrev_b32 v222, 16, v109
v_mfma_f32_16x16x32_bf16 v[44:47], v[140:143], v[100:103], v[44:47]
v_and_b32 v223, 0xffff0000, v109
v_lshlrev_b32 v224, 16, v110
v_and_b32 v225, 0xffff0000, v110
v_lshlrev_b32 v226, 16, v111
v_mfma_f32_16x16x32_bf16 v[48:51], v[160:163], v[96:99], v[48:51]
v_and_b32 v227, 0xffff0000, v111
v_pk_fma_f32 v[220:221], v[220:221], v[212:213], v[204:205]
v_pk_fma_f32 v[222:223], v[222:223], v[214:215], v[206:207]
v_pk_fma_f32 v[224:225], v[224:225], v[216:217], v[208:209]
v_pk_fma_f32 v[226:227], v[226:227], v[218:219], v[210:211]
v_mfma_f32_16x16x32_bf16 v[52:55], v[164:167], v[96:99], v[52:55]
v_cvt_pk_bf16_f32 v108, v220, v221
v_cvt_pk_bf16_f32 v109, v222, v223
v_cvt_pk_bf16_f32 v110, v224, v225
v_cvt_pk_bf16_f32 v111, v226, v227
s_waitcnt vmcnt(8) lgkmcnt(0)
s_barrier
v_mfma_f32_16x16x32_bf16 v[16:19], v[144:147], v[104:107], v[16:19]
ds_read_b64_tr_b16 v[128:129], v180 offset:49152
ds_read_b64_tr_b16 v[130:131], v180 offset:49664
ds_read_b64_tr_b16 v[132:133], v181 offset:49152
s_add_u32 m0, s40, 16384
s_nop 0
buffer_load_dwordx4 v178, s[16:19], s38 offen lds
s_add_u32 s38, s38, 131072
v_mfma_f32_16x16x32_bf16 v[32:35], v[144:147], v[108:111], v[32:35]
ds_read_b64_tr_b16 v[134:135], v181 offset:49664
ds_read_b64_tr_b16 v[136:137], v182 offset:49152
s_add_u32 m0, s42, 8192
s_mov_b32 exec_hi, 0
buffer_load_dwordx4 v179, s[20:23], s39 offen lds
s_mov_b32 exec_hi, -1
s_add_u32 s39, s39, 4096
v_mfma_f32_16x16x32_bf16 v[20:23], v[148:151], v[104:107], v[20:23]
ds_read_b64_tr_b16 v[138:139], v182 offset:49664
ds_read_b64_tr_b16 v[140:141], v183 offset:49152
ds_read_b64_tr_b16 v[142:143], v183 offset:49664
buffer_load_dwordx4 v[72:75], v176, s[12:15], s37 offen
v_mfma_f32_16x16x32_bf16 v[36:39], v[148:151], v[108:111], v[36:39]
ds_read_b64_tr_b16 v[160:161], v184 offset:24576
ds_read_b64_tr_b16 v[162:163], v184 offset:24832
ds_read_b64_tr_b16 v[164:165], v185 offset:24576
buffer_load_dwordx4 v[76:79], v177, s[12:15], s37 offen
s_add_u32 s37, s37, 262144
v_lshlrev_b32 v220, 16, v112
v_and_b32 v221, 0xffff0000, v112
v_lshlrev_b32 v222, 16, v113
v_and_b32 v223, 0xffff0000, v113
v_lshlrev_b32 v224, 16, v114
v_mfma_f32_16x16x32_bf16 v[24:27], v[152:155], v[104:107], v[24:27]
ds_read_b64_tr_b16 v[166:167], v185 offset:24832
ds_read_b128 v[204:207], v187 offset:1792
v_and_b32 v225, 0xffff0000, v114
v_lshlrev_b32 v226, 16, v115
v_and_b32 v227, 0xffff0000, v115
v_pk_fma_f32 v[220:221], v[220:221], v[196:197], v[188:189]
v_pk_fma_f32 v[222:223], v[222:223], v[198:199], v[190:191]
v_mfma_f32_16x16x32_bf16 v[40:43], v[152:155], v[108:111], v[40:43]
ds_read_b128 v[208:211], v187 offset:1808
ds_read_b128 v[212:215], v187 offset:5888
ds_read_b128 v[216:219], v187 offset:5904
v_pk_fma_f32 v[224:225], v[224:225], v[200:201], v[192:193]
v_pk_fma_f32 v[226:227], v[226:227], v[202:203], v[194:195]
v_cvt_pk_bf16_f32 v112, v220, v221
v_cvt_pk_bf16_f32 v113, v222, v223
v_mfma_f32_16x16x32_bf16 v[28:31], v[156:159], v[104:107], v[28:31]
v_cvt_pk_bf16_f32 v114, v224, v225
v_cvt_pk_bf16_f32 v115, v226, v227
v_lshlrev_b32 v220, 16, v116
v_and_b32 v221, 0xffff0000, v116
v_lshlrev_b32 v222, 16, v117
v_mfma_f32_16x16x32_bf16 v[44:47], v[156:159], v[108:111], v[44:47]
v_and_b32 v223, 0xffff0000, v117
v_lshlrev_b32 v224, 16, v118
v_and_b32 v225, 0xffff0000, v118
v_lshlrev_b32 v226, 16, v119
v_mfma_f32_16x16x32_bf16 v[48:51], v[168:171], v[104:107], v[48:51]
v_and_b32 v227, 0xffff0000, v119
v_pk_fma_f32 v[220:221], v[220:221], v[196:197], v[188:189]
v_pk_fma_f32 v[222:223], v[222:223], v[198:199], v[190:191]
v_pk_fma_f32 v[224:225], v[224:225], v[200:201], v[192:193]
v_pk_fma_f32 v[226:227], v[226:227], v[202:203], v[194:195]
v_mfma_f32_16x16x32_bf16 v[52:55], v[172:175], v[104:107], v[52:55]
v_cvt_pk_bf16_f32 v116, v220, v221
v_cvt_pk_bf16_f32 v117, v222, v223
v_cvt_pk_bf16_f32 v118, v224, v225
v_cvt_pk_bf16_f32 v119, v226, v227
s_waitcnt vmcnt(8) lgkmcnt(0)
s_barrier
v_mfma_f32_16x16x32_bf16 v[16:19], v[128:131], v[112:115], v[16:19]
ds_read_b64_tr_b16 v[144:145], v180 offset:57344
ds_read_b64_tr_b16 v[146:147], v180 offset:57856
ds_read_b64_tr_b16 v[148:149], v181 offset:57344
s_add_u32 m0, s40, 24576
s_nop 0
buffer_load_dwordx4 v178, s[16:19], s38 offen lds
s_add_u32 s38, s38, 131072
v_mfma_f32_16x16x32_bf16 v[32:35], v[128:131], v[116:119], v[32:35]
ds_read_b64_tr_b16 v[150:151], v181 offset:57856
ds_read_b64_tr_b16 v[152:153], v182 offset:57344
s_add_u32 m0, s42, 12288
s_mov_b32 exec_hi, 0
buffer_load_dwordx4 v179, s[20:23], s39 offen lds
s_mov_b32 exec_hi, -1
s_add_u32 s39, s39, 4096
v_mfma_f32_16x16x32_bf16 v[20:23], v[132:135], v[112:115], v[20:23]
ds_read_b64_tr_b16 v[154:155], v182 offset:57856
ds_read_b64_tr_b16 v[156:157], v183 offset:57344
ds_read_b64_tr_b16 v[158:159], v183 offset:57856
buffer_load_dwordx4 v[80:83], v176, s[12:15], s37 offen
v_mfma_f32_16x16x32_bf16 v[36:39], v[132:135], v[116:119], v[36:39]
ds_read_b64_tr_b16 v[168:169], v184 offset:28672
ds_read_b64_tr_b16 v[170:171], v184 offset:28928
ds_read_b64_tr_b16 v[172:173], v185 offset:28672
buffer_load_dwordx4 v[84:87], v177, s[12:15], s37 offen
s_add_u32 s37, s37, 262144
v_lshlrev_b32 v220, 16, v120
v_and_b32 v221, 0xffff0000, v120
v_lshlrev_b32 v222, 16, v121
v_and_b32 v223, 0xffff0000, v121
v_lshlrev_b32 v224, 16, v122
v_mfma_f32_16x16x32_bf16 v[24:27], v[136:139], v[112:115], v[24:27]
ds_read_b64_tr_b16 v[174:175], v185 offset:28928
ds_read_b128 v[188:191], v187 offset:2048
v_and_b32 v225, 0xffff0000, v122
v_lshlrev_b32 v226, 16, v123
v_and_b32 v227, 0xffff0000, v123
v_pk_fma_f32 v[220:221], v[220:221], v[212:213], v[204:205]
v_pk_fma_f32 v[222:223], v[222:223], v[214:215], v[206:207]
v_mfma_f32_16x16x32_bf16 v[40:43], v[136:139], v[116:119], v[40:43]
ds_read_b128 v[192:195], v187 offset:2064
ds_read_b128 v[196:199], v187 offset:6144
ds_read_b128 v[200:203], v187 offset:6160
v_pk_fma_f32 v[224:225], v[224:225], v[216:217], v[208:209]
v_pk_fma_f32 v[226:227], v[226:227], v[218:219], v[210:211]
v_cvt_pk_bf16_f32 v120, v220, v221
v_cvt_pk_bf16_f32 v121, v222, v223
v_mfma_f32_16x16x32_bf16 v[28:31], v[140:143], v[112:115], v[28:31]
v_cvt_pk_bf16_f32 v122, v224, v225
v_cvt_pk_bf16_f32 v123, v226, v227
v_lshlrev_b32 v220, 16, v124
v_and_b32 v221, 0xffff0000, v124
v_lshlrev_b32 v222, 16, v125
v_mfma_f32_16x16x32_bf16 v[44:47], v[140:143], v[116:119], v[44:47]
v_and_b32 v223, 0xffff0000, v125
v_lshlrev_b32 v224, 16, v126
v_and_b32 v225, 0xffff0000, v126
v_lshlrev_b32 v226, 16, v127
v_mfma_f32_16x16x32_bf16 v[48:51], v[160:163], v[112:115], v[48:51]
v_and_b32 v227, 0xffff0000, v127
v_pk_fma_f32 v[220:221], v[220:221], v[212:213], v[204:205]
v_pk_fma_f32 v[222:223], v[222:223], v[214:215], v[206:207]
v_pk_fma_f32 v[224:225], v[224:225], v[216:217], v[208:209]
v_pk_fma_f32 v[226:227], v[226:227], v[218:219], v[210:211]
v_mfma_f32_16x16x32_bf16 v[52:55], v[164:167], v[112:115], v[52:55]
v_cvt_pk_bf16_f32 v124, v220, v221
v_cvt_pk_bf16_f32 v125, v222, v223
v_cvt_pk_bf16_f32 v126, v224, v225
v_cvt_pk_bf16_f32 v127, v226, v227
s_waitcnt vmcnt(8) lgkmcnt(0)
s_barrier
v_mfma_f32_16x16x32_bf16 v[16:19], v[144:147], v[120:123], v[16:19]
ds_read_b64_tr_b16 v[128:129], v180 offset:0
ds_read_b64_tr_b16 v[130:131], v180 offset:512
ds_read_b64_tr_b16 v[132:133], v181 offset:0
s_add_u32 m0, s40, 32768
s_nop 0
buffer_load_dwordx4 v178, s[16:19], s38 offen lds
s_add_u32 s38, s38, 131072
v_mfma_f32_16x16x32_bf16 v[32:35], v[144:147], v[124:127], v[32:35]
ds_read_b64_tr_b16 v[134:135], v181 offset:512
ds_read_b64_tr_b16 v[136:137], v182 offset:0
s_add_u32 m0, s42, 16384
s_mov_b32 exec_hi, 0
buffer_load_dwordx4 v179, s[20:23], s39 offen lds
s_mov_b32 exec_hi, -1
s_add_u32 s39, s39, 4096
v_mfma_f32_16x16x32_bf16 v[20:23], v[148:151], v[120:123], v[20:23]
ds_read_b64_tr_b16 v[138:139], v182 offset:512
ds_read_b64_tr_b16 v[140:141], v183 offset:0
ds_read_b64_tr_b16 v[142:143], v183 offset:512
buffer_load_dwordx4 v[88:91], v176, s[12:15], s37 offen
v_mfma_f32_16x16x32_bf16 v[36:39], v[148:151], v[124:127], v[36:39]
ds_read_b64_tr_b16 v[160:161], v184 offset:0
ds_read_b64_tr_b16 v[162:163], v184 offset:256
ds_read_b64_tr_b16 v[164:165], v185 offset:0
buffer_load_dwordx4 v[92:95], v177, s[12:15], s37 offen
s_add_u32 s37, s37, 262144
v_lshlrev_b32 v220, 16, v64
v_and_b32 v221, 0xffff0000, v64
v_lshlrev_b32 v222, 16, v65
v_and_b32 v223, 0xffff0000, v65
v_lshlrev_b32 v224, 16, v66
v_mfma_f32_16x16x32_bf16 v[24:27], v[152:155], v[120:123], v[24:27]
ds_read_b64_tr_b16 v[166:167], v185 offset:256
ds_read_b128 v[204:207], v187 offset:2304
v_and_b32 v225, 0xffff0000, v66
v_lshlrev_b32 v226, 16, v67
v_and_b32 v227, 0xffff0000, v67
v_pk_fma_f32 v[220:221], v[220:221], v[196:197], v[188:189]
v_pk_fma_f32 v[222:223], v[222:223], v[198:199], v[190:191]
v_mfma_f32_16x16x32_bf16 v[40:43], v[152:155], v[124:127], v[40:43]
ds_read_b128 v[208:211], v187 offset:2320
ds_read_b128 v[212:215], v187 offset:6400
ds_read_b128 v[216:219], v187 offset:6416
v_pk_fma_f32 v[224:225], v[224:225], v[200:201], v[192:193]
v_pk_fma_f32 v[226:227], v[226:227], v[202:203], v[194:195]
v_cvt_pk_bf16_f32 v64, v220, v221
v_cvt_pk_bf16_f32 v65, v222, v223
v_mfma_f32_16x16x32_bf16 v[28:31], v[156:159], v[120:123], v[28:31]
v_cvt_pk_bf16_f32 v66, v224, v225
v_cvt_pk_bf16_f32 v67, v226, v227
v_lshlrev_b32 v220, 16, v68
v_and_b32 v221, 0xffff0000, v68
v_lshlrev_b32 v222, 16, v69
v_mfma_f32_16x16x32_bf16 v[44:47], v[156:159], v[124:127], v[44:47]
v_and_b32 v223, 0xffff0000, v69
v_lshlrev_b32 v224, 16, v70
v_and_b32 v225, 0xffff0000, v70
v_lshlrev_b32 v226, 16, v71
v_mfma_f32_16x16x32_bf16 v[48:51], v[168:171], v[120:123], v[48:51]
v_and_b32 v227, 0xffff0000, v71
v_pk_fma_f32 v[220:221], v[220:221], v[196:197], v[188:189]
v_pk_fma_f32 v[222:223], v[222:223], v[198:199], v[190:191]
v_pk_fma_f32 v[224:225], v[224:225], v[200:201], v[192:193]
v_pk_fma_f32 v[226:227], v[226:227], v[202:203], v[194:195]
v_mfma_f32_16x16x32_bf16 v[52:55], v[172:175], v[120:123], v[52:55]
v_cvt_pk_bf16_f32 v68, v220, v221
v_cvt_pk_bf16_f32 v69, v222, v223
v_cvt_pk_bf16_f32 v70, v224, v225
v_cvt_pk_bf16_f32 v71, v226, v227
s_waitcnt vmcnt(8) lgkmcnt(0)
s_barrier
v_mfma_f32_16x16x32_bf16 v[16:19], v[128:131], v[64:67], v[16:19]
ds_read_b64_tr_b16 v[144:145], v180 offset:8192
ds_read_b64_tr_b16 v[146:147], v180 offset:8704
ds_read_b64_tr_b16 v[148:149], v181 offset:8192
s_add_u32 m0, s40, 40960
s_nop 0
buffer_load_dwordx4 v178, s[16:19], s38 offen lds
s_add_u32 s38, s38, 131072
v_mfma_f32_16x16x32_bf16 v[32:35], v[128:131], v[68:71], v[32:35]
ds_read_b64_tr_b16 v[150:151], v181 offset:8704
ds_read_b64_tr_b16 v[152:153], v182 offset:8192
s_add_u32 m0, s42, 20480
s_mov_b32 exec_hi, 0
buffer_load_dwordx4 v179, s[20:23], s39 offen lds
s_mov_b32 exec_hi, -1
s_add_u32 s39, s39, 4096
v_mfma_f32_16x16x32_bf16 v[20:23], v[132:135], v[64:67], v[20:23]
ds_read_b64_tr_b16 v[154:155], v182 offset:8704
ds_read_b64_tr_b16 v[156:157], v183 offset:8192
ds_read_b64_tr_b16 v[158:159], v183 offset:8704
buffer_load_dwordx4 v[96:99], v176, s[12:15], s37 offen
v_mfma_f32_16x16x32_bf16 v[36:39], v[132:135], v[68:71], v[36:39]
ds_read_b64_tr_b16 v[168:169], v184 offset:4096
ds_read_b64_tr_b16 v[170:171], v184 offset:4352
ds_read_b64_tr_b16 v[172:173], v185 offset:4096
buffer_load_dwordx4 v[100:103], v177, s[12:15], s37 offen
s_add_u32 s37, s37, 262144
v_lshlrev_b32 v220, 16, v72
v_and_b32 v221, 0xffff0000, v72
v_lshlrev_b32 v222, 16, v73
v_and_b32 v223, 0xffff0000, v73
v_lshlrev_b32 v224, 16, v74
v_mfma_f32_16x16x32_bf16 v[24:27], v[136:139], v[64:67], v[24:27]
ds_read_b64_tr_b16 v[174:175], v185 offset:4352
ds_read_b128 v[188:191], v187 offset:2560
v_and_b32 v225, 0xffff0000, v74
v_lshlrev_b32 v226, 16, v75
v_and_b32 v227, 0xffff0000, v75
v_pk_fma_f32 v[220:221], v[220:221], v[212:213], v[204:205]
v_pk_fma_f32 v[222:223], v[222:223], v[214:215], v[206:207]
v_mfma_f32_16x16x32_bf16 v[40:43], v[136:139], v[68:71], v[40:43]
ds_read_b128 v[192:195], v187 offset:2576
ds_read_b128 v[196:199], v187 offset:6656
ds_read_b128 v[200:203], v187 offset:6672
v_pk_fma_f32 v[224:225], v[224:225], v[216:217], v[208:209]
v_pk_fma_f32 v[226:227], v[226:227], v[218:219], v[210:211]
v_cvt_pk_bf16_f32 v72, v220, v221
v_cvt_pk_bf16_f32 v73, v222, v223
v_mfma_f32_16x16x32_bf16 v[28:31], v[140:143], v[64:67], v[28:31]
v_cvt_pk_bf16_f32 v74, v224, v225
v_cvt_pk_bf16_f32 v75, v226, v227
v_lshlrev_b32 v220, 16, v76
v_and_b32 v221, 0xffff0000, v76
v_lshlrev_b32 v222, 16, v77
v_mfma_f32_16x16x32_bf16 v[44:47], v[140:143], v[68:71], v[44:47]
v_and_b32 v223, 0xffff0000, v77
v_lshlrev_b32 v224, 16, v78
v_and_b32 v225, 0xffff0000, v78
v_lshlrev_b32 v226, 16, v79
v_mfma_f32_16x16x32_bf16 v[48:51], v[160:163], v[64:67], v[48:51]
v_and_b32 v227, 0xffff0000, v79
v_pk_fma_f32 v[220:221], v[220:221], v[212:213], v[204:205]
v_pk_fma_f32 v[222:223], v[222:223], v[214:215], v[206:207]
v_pk_fma_f32 v[224:225], v[224:225], v[216:217], v[208:209]
v_pk_fma_f32 v[226:227], v[226:227], v[218:219], v[210:211]
v_mfma_f32_16x16x32_bf16 v[52:55], v[164:167], v[64:67], v[52:55]
v_cvt_pk_bf16_f32 v76, v220, v221
v_cvt_pk_bf16_f32 v77, v222, v223
v_cvt_pk_bf16_f32 v78, v224, v225
v_cvt_pk_bf16_f32 v79, v226, v227
s_waitcnt vmcnt(8) lgkmcnt(0)
s_barrier
v_mfma_f32_16x16x32_bf16 v[16:19], v[144:147], v[72:75], v[16:19]
ds_read_b64_tr_b16 v[128:129], v180 offset:16384
ds_read_b64_tr_b16 v[130:131], v180 offset:16896
ds_read_b64_tr_b16 v[132:133], v181 offset:16384
s_add_u32 m0, s40, 49152
s_nop 0
buffer_load_dwordx4 v178, s[16:19], s38 offen lds
s_add_u32 s38, s38, 131072
v_mfma_f32_16x16x32_bf16 v[32:35], v[144:147], v[76:79], v[32:35]
ds_read_b64_tr_b16 v[134:135], v181 offset:16896
ds_read_b64_tr_b16 v[136:137], v182 offset:16384
s_add_u32 m0, s42, 24576
s_mov_b32 exec_hi, 0
buffer_load_dwordx4 v179, s[20:23], s39 offen lds
s_mov_b32 exec_hi, -1
s_add_u32 s39, s39, 4096
v_mfma_f32_16x16x32_bf16 v[20:23], v[148:151], v[72:75], v[20:23]
ds_read_b64_tr_b16 v[138:139], v182 offset:16896
ds_read_b64_tr_b16 v[140:141], v183 offset:16384
ds_read_b64_tr_b16 v[142:143], v183 offset:16896
buffer_load_dwordx4 v[104:107], v176, s[12:15], s37 offen
v_mfma_f32_16x16x32_bf16 v[36:39], v[148:151], v[76:79], v[36:39]
ds_read_b64_tr_b16 v[160:161], v184 offset:8192
ds_read_b64_tr_b16 v[162:163], v184 offset:8448
ds_read_b64_tr_b16 v[164:165], v185 offset:8192
buffer_load_dwordx4 v[108:111], v177, s[12:15], s37 offen
s_add_u32 s37, s37, 262144
v_lshlrev_b32 v220, 16, v80
v_and_b32 v221, 0xffff0000, v80
v_lshlrev_b32 v222, 16, v81
v_and_b32 v223, 0xffff0000, v81
v_lshlrev_b32 v224, 16, v82
v_mfma_f32_16x16x32_bf16 v[24:27], v[152:155], v[72:75], v[24:27]
ds_read_b64_tr_b16 v[166:167], v185 offset:8448
ds_read_b128 v[204:207], v187 offset:2816
v_and_b32 v225, 0xffff0000, v82
v_lshlrev_b32 v226, 16, v83
v_and_b32 v227, 0xffff0000, v83
v_pk_fma_f32 v[220:221], v[220:221], v[196:197], v[188:189]
v_pk_fma_f32 v[222:223], v[222:223], v[198:199], v[190:191]
v_mfma_f32_16x16x32_bf16 v[40:43], v[152:155], v[76:79], v[40:43]
ds_read_b128 v[208:211], v187 offset:2832
ds_read_b128 v[212:215], v187 offset:6912
ds_read_b128 v[216:219], v187 offset:6928
v_pk_fma_f32 v[224:225], v[224:225], v[200:201], v[192:193]
v_pk_fma_f32 v[226:227], v[226:227], v[202:203], v[194:195]
v_cvt_pk_bf16_f32 v80, v220, v221
v_cvt_pk_bf16_f32 v81, v222, v223
v_mfma_f32_16x16x32_bf16 v[28:31], v[156:159], v[72:75], v[28:31]
v_cvt_pk_bf16_f32 v82, v224, v225
v_cvt_pk_bf16_f32 v83, v226, v227
v_lshlrev_b32 v220, 16, v84
v_and_b32 v221, 0xffff0000, v84
v_lshlrev_b32 v222, 16, v85
v_mfma_f32_16x16x32_bf16 v[44:47], v[156:159], v[76:79], v[44:47]
v_and_b32 v223, 0xffff0000, v85
v_lshlrev_b32 v224, 16, v86
v_and_b32 v225, 0xffff0000, v86
v_lshlrev_b32 v226, 16, v87
v_mfma_f32_16x16x32_bf16 v[48:51], v[168:171], v[72:75], v[48:51]
v_and_b32 v227, 0xffff0000, v87
v_pk_fma_f32 v[220:221], v[220:221], v[196:197], v[188:189]
v_pk_fma_f32 v[222:223], v[222:223], v[198:199], v[190:191]
v_pk_fma_f32 v[224:225], v[224:225], v[200:201], v[192:193]
v_pk_fma_f32 v[226:227], v[226:227], v[202:203], v[194:195]
v_mfma_f32_16x16x32_bf16 v[52:55], v[172:175], v[72:75], v[52:55]
v_cvt_pk_bf16_f32 v84, v220, v221
v_cvt_pk_bf16_f32 v85, v222, v223
v_cvt_pk_bf16_f32 v86, v224, v225
v_cvt_pk_bf16_f32 v87, v226, v227
s_waitcnt vmcnt(8) lgkmcnt(0)
s_barrier
v_mfma_f32_16x16x32_bf16 v[16:19], v[128:131], v[80:83], v[16:19]
ds_read_b64_tr_b16 v[144:145], v180 offset:24576
ds_read_b64_tr_b16 v[146:147], v180 offset:25088
ds_read_b64_tr_b16 v[148:149], v181 offset:24576
s_add_u32 m0, s40, 57344
s_nop 0
buffer_load_dwordx4 v178, s[16:19], s38 offen lds
s_add_u32 s38, s38, 131072
v_mfma_f32_16x16x32_bf16 v[32:35], v[128:131], v[84:87], v[32:35]
ds_read_b64_tr_b16 v[150:151], v181 offset:25088
ds_read_b64_tr_b16 v[152:153], v182 offset:24576
s_add_u32 m0, s42, 28672
s_mov_b32 exec_hi, 0
buffer_load_dwordx4 v179, s[20:23], s39 offen lds
s_mov_b32 exec_hi, -1
s_add_u32 s39, s39, 4096
v_mfma_f32_16x16x32_bf16 v[20:23], v[132:135], v[80:83], v[20:23]
ds_read_b64_tr_b16 v[154:155], v182 offset:25088
ds_read_b64_tr_b16 v[156:157], v183 offset:24576
ds_read_b64_tr_b16 v[158:159], v183 offset:25088
buffer_load_dwordx4 v[112:115], v176, s[12:15], s37 offen
v_mfma_f32_16x16x32_bf16 v[36:39], v[132:135], v[84:87], v[36:39]
ds_read_b64_tr_b16 v[168:169], v184 offset:12288
ds_read_b64_tr_b16 v[170:171], v184 offset:12544
ds_read_b64_tr_b16 v[172:173], v185 offset:12288
buffer_load_dwordx4 v[116:119], v177, s[12:15], s37 offen
s_add_u32 s37, s37, 262144
v_lshlrev_b32 v220, 16, v88
v_and_b32 v221, 0xffff0000, v88
v_lshlrev_b32 v222, 16, v89
v_and_b32 v223, 0xffff0000, v89
v_lshlrev_b32 v224, 16, v90
v_mfma_f32_16x16x32_bf16 v[24:27], v[136:139], v[80:83], v[24:27]
ds_read_b64_tr_b16 v[174:175], v185 offset:12544
ds_read_b128 v[188:191], v187 offset:3072
v_and_b32 v225, 0xffff0000, v90
v_lshlrev_b32 v226, 16, v91
v_and_b32 v227, 0xffff0000, v91
v_pk_fma_f32 v[220:221], v[220:221], v[212:213], v[204:205]
v_pk_fma_f32 v[222:223], v[222:223], v[214:215], v[206:207]
v_mfma_f32_16x16x32_bf16 v[40:43], v[136:139], v[84:87], v[40:43]
ds_read_b128 v[192:195], v187 offset:3088
ds_read_b128 v[196:199], v187 offset:7168
ds_read_b128 v[200:203], v187 offset:7184
v_pk_fma_f32 v[224:225], v[224:225], v[216:217], v[208:209]
v_pk_fma_f32 v[226:227], v[226:227], v[218:219], v[210:211]
v_cvt_pk_bf16_f32 v88, v220, v221
v_cvt_pk_bf16_f32 v89, v222, v223
v_mfma_f32_16x16x32_bf16 v[28:31], v[140:143], v[80:83], v[28:31]
v_cvt_pk_bf16_f32 v90, v224, v225
v_cvt_pk_bf16_f32 v91, v226, v227
v_lshlrev_b32 v220, 16, v92
v_and_b32 v221, 0xffff0000, v92
v_lshlrev_b32 v222, 16, v93
v_mfma_f32_16x16x32_bf16 v[44:47], v[140:143], v[84:87], v[44:47]
v_and_b32 v223, 0xffff0000, v93
v_lshlrev_b32 v224, 16, v94
v_and_b32 v225, 0xffff0000, v94
v_lshlrev_b32 v226, 16, v95
v_mfma_f32_16x16x32_bf16 v[48:51], v[160:163], v[80:83], v[48:51]
v_and_b32 v227, 0xffff0000, v95
v_pk_fma_f32 v[220:221], v[220:221], v[212:213], v[204:205]
v_pk_fma_f32 v[222:223], v[222:223], v[214:215], v[206:207]
v_pk_fma_f32 v[224:225], v[224:225], v[216:217], v[208:209]
v_pk_fma_f32 v[226:227], v[226:227], v[218:219], v[210:211]
v_mfma_f32_16x16x32_bf16 v[52:55], v[164:167], v[80:83], v[52:55]
v_cvt_pk_bf16_f32 v92, v220, v221
v_cvt_pk_bf16_f32 v93, v222, v223
v_cvt_pk_bf16_f32 v94, v224, v225
v_cvt_pk_bf16_f32 v95, v226, v227
s_waitcnt vmcnt(8) lgkmcnt(0)
s_barrier
v_mfma_f32_16x16x32_bf16 v[16:19], v[144:147], v[88:91], v[16:19]
ds_read_b64_tr_b16 v[128:129], v180 offset:32768
ds_read_b64_tr_b16 v[130:131], v180 offset:33280
ds_read_b64_tr_b16 v[132:133], v181 offset:32768
buffer_load_dwordx4 v[120:123], v176, s[12:15], s37 offen
v_mfma_f32_16x16x32_bf16 v[32:35], v[144:147], v[92:95], v[32:35]
ds_read_b64_tr_b16 v[134:135], v181 offset:33280
ds_read_b64_tr_b16 v[136:137], v182 offset:32768
buffer_load_dwordx4 v[124:127], v177, s[12:15], s37 offen
s_add_u32 s37, s37, 262144
v_mfma_f32_16x16x32_bf16 v[20:23], v[148:151], v[88:91], v[20:23]
ds_read_b64_tr_b16 v[138:139], v182 offset:33280
ds_read_b64_tr_b16 v[140:141], v183 offset:32768
ds_read_b64_tr_b16 v[142:143], v183 offset:33280
v_mfma_f32_16x16x32_bf16 v[36:39], v[148:151], v[92:95], v[36:39]
ds_read_b64_tr_b16 v[160:161], v184 offset:16384
ds_read_b64_tr_b16 v[162:163], v184 offset:16640
ds_read_b64_tr_b16 v[164:165], v185 offset:16384
v_lshlrev_b32 v220, 16, v96
v_and_b32 v221, 0xffff0000, v96
v_lshlrev_b32 v222, 16, v97
v_and_b32 v223, 0xffff0000, v97
v_lshlrev_b32 v224, 16, v98
v_mfma_f32_16x16x32_bf16 v[24:27], v[152:155], v[88:91], v[24:27]
ds_read_b64_tr_b16 v[166:167], v185 offset:16640
ds_read_b128 v[204:207], v187 offset:3328
v_and_b32 v225, 0xffff0000, v98
v_lshlrev_b32 v226, 16, v99
v_and_b32 v227, 0xffff0000, v99
v_pk_fma_f32 v[220:221], v[220:221], v[196:197], v[188:189]
v_pk_fma_f32 v[222:223], v[222:223], v[198:199], v[190:191]
v_mfma_f32_16x16x32_bf16 v[40:43], v[152:155], v[92:95], v[40:43]
ds_read_b128 v[208:211], v187 offset:3344
ds_read_b128 v[212:215], v187 offset:7424
ds_read_b128 v[216:219], v187 offset:7440
v_pk_fma_f32 v[224:225], v[224:225], v[200:201], v[192:193]
v_pk_fma_f32 v[226:227], v[226:227], v[202:203], v[194:195]
v_cvt_pk_bf16_f32 v96, v220, v221
v_cvt_pk_bf16_f32 v97, v222, v223
v_mfma_f32_16x16x32_bf16 v[28:31], v[156:159], v[88:91], v[28:31]
v_cvt_pk_bf16_f32 v98, v224, v225
v_cvt_pk_bf16_f32 v99, v226, v227
v_lshlrev_b32 v220, 16, v100
v_and_b32 v221, 0xffff0000, v100
v_lshlrev_b32 v222, 16, v101
v_mfma_f32_16x16x32_bf16 v[44:47], v[156:159], v[92:95], v[44:47]
v_and_b32 v223, 0xffff0000, v101
v_lshlrev_b32 v224, 16, v102
v_and_b32 v225, 0xffff0000, v102
v_lshlrev_b32 v226, 16, v103
v_mfma_f32_16x16x32_bf16 v[48:51], v[168:171], v[88:91], v[48:51]
v_and_b32 v227, 0xffff0000, v103
v_pk_fma_f32 v[220:221], v[220:221], v[196:197], v[188:189]
v_pk_fma_f32 v[222:223], v[222:223], v[198:199], v[190:191]
v_pk_fma_f32 v[224:225], v[224:225], v[200:201], v[192:193]
v_pk_fma_f32 v[226:227], v[226:227], v[202:203], v[194:195]
v_mfma_f32_16x16x32_bf16 v[52:55], v[172:175], v[88:91], v[52:55]
v_cvt_pk_bf16_f32 v100, v220, v221
v_cvt_pk_bf16_f32 v101, v222, v223
v_cvt_pk_bf16_f32 v102, v224, v225
v_cvt_pk_bf16_f32 v103, v226, v227
s_waitcnt vmcnt(6) lgkmcnt(0)
s_barrier
v_mfma_f32_16x16x32_bf16 v[16:19], v[128:131], v[96:99], v[16:19]
ds_read_b64_tr_b16 v[144:145], v180 offset:40960
ds_read_b64_tr_b16 v[146:147], v180 offset:41472
ds_read_b64_tr_b16 v[148:149], v181 offset:40960
s_mov_b32 s28, s58
s_and_b32 s29, s59, 0xffff
s_mov_b32 s30, 12582912
s_mov_b32 s31, 0x00020000
s_lshl_b32 s3, s2, 2
s_lshr_b32 s10, s32, 1
s_add_u32 s3, s3, s10
s_mul_i32 s3, s3, 12288
s_and_b32 s10, s32, 1
s_mul_i32 s10, s10, 6144
s_add_u32 s3, s3, s10
s_add_u32 s57, s3, 4096
v_lshlrev_b32 v10, 4, v186
s_mov_b32 m0, 106496
s_nop 0
buffer_load_dwordx4 v10, s[28:31], s57 offen lds
v_mfma_f32_16x16x32_bf16 v[32:35], v[128:131], v[100:103], v[32:35]
ds_read_b64_tr_b16 v[150:151], v181 offset:41472
ds_read_b64_tr_b16 v[152:153], v182 offset:40960
s_add_u32 s57, s57, 1024
s_mov_b32 m0, 106496
s_nop 0
buffer_load_dwordx4 v10, s[28:31], s57 offen lds
v_mfma_f32_16x16x32_bf16 v[20:23], v[132:135], v[96:99], v[20:23]
ds_read_b64_tr_b16 v[154:155], v182 offset:41472
ds_read_b64_tr_b16 v[156:157], v183 offset:40960
ds_read_b64_tr_b16 v[158:159], v183 offset:41472
v_mfma_f32_16x16x32_bf16 v[36:39], v[132:135], v[100:103], v[36:39]
ds_read_b64_tr_b16 v[168:169], v184 offset:20480
ds_read_b64_tr_b16 v[170:171], v184 offset:20736
ds_read_b64_tr_b16 v[172:173], v185 offset:20480
v_lshlrev_b32 v220, 16, v104
v_and_b32 v221, 0xffff0000, v104
v_lshlrev_b32 v222, 16, v105
v_and_b32 v223, 0xffff0000, v105
v_lshlrev_b32 v224, 16, v106
v_mfma_f32_16x16x32_bf16 v[24:27], v[136:139], v[96:99], v[24:27]
ds_read_b64_tr_b16 v[174:175], v185 offset:20736
ds_read_b128 v[188:191], v187 offset:3584
v_and_b32 v225, 0xffff0000, v106
v_lshlrev_b32 v226, 16, v107
v_and_b32 v227, 0xffff0000, v107
v_pk_fma_f32 v[220:221], v[220:221], v[212:213], v[204:205]
v_pk_fma_f32 v[222:223], v[222:223], v[214:215], v[206:207]
v_mfma_f32_16x16x32_bf16 v[40:43], v[136:139], v[100:103], v[40:43]
ds_read_b128 v[192:195], v187 offset:3600
ds_read_b128 v[196:199], v187 offset:7680
ds_read_b128 v[200:203], v187 offset:7696
v_pk_fma_f32 v[224:225], v[224:225], v[216:217], v[208:209]
v_pk_fma_f32 v[226:227], v[226:227], v[218:219], v[210:211]
v_cvt_pk_bf16_f32 v104, v220, v221
v_cvt_pk_bf16_f32 v105, v222, v223
v_mfma_f32_16x16x32_bf16 v[28:31], v[140:143], v[96:99], v[28:31]
v_cvt_pk_bf16_f32 v106, v224, v225
v_cvt_pk_bf16_f32 v107, v226, v227
v_lshlrev_b32 v220, 16, v108
v_and_b32 v221, 0xffff0000, v108
v_lshlrev_b32 v222, 16, v109
v_mfma_f32_16x16x32_bf16 v[44:47], v[140:143], v[100:103], v[44:47]
v_and_b32 v223, 0xffff0000, v109
v_lshlrev_b32 v224, 16, v110
v_and_b32 v225, 0xffff0000, v110
v_lshlrev_b32 v226, 16, v111
v_mfma_f32_16x16x32_bf16 v[48:51], v[160:163], v[96:99], v[48:51]
v_and_b32 v227, 0xffff0000, v111
v_pk_fma_f32 v[220:221], v[220:221], v[212:213], v[204:205]
v_pk_fma_f32 v[222:223], v[222:223], v[214:215], v[206:207]
v_pk_fma_f32 v[224:225], v[224:225], v[216:217], v[208:209]
v_pk_fma_f32 v[226:227], v[226:227], v[218:219], v[210:211]
v_mfma_f32_16x16x32_bf16 v[52:55], v[164:167], v[96:99], v[52:55]
v_cvt_pk_bf16_f32 v108, v220, v221
v_cvt_pk_bf16_f32 v109, v222, v223
v_cvt_pk_bf16_f32 v110, v224, v225
v_cvt_pk_bf16_f32 v111, v226, v227
s_waitcnt vmcnt(4) lgkmcnt(0)
s_barrier
v_mfma_f32_16x16x32_bf16 v[16:19], v[144:147], v[104:107], v[16:19]
ds_read_b64_tr_b16 v[128:129], v180 offset:49152
ds_read_b64_tr_b16 v[130:131], v180 offset:49664
ds_read_b64_tr_b16 v[132:133], v181 offset:49152
v_mfma_f32_16x16x32_bf16 v[32:35], v[144:147], v[108:111], v[32:35]
ds_read_b64_tr_b16 v[134:135], v181 offset:49664
ds_read_b64_tr_b16 v[136:137], v182 offset:49152
v_mfma_f32_16x16x32_bf16 v[20:23], v[148:151], v[104:107], v[20:23]
ds_read_b64_tr_b16 v[138:139], v182 offset:49664
ds_read_b64_tr_b16 v[140:141], v183 offset:49152
ds_read_b64_tr_b16 v[142:143], v183 offset:49664
v_mfma_f32_16x16x32_bf16 v[36:39], v[148:151], v[108:111], v[36:39]
ds_read_b64_tr_b16 v[160:161], v184 offset:24576
ds_read_b64_tr_b16 v[162:163], v184 offset:24832
ds_read_b64_tr_b16 v[164:165], v185 offset:24576
v_lshlrev_b32 v220, 16, v112
v_and_b32 v221, 0xffff0000, v112
v_lshlrev_b32 v222, 16, v113
v_and_b32 v223, 0xffff0000, v113
v_lshlrev_b32 v224, 16, v114
v_mfma_f32_16x16x32_bf16 v[24:27], v[152:155], v[104:107], v[24:27]
ds_read_b64_tr_b16 v[166:167], v185 offset:24832
ds_read_b128 v[204:207], v187 offset:3840
v_and_b32 v225, 0xffff0000, v114
v_lshlrev_b32 v226, 16, v115
v_and_b32 v227, 0xffff0000, v115
v_pk_fma_f32 v[220:221], v[220:221], v[196:197], v[188:189]
v_pk_fma_f32 v[222:223], v[222:223], v[198:199], v[190:191]
v_mfma_f32_16x16x32_bf16 v[40:43], v[152:155], v[108:111], v[40:43]
ds_read_b128 v[208:211], v187 offset:3856
ds_read_b128 v[212:215], v187 offset:7936
ds_read_b128 v[216:219], v187 offset:7952
v_pk_fma_f32 v[224:225], v[224:225], v[200:201], v[192:193]
v_pk_fma_f32 v[226:227], v[226:227], v[202:203], v[194:195]
v_cvt_pk_bf16_f32 v112, v220, v221
v_cvt_pk_bf16_f32 v113, v222, v223
v_mfma_f32_16x16x32_bf16 v[28:31], v[156:159], v[104:107], v[28:31]
v_cvt_pk_bf16_f32 v114, v224, v225
v_cvt_pk_bf16_f32 v115, v226, v227
v_lshlrev_b32 v220, 16, v116
v_and_b32 v221, 0xffff0000, v116
v_lshlrev_b32 v222, 16, v117
v_mfma_f32_16x16x32_bf16 v[44:47], v[156:159], v[108:111], v[44:47]
v_and_b32 v223, 0xffff0000, v117
v_lshlrev_b32 v224, 16, v118
v_and_b32 v225, 0xffff0000, v118
v_lshlrev_b32 v226, 16, v119
v_mfma_f32_16x16x32_bf16 v[48:51], v[168:171], v[104:107], v[48:51]
v_and_b32 v227, 0xffff0000, v119
v_pk_fma_f32 v[220:221], v[220:221], v[196:197], v[188:189]
v_pk_fma_f32 v[222:223], v[222:223], v[198:199], v[190:191]
v_pk_fma_f32 v[224:225], v[224:225], v[200:201], v[192:193]
v_pk_fma_f32 v[226:227], v[226:227], v[202:203], v[194:195]
v_mfma_f32_16x16x32_bf16 v[52:55], v[172:175], v[104:107], v[52:55]
v_cvt_pk_bf16_f32 v116, v220, v221
v_cvt_pk_bf16_f32 v117, v222, v223
v_cvt_pk_bf16_f32 v118, v224, v225
v_cvt_pk_bf16_f32 v119, v226, v227
s_waitcnt vmcnt(2) lgkmcnt(0)
s_barrier
v_mfma_f32_16x16x32_bf16 v[16:19], v[128:131], v[112:115], v[16:19]
ds_read_b64_tr_b16 v[144:145], v180 offset:57344
ds_read_b64_tr_b16 v[146:147], v180 offset:57856
v_mfma_f32_16x16x32_bf16 v[32:35], v[128:131], v[116:119], v[32:35]
ds_read_b64_tr_b16 v[148:149], v181 offset:57344
ds_read_b64_tr_b16 v[150:151], v181 offset:57856
v_mfma_f32_16x16x32_bf16 v[20:23], v[132:135], v[112:115], v[20:23]
ds_read_b64_tr_b16 v[152:153], v182 offset:57344
ds_read_b64_tr_b16 v[154:155], v182 offset:57856
v_mfma_f32_16x16x32_bf16 v[36:39], v[132:135], v[116:119], v[36:39]
ds_read_b64_tr_b16 v[156:157], v183 offset:57344
ds_read_b64_tr_b16 v[158:159], v183 offset:57856
v_lshlrev_b32 v220, 16, v120
v_and_b32 v221, 0xffff0000, v120
v_lshlrev_b32 v222, 16, v121
v_and_b32 v223, 0xffff0000, v121
v_lshlrev_b32 v224, 16, v122
v_mfma_f32_16x16x32_bf16 v[24:27], v[136:139], v[112:115], v[24:27]
ds_read_b64_tr_b16 v[168:169], v184 offset:28672
ds_read_b64_tr_b16 v[170:171], v184 offset:28928
v_and_b32 v225, 0xffff0000, v122
v_lshlrev_b32 v226, 16, v123
v_and_b32 v227, 0xffff0000, v123
v_pk_fma_f32 v[220:221], v[220:221], v[212:213], v[204:205]
v_pk_fma_f32 v[222:223], v[222:223], v[214:215], v[206:207]
v_mfma_f32_16x16x32_bf16 v[40:43], v[136:139], v[116:119], v[40:43]
ds_read_b64_tr_b16 v[172:173], v185 offset:28672
ds_read_b64_tr_b16 v[174:175], v185 offset:28928
v_pk_fma_f32 v[224:225], v[224:225], v[216:217], v[208:209]
v_pk_fma_f32 v[226:227], v[226:227], v[218:219], v[210:211]
v_cvt_pk_bf16_f32 v120, v220, v221
v_cvt_pk_bf16_f32 v121, v222, v223
v_mfma_f32_16x16x32_bf16 v[28:31], v[140:143], v[112:115], v[28:31]
v_cvt_pk_bf16_f32 v122, v224, v225
v_cvt_pk_bf16_f32 v123, v226, v227
v_lshlrev_b32 v220, 16, v124
v_and_b32 v221, 0xffff0000, v124
v_lshlrev_b32 v222, 16, v125
v_mfma_f32_16x16x32_bf16 v[44:47], v[140:143], v[116:119], v[44:47]
v_and_b32 v223, 0xffff0000, v125
v_lshlrev_b32 v224, 16, v126
v_and_b32 v225, 0xffff0000, v126
v_lshlrev_b32 v226, 16, v127
v_mfma_f32_16x16x32_bf16 v[48:51], v[160:163], v[112:115], v[48:51]
v_and_b32 v227, 0xffff0000, v127
v_pk_fma_f32 v[220:221], v[220:221], v[212:213], v[204:205]
v_pk_fma_f32 v[222:223], v[222:223], v[214:215], v[206:207]
v_pk_fma_f32 v[224:225], v[224:225], v[216:217], v[208:209]
v_pk_fma_f32 v[226:227], v[226:227], v[218:219], v[210:211]
v_mfma_f32_16x16x32_bf16 v[52:55], v[164:167], v[112:115], v[52:55]
v_cvt_pk_bf16_f32 v124, v220, v221
v_cvt_pk_bf16_f32 v125, v222, v223
v_cvt_pk_bf16_f32 v126, v224, v225
v_cvt_pk_bf16_f32 v127, v226, v227
s_waitcnt vmcnt(2) lgkmcnt(0)
s_barrier
v_mfma_f32_16x16x32_bf16 v[16:19], v[144:147], v[120:123], v[16:19]
v_mfma_f32_16x16x32_bf16 v[32:35], v[144:147], v[124:127], v[32:35]
v_mfma_f32_16x16x32_bf16 v[20:23], v[148:151], v[120:123], v[20:23]
v_mfma_f32_16x16x32_bf16 v[36:39], v[148:151], v[124:127], v[36:39]
v_mfma_f32_16x16x32_bf16 v[24:27], v[152:155], v[120:123], v[24:27]
v_mfma_f32_16x16x32_bf16 v[40:43], v[152:155], v[124:127], v[40:43]
v_mfma_f32_16x16x32_bf16 v[28:31], v[156:159], v[120:123], v[28:31]
v_mfma_f32_16x16x32_bf16 v[44:47], v[156:159], v[124:127], v[44:47]
v_mfma_f32_16x16x32_bf16 v[48:51], v[168:171], v[120:123], v[48:51]
v_mfma_f32_16x16x32_bf16 v[52:55], v[172:175], v[120:123], v[52:55]
s_branch k2_kernel_ordend
k2_kernel_ordb:
s_waitcnt vmcnt(8) lgkmcnt(0)
s_barrier
v_mfma_f32_16x16x32_bf16 v[16:19], v[128:131], v[64:67], v[16:19]
ds_read_b64_tr_b16 v[144:145], v180 offset:8192
ds_read_b64_tr_b16 v[146:147], v180 offset:8704
ds_read_b64_tr_b16 v[148:149], v181 offset:8192
v_lshlrev_b32 v220, 16, v72
v_and_b32 v221, 0xffff0000, v72
v_lshlrev_b32 v222, 16, v73
v_and_b32 v223, 0xffff0000, v73
v_lshlrev_b32 v224, 16, v74
v_mfma_f32_16x16x32_bf16 v[32:35], v[128:131], v[68:71], v[32:35]
ds_read_b64_tr_b16 v[150:151], v181 offset:8704
ds_read_b64_tr_b16 v[152:153], v182 offset:8192
v_and_b32 v225, 0xffff0000, v74
v_lshlrev_b32 v226, 16, v75
v_and_b32 v227, 0xffff0000, v75
v_pk_fma_f32 v[220:221], v[220:221], v[212:213], v[204:205]
v_pk_fma_f32 v[222:223], v[222:223], v[214:215], v[206:207]
v_mfma_f32_16x16x32_bf16 v[20:23], v[132:135], v[64:67], v[20:23]
ds_read_b64_tr_b16 v[154:155], v182 offset:8704
ds_read_b64_tr_b16 v[156:157], v183 offset:8192
ds_read_b64_tr_b16 v[158:159], v183 offset:8704
v_pk_fma_f32 v[224:225], v[224:225], v[216:217], v[208:209]
v_pk_fma_f32 v[226:227], v[226:227], v[218:219], v[210:211]
v_cvt_pk_bf16_f32 v72, v220, v221
v_cvt_pk_bf16_f32 v73, v222, v223
v_mfma_f32_16x16x32_bf16 v[36:39], v[132:135], v[68:71], v[36:39]
ds_read_b64_tr_b16 v[168:169], v184 offset:4096
ds_read_b64_tr_b16 v[170:171], v184 offset:4352
ds_read_b64_tr_b16 v[172:173], v185 offset:4096
v_cvt_pk_bf16_f32 v74, v224, v225
v_cvt_pk_bf16_f32 v75, v226, v227
v_lshlrev_b32 v220, 16, v76
v_and_b32 v221, 0xffff0000, v76
v_lshlrev_b32 v222, 16, v77
v_mfma_f32_16x16x32_bf16 v[24:27], v[136:139], v[64:67], v[24:27]
ds_read_b64_tr_b16 v[174:175], v185 offset:4352
ds_read_b128 v[188:191], v187 offset:512
v_and_b32 v223, 0xffff0000, v77
v_lshlrev_b32 v224, 16, v78
v_and_b32 v225, 0xffff0000, v78
v_lshlrev_b32 v226, 16, v79
v_mfma_f32_16x16x32_bf16 v[40:43], v[136:139], v[68:71], v[40:43]
ds_read_b128 v[192:195], v187 offset:528
ds_read_b128 v[196:199], v187 offset:4608
ds_read_b128 v[200:203], v187 offset:4624
v_and_b32 v227, 0xffff0000, v79
v_pk_fma_f32 v[220:221], v[220:221], v[212:213], v[204:205]
v_pk_fma_f32 v[222:223], v[222:223], v[214:215], v[206:207]
v_pk_fma_f32 v[224:225], v[224:225], v[216:217], v[208:209]
v_pk_fma_f32 v[226:227], v[226:227], v[218:219], v[210:211]
v_mfma_f32_16x16x32_bf16 v[28:31], v[140:143], v[64:67], v[28:31]
s_add_u32 m0, s40, 40960
s_nop 0
buffer_load_dwordx4 v178, s[16:19], s38 offen lds
s_add_u32 s38, s38, 131072
v_cvt_pk_bf16_f32 v76, v220, v221
v_cvt_pk_bf16_f32 v77, v222, v223
v_cvt_pk_bf16_f32 v78, v224, v225
v_cvt_pk_bf16_f32 v79, v226, v227
v_mfma_f32_16x16x32_bf16 v[44:47], v[140:143], v[68:71], v[44:47]
s_add_u32 m0, s42, 20480
s_mov_b32 exec_hi, 0
buffer_load_dwordx4 v179, s[20:23], s39 offen lds
s_mov_b32 exec_hi, -1
s_add_u32 s39, s39, 4096
v_mfma_f32_16x16x32_bf16 v[48:51], v[160:163], v[64:67], v[48:51]
buffer_load_dwordx4 v[96:99], v176, s[12:15], s37 offen
v_mfma_f32_16x16x32_bf16 v[52:55], v[164:167], v[64:67], v[52:55]
buffer_load_dwordx4 v[100:103], v177, s[12:15], s37 offen
s_add_u32 s37, s37, 262144
s_waitcnt vmcnt(8) lgkmcnt(0)
s_barrier
v_mfma_f32_16x16x32_bf16 v[16:19], v[144:147], v[72:75], v[16:19]
ds_read_b64_tr_b16 v[128:129], v180 offset:16384
ds_read_b64_tr_b16 v[130:131], v180 offset:16896
ds_read_b64_tr_b16 v[132:133], v181 offset:16384
v_lshlrev_b32 v220, 16, v80
v_and_b32 v221, 0xffff0000, v80
v_lshlrev_b32 v222, 16, v81
v_and_b32 v223, 0xffff0000, v81
v_lshlrev_b32 v224, 16, v82
v_mfma_f32_16x16x32_bf16 v[32:35], v[144:147], v[76:79], v[32:35]
ds_read_b64_tr_b16 v[134:135], v181 offset:16896
ds_read_b64_tr_b16 v[136:137], v182 offset:16384
v_and_b32 v225, 0xffff0000, v82
v_lshlrev_b32 v226, 16, v83
v_and_b32 v227, 0xffff0000, v83
v_pk_fma_f32 v[220:221], v[220:221], v[196:197], v[188:189]
v_pk_fma_f32 v[222:223], v[222:223], v[198:199], v[190:191]
v_mfma_f32_16x16x32_bf16 v[20:23], v[148:151], v[72:75], v[20:23]
ds_read_b64_tr_b16 v[138:139], v182 offset:16896
ds_read_b64_tr_b16 v[140:141], v183 offset:16384
ds_read_b64_tr_b16 v[142:143], v183 offset:16896
v_pk_fma_f32 v[224:225], v[224:225], v[200:201], v[192:193]
v_pk_fma_f32 v[226:227], v[226:227], v[202:203], v[194:195]
v_cvt_pk_bf16_f32 v80, v220, v221
v_cvt_pk_bf16_f32 v81, v222, v223
v_mfma_f32_16x16x32_bf16 v[36:39], v[148:151], v[76:79], v[36:39]
ds_read_b64_tr_b16 v[160:161], v184 offset:8192
ds_read_b64_tr_b16 v[162:163], v184 offset:8448
ds_read_b64_tr_b16 v[164:165], v185 offset:8192
v_cvt_pk_bf16_f32 v82, v224, v225
v_cvt_pk_bf16_f32 v83, v226, v227
v_lshlrev_b32 v220, 16, v84
v_and_b32 v221, 0xffff0000, v84
v_lshlrev_b32 v222, 16, v85
v_mfma_f32_16x16x32_bf16 v[24:27], v[152:155], v[72:75], v[24:27]
ds_read_b64_tr_b16 v[166:167], v185 offset:8448
ds_read_b128 v[204:207], v187 offset:768
v_and_b32 v223, 0xffff0000, v85
v_lshlrev_b32 v224, 16, v86
v_and_b32 v225, 0xffff0000, v86
v_lshlrev_b32 v226, 16, v87
v_mfma_f32_16x16x32_bf16 v[40:43], v[152:155], v[76:79], v[40:43]
ds_read_b128 v[208:211], v187 offset:784
ds_read_b128 v[212:215], v187 offset:4864
ds_read_b128 v[216:219], v187 offset:4880
v_and_b32 v227, 0xffff0000, v87
v_pk_fma_f32 v[220:221], v[220:221], v[196:197], v[188:189]
v_pk_fma_f32 v[222:223], v[222:223], v[198:199], v[190:191]
v_pk_fma_f32 v[224:225], v[224:225], v[200:201], v[192:193]
v_pk_fma_f32 v[226:227], v[226:227], v[202:203], v[194:195]
v_mfma_f32_16x16x32_bf16 v[28:31], v[156:159], v[72:75], v[28:31]
s_add_u32 m0, s40, 49152
s_nop 0
buffer_load_dwordx4 v178, s[16:19], s38 offen lds
s_add_u32 s38, s38, 131072
v_cvt_pk_bf16_f32 v84, v220, v221
v_cvt_pk_bf16_f32 v85, v222, v223
v_cvt_pk_bf16_f32 v86, v224, v225
v_cvt_pk_bf16_f32 v87, v226, v227
v_mfma_f32_16x16x32_bf16 v[44:47], v[156:159], v[76:79], v[44:47]
s_add_u32 m0, s42, 24576
s_mov_b32 exec_hi, 0
buffer_load_dwordx4 v179, s[20:23], s39 offen lds
s_mov_b32 exec_hi, -1
s_add_u32 s39, s39, 4096
v_mfma_f32_16x16x32_bf16 v[48:51], v[168:171], v[72:75], v[48:51]
buffer_load_dwordx4 v[104:107], v176, s[12:15], s37 offen
v_mfma_f32_16x16x32_bf16 v[52:55], v[172:175], v[72:75], v[52:55]
buffer_load_dwordx4 v[108:111], v177, s[12:15], s37 offen
s_add_u32 s37, s37, 262144
s_waitcnt vmcnt(8) lgkmcnt(0)
s_barrier
v_mfma_f32_16x16x32_bf16 v[16:19], v[128:131], v[80:83], v[16:19]
ds_read_b64_tr_b16 v[144:145], v180 offset:24576
ds_read_b64_tr_b16 v[146:147], v180 offset:25088
ds_read_b64_tr_b16 v[148:149], v181 offset:24576
v_lshlrev_b32 v220, 16, v88
v_and_b32 v221, 0xffff0000, v88
v_lshlrev_b32 v222, 16, v89
v_and_b32 v223, 0xffff0000, v89
v_lshlrev_b32 v224, 16, v90
v_mfma_f32_16x16x32_bf16 v[32:35], v[128:131], v[84:87], v[32:35]
ds_read_b64_tr_b16 v[150:151], v181 offset:25088
ds_read_b64_tr_b16 v[152:153], v182 offset:24576
v_and_b32 v225, 0xffff0000, v90
v_lshlrev_b32 v226, 16, v91
v_and_b32 v227, 0xffff0000, v91
v_pk_fma_f32 v[220:221], v[220:221], v[212:213], v[204:205]
v_pk_fma_f32 v[222:223], v[222:223], v[214:215], v[206:207]
v_mfma_f32_16x16x32_bf16 v[20:23], v[132:135], v[80:83], v[20:23]
ds_read_b64_tr_b16 v[154:155], v182 offset:25088
ds_read_b64_tr_b16 v[156:157], v183 offset:24576
ds_read_b64_tr_b16 v[158:159], v183 offset:25088
v_pk_fma_f32 v[224:225], v[224:225], v[216:217], v[208:209]
v_pk_fma_f32 v[226:227], v[226:227], v[218:219], v[210:211]
v_cvt_pk_bf16_f32 v88, v220, v221
v_cvt_pk_bf16_f32 v89, v222, v223
v_mfma_f32_16x16x32_bf16 v[36:39], v[132:135], v[84:87], v[36:39]
ds_read_b64_tr_b16 v[168:169], v184 offset:12288
ds_read_b64_tr_b16 v[170:171], v184 offset:12544
ds_read_b64_tr_b16 v[172:173], v185 offset:12288
v_cvt_pk_bf16_f32 v90, v224, v225
v_cvt_pk_bf16_f32 v91, v226, v227
v_lshlrev_b32 v220, 16, v92
v_and_b32 v221, 0xffff0000, v92
v_lshlrev_b32 v222, 16, v93
v_mfma_f32_16x16x32_bf16 v[24:27], v[136:139], v[80:83], v[24:27]
ds_read_b64_tr_b16 v[174:175], v185 offset:12544
ds_read_b128 v[188:191], v187 offset:1024
v_and_b32 v223, 0xffff0000, v93
v_lshlrev_b32 v224, 16, v94
v_and_b32 v225, 0xffff0000, v94
v_lshlrev_b32 v226, 16, v95
v_mfma_f32_16x16x32_bf16 v[40:43], v[136:139], v[84:87], v[40:43]
ds_read_b128 v[192:195], v187 offset:1040
ds_read_b128 v[196:199], v187 offset:5120
ds_read_b128 v[200:203], v187 offset:5136
v_and_b32 v227, 0xffff0000, v95
v_pk_fma_f32 v[220:221], v[220:221], v[212:213], v[204:205]
v_pk_fma_f32 v[222:223], v[222:223], v[214:215], v[206:207]
v_pk_fma_f32 v[224:225], v[224:225], v[216:217], v[208:209]
v_pk_fma_f32 v[226:227], v[226:227], v[218:219], v[210:211]
v_mfma_f32_16x16x32_bf16 v[28:31], v[140:143], v[80:83], v[28:31]
s_add_u32 m0, s40, 57344
s_nop 0
buffer_load_dwordx4 v178, s[16:19], s38 offen lds
s_add_u32 s38, s38, 131072
v_cvt_pk_bf16_f32 v92, v220, v221
v_cvt_pk_bf16_f32 v93, v222, v223
v_cvt_pk_bf16_f32 v94, v224, v225
v_cvt_pk_bf16_f32 v95, v226, v227
v_mfma_f32_16x16x32_bf16 v[44:47], v[140:143], v[84:87], v[44:47]
s_add_u32 m0, s42, 28672
s_mov_b32 exec_hi, 0
buffer_load_dwordx4 v179, s[20:23], s39 offen lds
s_mov_b32 exec_hi, -1
s_add_u32 s39, s39, 4096
v_mfma_f32_16x16x32_bf16 v[48:51], v[160:163], v[80:83], v[48:51]
buffer_load_dwordx4 v[112:115], v176, s[12:15], s37 offen
v_mfma_f32_16x16x32_bf16 v[52:55], v[164:167], v[80:83], v[52:55]
buffer_load_dwordx4 v[116:119], v177, s[12:15], s37 offen
s_add_u32 s37, s37, 262144
s_waitcnt vmcnt(8) lgkmcnt(0)
s_barrier
v_mfma_f32_16x16x32_bf16 v[16:19], v[144:147], v[88:91], v[16:19]
ds_read_b64_tr_b16 v[128:129], v180 offset:32768
ds_read_b64_tr_b16 v[130:131], v180 offset:33280
ds_read_b64_tr_b16 v[132:133], v181 offset:32768
v_lshlrev_b32 v220, 16, v96
v_and_b32 v221, 0xffff0000, v96
v_lshlrev_b32 v222, 16, v97
v_and_b32 v223, 0xffff0000, v97
v_lshlrev_b32 v224, 16, v98
v_mfma_f32_16x16x32_bf16 v[32:35], v[144:147], v[92:95], v[32:35]
ds_read_b64_tr_b16 v[134:135], v181 offset:33280
ds_read_b64_tr_b16 v[136:137], v182 offset:32768
v_and_b32 v225, 0xffff0000, v98
v_lshlrev_b32 v226, 16, v99
v_and_b32 v227, 0xffff0000, v99
v_pk_fma_f32 v[220:221], v[220:221], v[196:197], v[188:189]
v_pk_fma_f32 v[222:223], v[222:223], v[198:199], v[190:191]
v_mfma_f32_16x16x32_bf16 v[20:23], v[148:151], v[88:91], v[20:23]
ds_read_b64_tr_b16 v[138:139], v182 offset:33280
ds_read_b64_tr_b16 v[140:141], v183 offset:32768
ds_read_b64_tr_b16 v[142:143], v183 offset:33280
v_pk_fma_f32 v[224:225], v[224:225], v[200:201], v[192:193]
v_pk_fma_f32 v[226:227], v[226:227], v[202:203], v[194:195]
v_cvt_pk_bf16_f32 v96, v220, v221
v_cvt_pk_bf16_f32 v97, v222, v223
v_mfma_f32_16x16x32_bf16 v[36:39], v[148:151], v[92:95], v[36:39]
ds_read_b64_tr_b16 v[160:161], v184 offset:16384
ds_read_b64_tr_b16 v[162:163], v184 offset:16640
ds_read_b64_tr_b16 v[164:165], v185 offset:16384
v_cvt_pk_bf16_f32 v98, v224, v225
v_cvt_pk_bf16_f32 v99, v226, v227
v_lshlrev_b32 v220, 16, v100
v_and_b32 v221, 0xffff0000, v100
v_lshlrev_b32 v222, 16, v101
v_mfma_f32_16x16x32_bf16 v[24:27], v[152:155], v[88:91], v[24:27]
ds_read_b64_tr_b16 v[166:167], v185 offset:16640
ds_read_b128 v[204:207], v187 offset:1280
v_and_b32 v223, 0xffff0000, v101
v_lshlrev_b32 v224, 16, v102
v_and_b32 v225, 0xffff0000, v102
v_lshlrev_b32 v226, 16, v103
v_mfma_f32_16x16x32_bf16 v[40:43], v[152:155], v[92:95], v[40:43]
ds_read_b128 v[208:211], v187 offset:1296
ds_read_b128 v[212:215], v187 offset:5376
ds_read_b128 v[216:219], v187 offset:5392
v_and_b32 v227, 0xffff0000, v103
v_pk_fma_f32 v[220:221], v[220:221], v[196:197], v[188:189]
v_pk_fma_f32 v[222:223], v[222:223], v[198:199], v[190:191]
v_pk_fma_f32 v[224:225], v[224:225], v[200:201], v[192:193]
v_pk_fma_f32 v[226:227], v[226:227], v[202:203], v[194:195]
v_mfma_f32_16x16x32_bf16 v[28:31], v[156:159], v[88:91], v[28:31]
s_add_u32 m0, s40, 0
s_nop 0
buffer_load_dwordx4 v178, s[16:19], s38 offen lds
s_add_u32 s38, s38, 131072
v_cvt_pk_bf16_f32 v100, v220, v221
v_cvt_pk_bf16_f32 v101, v222, v223
v_cvt_pk_bf16_f32 v102, v224, v225
v_cvt_pk_bf16_f32 v103, v226, v227
v_mfma_f32_16x16x32_bf16 v[44:47], v[156:159], v[92:95], v[44:47]
s_add_u32 m0, s42, 0
s_mov_b32 exec_hi, 0
buffer_load_dwordx4 v179, s[20:23], s39 offen lds
s_mov_b32 exec_hi, -1
s_add_u32 s39, s39, 4096
v_mfma_f32_16x16x32_bf16 v[48:51], v[168:171], v[88:91], v[48:51]
buffer_load_dwordx4 v[120:123], v176, s[12:15], s37 offen
v_mfma_f32_16x16x32_bf16 v[52:55], v[172:175], v[88:91], v[52:55]
buffer_load_dwordx4 v[124:127], v177, s[12:15], s37 offen
s_add_u32 s37, s37, 262144
s_waitcnt vmcnt(8) lgkmcnt(0)
s_barrier
v_mfma_f32_16x16x32_bf16 v[16:19], v[128:131], v[96:99], v[16:19]
ds_read_b64_tr_b16 v[144:145], v180 offset:40960
ds_read_b64_tr_b16 v[146:147], v180 offset:41472
ds_read_b64_tr_b16 v[148:149], v181 offset:40960
v_lshlrev_b32 v220, 16, v104
v_and_b32 v221, 0xffff0000, v104
v_lshlrev_b32 v222, 16, v105
v_and_b32 v223, 0xffff0000, v105
v_lshlrev_b32 v224, 16, v106
v_mfma_f32_16x16x32_bf16 v[32:35], v[128:131], v[100:103], v[32:35]
ds_read_b64_tr_b16 v[150:151], v181 offset:41472
ds_read_b64_tr_b16 v[152:153], v182 offset:40960
v_and_b32 v225, 0xffff0000, v106
v_lshlrev_b32 v226, 16, v107
v_and_b32 v227, 0xffff0000, v107
v_pk_fma_f32 v[220:221], v[220:221], v[212:213], v[204:205]
v_pk_fma_f32 v[222:223], v[222:223], v[214:215], v[206:207]
v_mfma_f32_16x16x32_bf16 v[20:23], v[132:135], v[96:99], v[20:23]
ds_read_b64_tr_b16 v[154:155], v182 offset:41472
ds_read_b64_tr_b16 v[156:157], v183 offset:40960
ds_read_b64_tr_b16 v[158:159], v183 offset:41472
v_pk_fma_f32 v[224:225], v[224:225], v[216:217], v[208:209]
v_pk_fma_f32 v[226:227], v[226:227], v[218:219], v[210:211]
v_cvt_pk_bf16_f32 v104, v220, v221
v_cvt_pk_bf16_f32 v105, v222, v223
v_mfma_f32_16x16x32_bf16 v[36:39], v[132:135], v[100:103], v[36:39]
ds_read_b64_tr_b16 v[168:169], v184 offset:20480
ds_read_b64_tr_b16 v[170:171], v184 offset:20736
ds_read_b64_tr_b16 v[172:173], v185 offset:20480
v_cvt_pk_bf16_f32 v106, v224, v225
v_cvt_pk_bf16_f32 v107, v226, v227
v_lshlrev_b32 v220, 16, v108
v_and_b32 v221, 0xffff0000, v108
v_lshlrev_b32 v222, 16, v109
v_mfma_f32_16x16x32_bf16 v[24:27], v[136:139], v[96:99], v[24:27]
ds_read_b64_tr_b16 v[174:175], v185 offset:20736
ds_read_b128 v[188:191], v187 offset:1536
v_and_b32 v223, 0xffff0000, v109
v_lshlrev_b32 v224, 16, v110
v_and_b32 v225, 0xffff0000, v110
v_lshlrev_b32 v226, 16, v111
v_mfma_f32_16x16x32_bf16 v[40:43], v[136:139], v[100:103], v[40:43]
ds_read_b128 v[192:195], v187 offset:1552
ds_read_b128 v[196:199], v187 offset:5632
ds_read_b128 v[200:203], v187 offset:5648
v_and_b32 v227, 0xffff0000, v111
v_pk_fma_f32 v[220:221], v[220:221], v[212:213], v[204:205]
v_pk_fma_f32 v[222:223], v[222:223], v[214:215], v[206:207]
v_pk_fma_f32 v[224:225], v[224:225], v[216:217], v[208:209]
v_pk_fma_f32 v[226:227], v[226:227], v[218:219], v[210:211]
v_mfma_f32_16x16x32_bf16 v[28:31], v[140:143], v[96:99], v[28:31]
s_add_u32 m0, s40, 8192
s_nop 0
buffer_load_dwordx4 v178, s[16:19], s38 offen lds
s_add_u32 s38, s38, 131072
v_cvt_pk_bf16_f32 v108, v220, v221
v_cvt_pk_bf16_f32 v109, v222, v223
v_cvt_pk_bf16_f32 v110, v224, v225
v_cvt_pk_bf16_f32 v111, v226, v227
v_mfma_f32_16x16x32_bf16 v[44:47], v[140:143], v[100:103], v[44:47]
s_add_u32 m0, s42, 4096
s_mov_b32 exec_hi, 0
buffer_load_dwordx4 v179, s[20:23], s39 offen lds
s_mov_b32 exec_hi, -1
s_add_u32 s39, s39, 4096
v_mfma_f32_16x16x32_bf16 v[48:51], v[160:163], v[96:99], v[48:51]
buffer_load_dwordx4 v[64:67], v176, s[12:15], s37 offen
v_mfma_f32_16x16x32_bf16 v[52:55], v[164:167], v[96:99], v[52:55]
buffer_load_dwordx4 v[68:71], v177, s[12:15], s37 offen
s_add_u32 s37, s37, 262144
s_waitcnt vmcnt(8) lgkmcnt(0)
s_barrier
v_mfma_f32_16x16x32_bf16 v[16:19], v[144:147], v[104:107], v[16:19]
ds_read_b64_tr_b16 v[128:129], v180 offset:49152
ds_read_b64_tr_b16 v[130:131], v180 offset:49664
ds_read_b64_tr_b16 v[132:133], v181 offset:49152
v_lshlrev_b32 v220, 16, v112
v_and_b32 v221, 0xffff0000, v112
v_lshlrev_b32 v222, 16, v113
v_and_b32 v223, 0xffff0000, v113
v_lshlrev_b32 v224, 16, v114
v_mfma_f32_16x16x32_bf16 v[32:35], v[144:147], v[108:111], v[32:35]
ds_read_b64_tr_b16 v[134:135], v181 offset:49664
ds_read_b64_tr_b16 v[136:137], v182 offset:49152
v_and_b32 v225, 0xffff0000, v114
v_lshlrev_b32 v226, 16, v115
v_and_b32 v227, 0xffff0000, v115
v_pk_fma_f32 v[220:221], v[220:221], v[196:197], v[188:189]
v_pk_fma_f32 v[222:223], v[222:223], v[198:199], v[190:191]
v_mfma_f32_16x16x32_bf16 v[20:23], v[148:151], v[104:107], v[20:23]
ds_read_b64_tr_b16 v[138:139], v182 offset:49664
ds_read_b64_tr_b16 v[140:141], v183 offset:49152
ds_read_b64_tr_b16 v[142:143], v183 offset:49664
v_pk_fma_f32 v[224:225], v[224:225], v[200:201], v[192:193]
v_pk_fma_f32 v[226:227], v[226:227], v[202:203], v[194:195]
v_cvt_pk_bf16_f32 v112, v220, v221
v_cvt_pk_bf16_f32 v113, v222, v223
v_mfma_f32_16x16x32_bf16 v[36:39], v[148:151], v[108:111], v[36:39]
ds_read_b64_tr_b16 v[160:161], v184 offset:24576
ds_read_b64_tr_b16 v[162:163], v184 offset:24832
ds_read_b64_tr_b16 v[164:165], v185 offset:24576
v_cvt_pk_bf16_f32 v114, v224, v225
v_cvt_pk_bf16_f32 v115, v226, v227
v_lshlrev_b32 v220, 16, v116
v_and_b32 v221, 0xffff0000, v116
v_lshlrev_b32 v222, 16, v117
v_mfma_f32_16x16x32_bf16 v[24:27], v[152:155], v[104:107], v[24:27]
ds_read_b64_tr_b16 v[166:167], v185 offset:24832
ds_read_b128 v[204:207], v187 offset:1792
v_and_b32 v223, 0xffff0000, v117
v_lshlrev_b32 v224, 16, v118
v_and_b32 v225, 0xffff0000, v118
v_lshlrev_b32 v226, 16, v119
v_mfma_f32_16x16x32_bf16 v[40:43], v[152:155], v[108:111], v[40:43]
ds_read_b128 v[208:211], v187 offset:1808
ds_read_b128 v[212:215], v187 offset:5888
ds_read_b128 v[216:219], v187 offset:5904
v_and_b32 v227, 0xffff0000, v119
v_pk_fma_f32 v[220:221], v[220:221], v[196:197], v[188:189]
v_pk_fma_f32 v[222:223], v[222:223], v[198:199], v[190:191]
v_pk_fma_f32 v[224:225], v[224:225], v[200:201], v[192:193]
v_pk_fma_f32 v[226:227], v[226:227], v[202:203], v[194:195]
v_mfma_f32_16x16x32_bf16 v[28:31], v[156:159], v[104:107], v[28:31]
s_add_u32 m0, s40, 16384
s_nop 0
buffer_load_dwordx4 v178, s[16:19], s38 offen lds
s_add_u32 s38, s38, 131072
v_cvt_pk_bf16_f32 v116, v220, v221
v_cvt_pk_bf16_f32 v117, v222, v223
v_cvt_pk_bf16_f32 v118, v224, v225
v_cvt_pk_bf16_f32 v119, v226, v227
v_mfma_f32_16x16x32_bf16 v[44:47], v[156:159], v[108:111], v[44:47]
s_add_u32 m0, s42, 8192
s_mov_b32 exec_hi, 0
buffer_load_dwordx4 v179, s[20:23], s39 offen lds
s_mov_b32 exec_hi, -1
s_add_u32 s39, s39, 4096
v_mfma_f32_16x16x32_bf16 v[48:51], v[168:171], v[104:107], v[48:51]
buffer_load_dwordx4 v[72:75], v176, s[12:15], s37 offen
v_mfma_f32_16x16x32_bf16 v[52:55], v[172:175], v[104:107], v[52:55]
buffer_load_dwordx4 v[76:79], v177, s[12:15], s37 offen
s_add_u32 s37, s37, 262144
s_waitcnt vmcnt(8) lgkmcnt(0)
s_barrier
v_mfma_f32_16x16x32_bf16 v[16:19], v[128:131], v[112:115], v[16:19]
ds_read_b64_tr_b16 v[144:145], v180 offset:57344
ds_read_b64_tr_b16 v[146:147], v180 offset:57856
ds_read_b64_tr_b16 v[148:149], v181 offset:57344
v_lshlrev_b32 v220, 16, v120
v_and_b32 v221, 0xffff0000, v120
v_lshlrev_b32 v222, 16, v121
v_and_b32 v223, 0xffff0000, v121
v_lshlrev_b32 v224, 16, v122
v_mfma_f32_16x16x32_bf16 v[32:35], v[128:131], v[116:119], v[32:35]
ds_read_b64_tr_b16 v[150:151], v181 offset:57856
ds_read_b64_tr_b16 v[152:153], v182 offset:57344
v_and_b32 v225, 0xffff0000, v122
v_lshlrev_b32 v226, 16, v123
v_and_b32 v227, 0xffff0000, v123
v_pk_fma_f32 v[220:221], v[220:221], v[212:213], v[204:205]
v_pk_fma_f32 v[222:223], v[222:223], v[214:215], v[206:207]
v_mfma_f32_16x16x32_bf16 v[20:23], v[132:135], v[112:115], v[20:23]
ds_read_b64_tr_b16 v[154:155], v182 offset:57856
ds_read_b64_tr_b16 v[156:157], v183 offset:57344
ds_read_b64_tr_b16 v[158:159], v183 offset:57856
v_pk_fma_f32 v[224:225], v[224:225], v[216:217], v[208:209]
v_pk_fma_f32 v[226:227], v[226:227], v[218:219], v[210:211]
v_cvt_pk_bf16_f32 v120, v220, v221
v_cvt_pk_bf16_f32 v121, v222, v223
v_mfma_f32_16x16x32_bf16 v[36:39], v[132:135], v[116:119], v[36:39]
ds_read_b64_tr_b16 v[168:169], v184 offset:28672
ds_read_b64_tr_b16 v[170:171], v184 offset:28928
ds_read_b64_tr_b16 v[172:173], v185 offset:28672
v_cvt_pk_bf16_f32 v122, v224, v225
v_cvt_pk_bf16_f32 v123, v226, v227
v_lshlrev_b32 v220, 16, v124
v_and_b32 v221, 0xffff0000, v124
v_lshlrev_b32 v222, 16, v125
v_mfma_f32_16x16x32_bf16 v[24:27], v[136:139], v[112:115], v[24:27]
ds_read_b64_tr_b16 v[174:175], v185 offset:28928
ds_read_b128 v[188:191], v187 offset:2048
v_and_b32 v223, 0xffff0000, v125
v_lshlrev_b32 v224, 16, v126
v_and_b32 v225, 0xffff0000, v126
v_lshlrev_b32 v226, 16, v127
v_mfma_f32_16x16x32_bf16 v[40:43], v[136:139], v[116:119], v[40:43]
ds_read_b128 v[192:195], v187 offset:2064
ds_read_b128 v[196:199], v187 offset:6144
ds_read_b128 v[200:203], v187 offset:6160
v_and_b32 v227, 0xffff0000, v127
v_pk_fma_f32 v[220:221], v[220:221], v[212:213], v[204:205]
v_pk_fma_f32 v[222:223], v[222:223], v[214:215], v[206:207]
v_pk_fma_f32 v[224:225], v[224:225], v[216:217], v[208:209]
v_pk_fma_f32 v[226:227], v[226:227], v[218:219], v[210:211]
v_mfma_f32_16x16x32_bf16 v[28:31], v[140:143], v[112:115], v[28:31]
s_add_u32 m0, s40, 24576
s_nop 0
buffer_load_dwordx4 v178, s[16:19], s38 offen lds
s_add_u32 s38, s38, 131072
v_cvt_pk_bf16_f32 v124, v220, v221
v_cvt_pk_bf16_f32 v125, v222, v223
v_cvt_pk_bf16_f32 v126, v224, v225
v_cvt_pk_bf16_f32 v127, v226, v227
v_mfma_f32_16x16x32_bf16 v[44:47], v[140:143], v[116:119], v[44:47]
s_add_u32 m0, s42, 12288
s_mov_b32 exec_hi, 0
buffer_load_dwordx4 v179, s[20:23], s39 offen lds
s_mov_b32 exec_hi, -1
s_add_u32 s39, s39, 4096
v_mfma_f32_16x16x32_bf16 v[48:51], v[160:163], v[112:115], v[48:51]
buffer_load_dwordx4 v[80:83], v176, s[12:15], s37 offen
v_mfma_f32_16x16x32_bf16 v[52:55], v[164:167], v[112:115], v[52:55]
buffer_load_dwordx4 v[84:87], v177, s[12:15], s37 offen
s_add_u32 s37, s37, 262144
s_waitcnt vmcnt(8) lgkmcnt(0)
s_barrier
v_mfma_f32_16x16x32_bf16 v[16:19], v[144:147], v[120:123], v[16:19]
ds_read_b64_tr_b16 v[128:129], v180 offset:0
ds_read_b64_tr_b16 v[130:131], v180 offset:512
ds_read_b64_tr_b16 v[132:133], v181 offset:0
v_lshlrev_b32 v220, 16, v64
v_and_b32 v221, 0xffff0000, v64
v_lshlrev_b32 v222, 16, v65
v_and_b32 v223, 0xffff0000, v65
v_lshlrev_b32 v224, 16, v66
v_mfma_f32_16x16x32_bf16 v[32:35], v[144:147], v[124:127], v[32:35]
ds_read_b64_tr_b16 v[134:135], v181 offset:512
ds_read_b64_tr_b16 v[136:137], v182 offset:0
v_and_b32 v225, 0xffff0000, v66
v_lshlrev_b32 v226, 16, v67
v_and_b32 v227, 0xffff0000, v67
v_pk_fma_f32 v[220:221], v[220:221], v[196:197], v[188:189]
v_pk_fma_f32 v[222:223], v[222:223], v[198:199], v[190:191]
v_mfma_f32_16x16x32_bf16 v[20:23], v[148:151], v[120:123], v[20:23]
ds_read_b64_tr_b16 v[138:139], v182 offset:512
ds_read_b64_tr_b16 v[140:141], v183 offset:0
ds_read_b64_tr_b16 v[142:143], v183 offset:512
v_pk_fma_f32 v[224:225], v[224:225], v[200:201], v[192:193]
v_pk_fma_f32 v[226:227], v[226:227], v[202:203], v[194:195]
v_cvt_pk_bf16_f32 v64, v220, v221
v_cvt_pk_bf16_f32 v65, v222, v223
v_mfma_f32_16x16x32_bf16 v[36:39], v[148:151], v[124:127], v[36:39]
ds_read_b64_tr_b16 v[160:161], v184 offset:0
ds_read_b64_tr_b16 v[162:163], v184 offset:256
ds_read_b64_tr_b16 v[164:165], v185 offset:0
v_cvt_pk_bf16_f32 v66, v224, v225
v_cvt_pk_bf16_f32 v67, v226, v227
v_lshlrev_b32 v220, 16, v68
v_and_b32 v221, 0xffff0000, v68
v_lshlrev_b32 v222, 16, v69
v_mfma_f32_16x16x32_bf16 v[24:27], v[152:155], v[120:123], v[24:27]
ds_read_b64_tr_b16 v[166:167], v185 offset:256
ds_read_b128 v[204:207], v187 offset:2304
v_and_b32 v223, 0xffff0000, v69
v_lshlrev_b32 v224, 16, v70
v_and_b32 v225, 0xffff0000, v70
v_lshlrev_b32 v226, 16, v71
v_mfma_f32_16x16x32_bf16 v[40:43], v[152:155], v[124:127], v[40:43]
ds_read_b128 v[208:211], v187 offset:2320
ds_read_b128 v[212:215], v187 offset:6400
ds_read_b128 v[216:219], v187 offset:6416
v_and_b32 v227, 0xffff0000, v71
v_pk_fma_f32 v[220:221], v[220:221], v[196:197], v[188:189]
v_pk_fma_f32 v[222:223], v[222:223], v[198:199], v[190:191]
v_pk_fma_f32 v[224:225], v[224:225], v[200:201], v[192:193]
v_pk_fma_f32 v[226:227], v[226:227], v[202:203], v[194:195]
v_mfma_f32_16x16x32_bf16 v[28:31], v[156:159], v[120:123], v[28:31]
s_add_u32 m0, s40, 32768
s_nop 0
buffer_load_dwordx4 v178, s[16:19], s38 offen lds
s_add_u32 s38, s38, 131072
v_cvt_pk_bf16_f32 v68, v220, v221
v_cvt_pk_bf16_f32 v69, v222, v223
v_cvt_pk_bf16_f32 v70, v224, v225
v_cvt_pk_bf16_f32 v71, v226, v227
v_mfma_f32_16x16x32_bf16 v[44:47], v[156:159], v[124:127], v[44:47]
s_add_u32 m0, s42, 16384
s_mov_b32 exec_hi, 0
buffer_load_dwordx4 v179, s[20:23], s39 offen lds
s_mov_b32 exec_hi, -1
s_add_u32 s39, s39, 4096
v_mfma_f32_16x16x32_bf16 v[48:51], v[168:171], v[120:123], v[48:51]
buffer_load_dwordx4 v[88:91], v176, s[12:15], s37 offen
v_mfma_f32_16x16x32_bf16 v[52:55], v[172:175], v[120:123], v[52:55]
buffer_load_dwordx4 v[92:95], v177, s[12:15], s37 offen
s_add_u32 s37, s37, 262144
s_waitcnt vmcnt(8) lgkmcnt(0)
s_barrier
v_mfma_f32_16x16x32_bf16 v[16:19], v[128:131], v[64:67], v[16:19]
ds_read_b64_tr_b16 v[144:145], v180 offset:8192
ds_read_b64_tr_b16 v[146:147], v180 offset:8704
ds_read_b64_tr_b16 v[148:149], v181 offset:8192
v_lshlrev_b32 v220, 16, v72
v_and_b32 v221, 0xffff0000, v72
v_lshlrev_b32 v222, 16, v73
v_and_b32 v223, 0xffff0000, v73
v_lshlrev_b32 v224, 16, v74
v_mfma_f32_16x16x32_bf16 v[32:35], v[128:131], v[68:71], v[32:35]
ds_read_b64_tr_b16 v[150:151], v181 offset:8704
ds_read_b64_tr_b16 v[152:153], v182 offset:8192
v_and_b32 v225, 0xffff0000, v74
v_lshlrev_b32 v226, 16, v75
v_and_b32 v227, 0xffff0000, v75
v_pk_fma_f32 v[220:221], v[220:221], v[212:213], v[204:205]
v_pk_fma_f32 v[222:223], v[222:223], v[214:215], v[206:207]
v_mfma_f32_16x16x32_bf16 v[20:23], v[132:135], v[64:67], v[20:23]
ds_read_b64_tr_b16 v[154:155], v182 offset:8704
ds_read_b64_tr_b16 v[156:157], v183 offset:8192
ds_read_b64_tr_b16 v[158:159], v183 offset:8704
v_pk_fma_f32 v[224:225], v[224:225], v[216:217], v[208:209]
v_pk_fma_f32 v[226:227], v[226:227], v[218:219], v[210:211]
v_cvt_pk_bf16_f32 v72, v220, v221
v_cvt_pk_bf16_f32 v73, v222, v223
v_mfma_f32_16x16x32_bf16 v[36:39], v[132:135], v[68:71], v[36:39]
ds_read_b64_tr_b16 v[168:169], v184 offset:4096
ds_read_b64_tr_b16 v[170:171], v184 offset:4352
ds_read_b64_tr_b16 v[172:173], v185 offset:4096
v_cvt_pk_bf16_f32 v74, v224, v225
v_cvt_pk_bf16_f32 v75, v226, v227
v_lshlrev_b32 v220, 16, v76
v_and_b32 v221, 0xffff0000, v76
v_lshlrev_b32 v222, 16, v77
v_mfma_f32_16x16x32_bf16 v[24:27], v[136:139], v[64:67], v[24:27]
ds_read_b64_tr_b16 v[174:175], v185 offset:4352
ds_read_b128 v[188:191], v187 offset:2560
v_and_b32 v223, 0xffff0000, v77
v_lshlrev_b32 v224, 16, v78
v_and_b32 v225, 0xffff0000, v78
v_lshlrev_b32 v226, 16, v79
v_mfma_f32_16x16x32_bf16 v[40:43], v[136:139], v[68:71], v[40:43]
ds_read_b128 v[192:195], v187 offset:2576
ds_read_b128 v[196:199], v187 offset:6656
ds_read_b128 v[200:203], v187 offset:6672
v_and_b32 v227, 0xffff0000, v79
v_pk_fma_f32 v[220:221], v[220:221], v[212:213], v[204:205]
v_pk_fma_f32 v[222:223], v[222:223], v[214:215], v[206:207]
v_pk_fma_f32 v[224:225], v[224:225], v[216:217], v[208:209]
v_pk_fma_f32 v[226:227], v[226:227], v[218:219], v[210:211]
v_mfma_f32_16x16x32_bf16 v[28:31], v[140:143], v[64:67], v[28:31]
s_add_u32 m0, s40, 40960
s_nop 0
buffer_load_dwordx4 v178, s[16:19], s38 offen lds
s_add_u32 s38, s38, 131072
v_cvt_pk_bf16_f32 v76, v220, v221
v_cvt_pk_bf16_f32 v77, v222, v223
v_cvt_pk_bf16_f32 v78, v224, v225
v_cvt_pk_bf16_f32 v79, v226, v227
v_mfma_f32_16x16x32_bf16 v[44:47], v[140:143], v[68:71], v[44:47]
s_add_u32 m0, s42, 20480
s_mov_b32 exec_hi, 0
buffer_load_dwordx4 v179, s[20:23], s39 offen lds
s_mov_b32 exec_hi, -1
s_add_u32 s39, s39, 4096
v_mfma_f32_16x16x32_bf16 v[48:51], v[160:163], v[64:67], v[48:51]
buffer_load_dwordx4 v[96:99], v176, s[12:15], s37 offen
v_mfma_f32_16x16x32_bf16 v[52:55], v[164:167], v[64:67], v[52:55]
buffer_load_dwordx4 v[100:103], v177, s[12:15], s37 offen
s_add_u32 s37, s37, 262144
s_waitcnt vmcnt(8) lgkmcnt(0)
s_barrier
v_mfma_f32_16x16x32_bf16 v[16:19], v[144:147], v[72:75], v[16:19]
ds_read_b64_tr_b16 v[128:129], v180 offset:16384
ds_read_b64_tr_b16 v[130:131], v180 offset:16896
ds_read_b64_tr_b16 v[132:133], v181 offset:16384
v_lshlrev_b32 v220, 16, v80
v_and_b32 v221, 0xffff0000, v80
v_lshlrev_b32 v222, 16, v81
v_and_b32 v223, 0xffff0000, v81
v_lshlrev_b32 v224, 16, v82
v_mfma_f32_16x16x32_bf16 v[32:35], v[144:147], v[76:79], v[32:35]
ds_read_b64_tr_b16 v[134:135], v181 offset:16896
ds_read_b64_tr_b16 v[136:137], v182 offset:16384
v_and_b32 v225, 0xffff0000, v82
v_lshlrev_b32 v226, 16, v83
v_and_b32 v227, 0xffff0000, v83
v_pk_fma_f32 v[220:221], v[220:221], v[196:197], v[188:189]
v_pk_fma_f32 v[222:223], v[222:223], v[198:199], v[190:191]
v_mfma_f32_16x16x32_bf16 v[20:23], v[148:151], v[72:75], v[20:23]
ds_read_b64_tr_b16 v[138:139], v182 offset:16896
ds_read_b64_tr_b16 v[140:141], v183 offset:16384
ds_read_b64_tr_b16 v[142:143], v183 offset:16896
v_pk_fma_f32 v[224:225], v[224:225], v[200:201], v[192:193]
v_pk_fma_f32 v[226:227], v[226:227], v[202:203], v[194:195]
v_cvt_pk_bf16_f32 v80, v220, v221
v_cvt_pk_bf16_f32 v81, v222, v223
v_mfma_f32_16x16x32_bf16 v[36:39], v[148:151], v[76:79], v[36:39]
ds_read_b64_tr_b16 v[160:161], v184 offset:8192
ds_read_b64_tr_b16 v[162:163], v184 offset:8448
ds_read_b64_tr_b16 v[164:165], v185 offset:8192
v_cvt_pk_bf16_f32 v82, v224, v225
v_cvt_pk_bf16_f32 v83, v226, v227
v_lshlrev_b32 v220, 16, v84
v_and_b32 v221, 0xffff0000, v84
v_lshlrev_b32 v222, 16, v85
v_mfma_f32_16x16x32_bf16 v[24:27], v[152:155], v[72:75], v[24:27]
ds_read_b64_tr_b16 v[166:167], v185 offset:8448
ds_read_b128 v[204:207], v187 offset:2816
v_and_b32 v223, 0xffff0000, v85
v_lshlrev_b32 v224, 16, v86
v_and_b32 v225, 0xffff0000, v86
v_lshlrev_b32 v226, 16, v87
v_mfma_f32_16x16x32_bf16 v[40:43], v[152:155], v[76:79], v[40:43]
ds_read_b128 v[208:211], v187 offset:2832
ds_read_b128 v[212:215], v187 offset:6912
ds_read_b128 v[216:219], v187 offset:6928
v_and_b32 v227, 0xffff0000, v87
v_pk_fma_f32 v[220:221], v[220:221], v[196:197], v[188:189]
v_pk_fma_f32 v[222:223], v[222:223], v[198:199], v[190:191]
v_pk_fma_f32 v[224:225], v[224:225], v[200:201], v[192:193]
v_pk_fma_f32 v[226:227], v[226:227], v[202:203], v[194:195]
v_mfma_f32_16x16x32_bf16 v[28:31], v[156:159], v[72:75], v[28:31]
s_add_u32 m0, s40, 49152
s_nop 0
buffer_load_dwordx4 v178, s[16:19], s38 offen lds
s_add_u32 s38, s38, 131072
v_cvt_pk_bf16_f32 v84, v220, v221
v_cvt_pk_bf16_f32 v85, v222, v223
v_cvt_pk_bf16_f32 v86, v224, v225
v_cvt_pk_bf16_f32 v87, v226, v227
v_mfma_f32_16x16x32_bf16 v[44:47], v[156:159], v[76:79], v[44:47]
s_add_u32 m0, s42, 24576
s_mov_b32 exec_hi, 0
buffer_load_dwordx4 v179, s[20:23], s39 offen lds
s_mov_b32 exec_hi, -1
s_add_u32 s39, s39, 4096
v_mfma_f32_16x16x32_bf16 v[48:51], v[168:171], v[72:75], v[48:51]
buffer_load_dwordx4 v[104:107], v176, s[12:15], s37 offen
v_mfma_f32_16x16x32_bf16 v[52:55], v[172:175], v[72:75], v[52:55]
buffer_load_dwordx4 v[108:111], v177, s[12:15], s37 offen
s_add_u32 s37, s37, 262144
s_waitcnt vmcnt(8) lgkmcnt(0)
s_barrier
v_mfma_f32_16x16x32_bf16 v[16:19], v[128:131], v[80:83], v[16:19]
ds_read_b64_tr_b16 v[144:145], v180 offset:24576
ds_read_b64_tr_b16 v[146:147], v180 offset:25088
ds_read_b64_tr_b16 v[148:149], v181 offset:24576
v_lshlrev_b32 v220, 16, v88
v_and_b32 v221, 0xffff0000, v88
v_lshlrev_b32 v222, 16, v89
v_and_b32 v223, 0xffff0000, v89
v_lshlrev_b32 v224, 16, v90
v_mfma_f32_16x16x32_bf16 v[32:35], v[128:131], v[84:87], v[32:35]
ds_read_b64_tr_b16 v[150:151], v181 offset:25088
ds_read_b64_tr_b16 v[152:153], v182 offset:24576
v_and_b32 v225, 0xffff0000, v90
v_lshlrev_b32 v226, 16, v91
v_and_b32 v227, 0xffff0000, v91
v_pk_fma_f32 v[220:221], v[220:221], v[212:213], v[204:205]
v_pk_fma_f32 v[222:223], v[222:223], v[214:215], v[206:207]
v_mfma_f32_16x16x32_bf16 v[20:23], v[132:135], v[80:83], v[20:23]
ds_read_b64_tr_b16 v[154:155], v182 offset:25088
ds_read_b64_tr_b16 v[156:157], v183 offset:24576
ds_read_b64_tr_b16 v[158:159], v183 offset:25088
v_pk_fma_f32 v[224:225], v[224:225], v[216:217], v[208:209]
v_pk_fma_f32 v[226:227], v[226:227], v[218:219], v[210:211]
v_cvt_pk_bf16_f32 v88, v220, v221
v_cvt_pk_bf16_f32 v89, v222, v223
v_mfma_f32_16x16x32_bf16 v[36:39], v[132:135], v[84:87], v[36:39]
ds_read_b64_tr_b16 v[168:169], v184 offset:12288
ds_read_b64_tr_b16 v[170:171], v184 offset:12544
ds_read_b64_tr_b16 v[172:173], v185 offset:12288
v_cvt_pk_bf16_f32 v90, v224, v225
v_cvt_pk_bf16_f32 v91, v226, v227
v_lshlrev_b32 v220, 16, v92
v_and_b32 v221, 0xffff0000, v92
v_lshlrev_b32 v222, 16, v93
v_mfma_f32_16x16x32_bf16 v[24:27], v[136:139], v[80:83], v[24:27]
ds_read_b64_tr_b16 v[174:175], v185 offset:12544
ds_read_b128 v[188:191], v187 offset:3072
v_and_b32 v223, 0xffff0000, v93
v_lshlrev_b32 v224, 16, v94
v_and_b32 v225, 0xffff0000, v94
v_lshlrev_b32 v226, 16, v95
v_mfma_f32_16x16x32_bf16 v[40:43], v[136:139], v[84:87], v[40:43]
ds_read_b128 v[192:195], v187 offset:3088
ds_read_b128 v[196:199], v187 offset:7168
ds_read_b128 v[200:203], v187 offset:7184
v_and_b32 v227, 0xffff0000, v95
v_pk_fma_f32 v[220:221], v[220:221], v[212:213], v[204:205]
v_pk_fma_f32 v[222:223], v[222:223], v[214:215], v[206:207]
v_pk_fma_f32 v[224:225], v[224:225], v[216:217], v[208:209]
v_pk_fma_f32 v[226:227], v[226:227], v[218:219], v[210:211]
v_mfma_f32_16x16x32_bf16 v[28:31], v[140:143], v[80:83], v[28:31]
s_add_u32 m0, s40, 57344
s_nop 0
buffer_load_dwordx4 v178, s[16:19], s38 offen lds
s_add_u32 s38, s38, 131072
v_cvt_pk_bf16_f32 v92, v220, v221
v_cvt_pk_bf16_f32 v93, v222, v223
v_cvt_pk_bf16_f32 v94, v224, v225
v_cvt_pk_bf16_f32 v95, v226, v227
v_mfma_f32_16x16x32_bf16 v[44:47], v[140:143], v[84:87], v[44:47]
s_add_u32 m0, s42, 28672
s_mov_b32 exec_hi, 0
buffer_load_dwordx4 v179, s[20:23], s39 offen lds
s_mov_b32 exec_hi, -1
s_add_u32 s39, s39, 4096
v_mfma_f32_16x16x32_bf16 v[48:51], v[160:163], v[80:83], v[48:51]
buffer_load_dwordx4 v[112:115], v176, s[12:15], s37 offen
v_mfma_f32_16x16x32_bf16 v[52:55], v[164:167], v[80:83], v[52:55]
buffer_load_dwordx4 v[116:119], v177, s[12:15], s37 offen
s_add_u32 s37, s37, 262144
s_waitcnt vmcnt(8) lgkmcnt(0)
s_barrier
v_mfma_f32_16x16x32_bf16 v[16:19], v[144:147], v[88:91], v[16:19]
ds_read_b64_tr_b16 v[128:129], v180 offset:32768
ds_read_b64_tr_b16 v[130:131], v180 offset:33280
ds_read_b64_tr_b16 v[132:133], v181 offset:32768
v_lshlrev_b32 v220, 16, v96
v_and_b32 v221, 0xffff0000, v96
v_lshlrev_b32 v222, 16, v97
v_and_b32 v223, 0xffff0000, v97
v_lshlrev_b32 v224, 16, v98
v_mfma_f32_16x16x32_bf16 v[32:35], v[144:147], v[92:95], v[32:35]
ds_read_b64_tr_b16 v[134:135], v181 offset:33280
ds_read_b64_tr_b16 v[136:137], v182 offset:32768
v_and_b32 v225, 0xffff0000, v98
v_lshlrev_b32 v226, 16, v99
v_and_b32 v227, 0xffff0000, v99
v_pk_fma_f32 v[220:221], v[220:221], v[196:197], v[188:189]
v_pk_fma_f32 v[222:223], v[222:223], v[198:199], v[190:191]
v_mfma_f32_16x16x32_bf16 v[20:23], v[148:151], v[88:91], v[20:23]
ds_read_b64_tr_b16 v[138:139], v182 offset:33280
ds_read_b64_tr_b16 v[140:141], v183 offset:32768
ds_read_b64_tr_b16 v[142:143], v183 offset:33280
v_pk_fma_f32 v[224:225], v[224:225], v[200:201], v[192:193]
v_pk_fma_f32 v[226:227], v[226:227], v[202:203], v[194:195]
v_cvt_pk_bf16_f32 v96, v220, v221
v_cvt_pk_bf16_f32 v97, v222, v223
v_mfma_f32_16x16x32_bf16 v[36:39], v[148:151], v[92:95], v[36:39]
ds_read_b64_tr_b16 v[160:161], v184 offset:16384
ds_read_b64_tr_b16 v[162:163], v184 offset:16640
ds_read_b64_tr_b16 v[164:165], v185 offset:16384
v_cvt_pk_bf16_f32 v98, v224, v225
v_cvt_pk_bf16_f32 v99, v226, v227
v_lshlrev_b32 v220, 16, v100
v_and_b32 v221, 0xffff0000, v100
v_lshlrev_b32 v222, 16, v101
v_mfma_f32_16x16x32_bf16 v[24:27], v[152:155], v[88:91], v[24:27]
ds_read_b64_tr_b16 v[166:167], v185 offset:16640
ds_read_b128 v[204:207], v187 offset:3328
v_and_b32 v223, 0xffff0000, v101
v_lshlrev_b32 v224, 16, v102
v_and_b32 v225, 0xffff0000, v102
v_lshlrev_b32 v226, 16, v103
v_mfma_f32_16x16x32_bf16 v[40:43], v[152:155], v[92:95], v[40:43]
ds_read_b128 v[208:211], v187 offset:3344
ds_read_b128 v[212:215], v187 offset:7424
ds_read_b128 v[216:219], v187 offset:7440
v_and_b32 v227, 0xffff0000, v103
v_pk_fma_f32 v[220:221], v[220:221], v[196:197], v[188:189]
v_pk_fma_f32 v[222:223], v[222:223], v[198:199], v[190:191]
v_pk_fma_f32 v[224:225], v[224:225], v[200:201], v[192:193]
v_pk_fma_f32 v[226:227], v[226:227], v[202:203], v[194:195]
v_mfma_f32_16x16x32_bf16 v[28:31], v[156:159], v[88:91], v[28:31]
v_cvt_pk_bf16_f32 v100, v220, v221
v_cvt_pk_bf16_f32 v101, v222, v223
v_cvt_pk_bf16_f32 v102, v224, v225
v_cvt_pk_bf16_f32 v103, v226, v227
v_mfma_f32_16x16x32_bf16 v[44:47], v[156:159], v[92:95], v[44:47]
v_mfma_f32_16x16x32_bf16 v[48:51], v[168:171], v[88:91], v[48:51]
buffer_load_dwordx4 v[120:123], v176, s[12:15], s37 offen
v_mfma_f32_16x16x32_bf16 v[52:55], v[172:175], v[88:91], v[52:55]
buffer_load_dwordx4 v[124:127], v177, s[12:15], s37 offen
s_add_u32 s37, s37, 262144
s_waitcnt vmcnt(6) lgkmcnt(0)
s_barrier
v_mfma_f32_16x16x32_bf16 v[16:19], v[128:131], v[96:99], v[16:19]
ds_read_b64_tr_b16 v[144:145], v180 offset:40960
ds_read_b64_tr_b16 v[146:147], v180 offset:41472
ds_read_b64_tr_b16 v[148:149], v181 offset:40960
v_lshlrev_b32 v220, 16, v104
v_and_b32 v221, 0xffff0000, v104
v_lshlrev_b32 v222, 16, v105
v_and_b32 v223, 0xffff0000, v105
v_lshlrev_b32 v224, 16, v106
v_mfma_f32_16x16x32_bf16 v[32:35], v[128:131], v[100:103], v[32:35]
ds_read_b64_tr_b16 v[150:151], v181 offset:41472
ds_read_b64_tr_b16 v[152:153], v182 offset:40960
v_and_b32 v225, 0xffff0000, v106
v_lshlrev_b32 v226, 16, v107
v_and_b32 v227, 0xffff0000, v107
v_pk_fma_f32 v[220:221], v[220:221], v[212:213], v[204:205]
v_pk_fma_f32 v[222:223], v[222:223], v[214:215], v[206:207]
v_mfma_f32_16x16x32_bf16 v[20:23], v[132:135], v[96:99], v[20:23]
ds_read_b64_tr_b16 v[154:155], v182 offset:41472
ds_read_b64_tr_b16 v[156:157], v183 offset:40960
ds_read_b64_tr_b16 v[158:159], v183 offset:41472
v_pk_fma_f32 v[224:225], v[224:225], v[216:217], v[208:209]
v_pk_fma_f32 v[226:227], v[226:227], v[218:219], v[210:211]
v_cvt_pk_bf16_f32 v104, v220, v221
v_cvt_pk_bf16_f32 v105, v222, v223
v_mfma_f32_16x16x32_bf16 v[36:39], v[132:135], v[100:103], v[36:39]
ds_read_b64_tr_b16 v[168:169], v184 offset:20480
ds_read_b64_tr_b16 v[170:171], v184 offset:20736
ds_read_b64_tr_b16 v[172:173], v185 offset:20480
v_cvt_pk_bf16_f32 v106, v224, v225
v_cvt_pk_bf16_f32 v107, v226, v227
v_lshlrev_b32 v220, 16, v108
v_and_b32 v221, 0xffff0000, v108
v_lshlrev_b32 v222, 16, v109
v_mfma_f32_16x16x32_bf16 v[24:27], v[136:139], v[96:99], v[24:27]
ds_read_b64_tr_b16 v[174:175], v185 offset:20736
ds_read_b128 v[188:191], v187 offset:3584
v_and_b32 v223, 0xffff0000, v109
v_lshlrev_b32 v224, 16, v110
v_and_b32 v225, 0xffff0000, v110
v_lshlrev_b32 v226, 16, v111
v_mfma_f32_16x16x32_bf16 v[40:43], v[136:139], v[100:103], v[40:43]
ds_read_b128 v[192:195], v187 offset:3600
ds_read_b128 v[196:199], v187 offset:7680
ds_read_b128 v[200:203], v187 offset:7696
v_and_b32 v227, 0xffff0000, v111
v_pk_fma_f32 v[220:221], v[220:221], v[212:213], v[204:205]
v_pk_fma_f32 v[222:223], v[222:223], v[214:215], v[206:207]
v_pk_fma_f32 v[224:225], v[224:225], v[216:217], v[208:209]
v_pk_fma_f32 v[226:227], v[226:227], v[218:219], v[210:211]
v_mfma_f32_16x16x32_bf16 v[28:31], v[140:143], v[96:99], v[28:31]
v_cvt_pk_bf16_f32 v108, v220, v221
v_cvt_pk_bf16_f32 v109, v222, v223
v_cvt_pk_bf16_f32 v110, v224, v225
v_cvt_pk_bf16_f32 v111, v226, v227
v_mfma_f32_16x16x32_bf16 v[44:47], v[140:143], v[100:103], v[44:47]
v_mfma_f32_16x16x32_bf16 v[48:51], v[160:163], v[96:99], v[48:51]
s_mov_b32 s28, s58
s_and_b32 s29, s59, 0xffff
s_mov_b32 s30, 12582912
s_mov_b32 s31, 0x00020000
s_lshl_b32 s3, s2, 2
s_lshr_b32 s10, s32, 1
s_add_u32 s3, s3, s10
s_mul_i32 s3, s3, 12288
s_and_b32 s10, s32, 1
s_mul_i32 s10, s10, 6144
s_add_u32 s3, s3, s10
s_add_u32 s57, s3, 4096
v_lshlrev_b32 v10, 4, v186
s_mov_b32 m0, 106496
s_nop 0
buffer_load_dwordx4 v10, s[28:31], s57 offen lds
v_mfma_f32_16x16x32_bf16 v[52:55], v[164:167], v[96:99], v[52:55]
s_add_u32 s57, s57, 1024
s_mov_b32 m0, 106496
s_nop 0
buffer_load_dwordx4 v10, s[28:31], s57 offen lds
s_waitcnt vmcnt(4) lgkmcnt(0)
s_barrier
v_mfma_f32_16x16x32_bf16 v[16:19], v[144:147], v[104:107], v[16:19]
ds_read_b64_tr_b16 v[128:129], v180 offset:49152
ds_read_b64_tr_b16 v[130:131], v180 offset:49664
ds_read_b64_tr_b16 v[132:133], v181 offset:49152
v_lshlrev_b32 v220, 16, v112
v_and_b32 v221, 0xffff0000, v112
v_lshlrev_b32 v222, 16, v113
v_and_b32 v223, 0xffff0000, v113
v_lshlrev_b32 v224, 16, v114
v_mfma_f32_16x16x32_bf16 v[32:35], v[144:147], v[108:111], v[32:35]
ds_read_b64_tr_b16 v[134:135], v181 offset:49664
ds_read_b64_tr_b16 v[136:137], v182 offset:49152
v_and_b32 v225, 0xffff0000, v114
v_lshlrev_b32 v226, 16, v115
v_and_b32 v227, 0xffff0000, v115
v_pk_fma_f32 v[220:221], v[220:221], v[196:197], v[188:189]
v_pk_fma_f32 v[222:223], v[222:223], v[198:199], v[190:191]
v_mfma_f32_16x16x32_bf16 v[20:23], v[148:151], v[104:107], v[20:23]
ds_read_b64_tr_b16 v[138:139], v182 offset:49664
ds_read_b64_tr_b16 v[140:141], v183 offset:49152
ds_read_b64_tr_b16 v[142:143], v183 offset:49664
v_pk_fma_f32 v[224:225], v[224:225], v[200:201], v[192:193]
v_pk_fma_f32 v[226:227], v[226:227], v[202:203], v[194:195]
v_cvt_pk_bf16_f32 v112, v220, v221
v_cvt_pk_bf16_f32 v113, v222, v223
v_mfma_f32_16x16x32_bf16 v[36:39], v[148:151], v[108:111], v[36:39]
ds_read_b64_tr_b16 v[160:161], v184 offset:24576
ds_read_b64_tr_b16 v[162:163], v184 offset:24832
ds_read_b64_tr_b16 v[164:165], v185 offset:24576
v_cvt_pk_bf16_f32 v114, v224, v225
v_cvt_pk_bf16_f32 v115, v226, v227
v_lshlrev_b32 v220, 16, v116
v_and_b32 v221, 0xffff0000, v116
v_lshlrev_b32 v222, 16, v117
v_mfma_f32_16x16x32_bf16 v[24:27], v[152:155], v[104:107], v[24:27]
ds_read_b64_tr_b16 v[166:167], v185 offset:24832
ds_read_b128 v[204:207], v187 offset:3840
v_and_b32 v223, 0xffff0000, v117
v_lshlrev_b32 v224, 16, v118
v_and_b32 v225, 0xffff0000, v118
v_lshlrev_b32 v226, 16, v119
v_mfma_f32_16x16x32_bf16 v[40:43], v[152:155], v[108:111], v[40:43]
ds_read_b128 v[208:211], v187 offset:3856
ds_read_b128 v[212:215], v187 offset:7936
ds_read_b128 v[216:219], v187 offset:7952
v_and_b32 v227, 0xffff0000, v119
v_pk_fma_f32 v[220:221], v[220:221], v[196:197], v[188:189]
v_pk_fma_f32 v[222:223], v[222:223], v[198:199], v[190:191]
v_pk_fma_f32 v[224:225], v[224:225], v[200:201], v[192:193]
v_pk_fma_f32 v[226:227], v[226:227], v[202:203], v[194:195]
v_mfma_f32_16x16x32_bf16 v[28:31], v[156:159], v[104:107], v[28:31]
v_cvt_pk_bf16_f32 v116, v220, v221
v_cvt_pk_bf16_f32 v117, v222, v223
v_cvt_pk_bf16_f32 v118, v224, v225
v_cvt_pk_bf16_f32 v119, v226, v227
v_mfma_f32_16x16x32_bf16 v[44:47], v[156:159], v[108:111], v[44:47]
v_mfma_f32_16x16x32_bf16 v[48:51], v[168:171], v[104:107], v[48:51]
v_mfma_f32_16x16x32_bf16 v[52:55], v[172:175], v[104:107], v[52:55]
s_waitcnt vmcnt(2) lgkmcnt(0)
s_barrier
v_mfma_f32_16x16x32_bf16 v[16:19], v[128:131], v[112:115], v[16:19]
ds_read_b64_tr_b16 v[144:145], v180 offset:57344
ds_read_b64_tr_b16 v[146:147], v180 offset:57856
v_lshlrev_b32 v220, 16, v120
v_and_b32 v221, 0xffff0000, v120
v_lshlrev_b32 v222, 16, v121
v_and_b32 v223, 0xffff0000, v121
v_lshlrev_b32 v224, 16, v122
v_mfma_f32_16x16x32_bf16 v[32:35], v[128:131], v[116:119], v[32:35]
ds_read_b64_tr_b16 v[148:149], v181 offset:57344
ds_read_b64_tr_b16 v[150:151], v181 offset:57856
v_and_b32 v225, 0xffff0000, v122
v_lshlrev_b32 v226, 16, v123
v_and_b32 v227, 0xffff0000, v123
v_pk_fma_f32 v[220:221], v[220:221], v[212:213], v[204:205]
v_pk_fma_f32 v[222:223], v[222:223], v[214:215], v[206:207]
v_mfma_f32_16x16x32_bf16 v[20:23], v[132:135], v[112:115], v[20:23]
ds_read_b64_tr_b16 v[152:153], v182 offset:57344
ds_read_b64_tr_b16 v[154:155], v182 offset:57856
v_pk_fma_f32 v[224:225], v[224:225], v[216:217], v[208:209]
v_pk_fma_f32 v[226:227], v[226:227], v[218:219], v[210:211]
v_cvt_pk_bf16_f32 v120, v220, v221
v_cvt_pk_bf16_f32 v121, v222, v223
v_mfma_f32_16x16x32_bf16 v[36:39], v[132:135], v[116:119], v[36:39]
ds_read_b64_tr_b16 v[156:157], v183 offset:57344
ds_read_b64_tr_b16 v[158:159], v183 offset:57856
v_cvt_pk_bf16_f32 v122, v224, v225
v_cvt_pk_bf16_f32 v123, v226, v227
v_lshlrev_b32 v220, 16, v124
v_and_b32 v221, 0xffff0000, v124
v_lshlrev_b32 v222, 16, v125
v_mfma_f32_16x16x32_bf16 v[24:27], v[136:139], v[112:115], v[24:27]
ds_read_b64_tr_b16 v[168:169], v184 offset:28672
ds_read_b64_tr_b16 v[170:171], v184 offset:28928
v_and_b32 v223, 0xffff0000, v125
v_lshlrev_b32 v224, 16, v126
v_and_b32 v225, 0xffff0000, v126
v_lshlrev_b32 v226, 16, v127
v_mfma_f32_16x16x32_bf16 v[40:43], v[136:139], v[116:119], v[40:43]
ds_read_b64_tr_b16 v[172:173], v185 offset:28672
ds_read_b64_tr_b16 v[174:175], v185 offset:28928
v_and_b32 v227, 0xffff0000, v127
v_pk_fma_f32 v[220:221], v[220:221], v[212:213], v[204:205]
v_pk_fma_f32 v[222:223], v[222:223], v[214:215], v[206:207]
v_pk_fma_f32 v[224:225], v[224:225], v[216:217], v[208:209]
v_pk_fma_f32 v[226:227], v[226:227], v[218:219], v[210:211]
v_mfma_f32_16x16x32_bf16 v[28:31], v[140:143], v[112:115], v[28:31]
v_cvt_pk_bf16_f32 v124, v220, v221
v_cvt_pk_bf16_f32 v125, v222, v223
v_cvt_pk_bf16_f32 v126, v224, v225
v_cvt_pk_bf16_f32 v127, v226, v227
v_mfma_f32_16x16x32_bf16 v[44:47], v[140:143], v[116:119], v[44:47]
v_mfma_f32_16x16x32_bf16 v[48:51], v[160:163], v[112:115], v[48:51]
v_mfma_f32_16x16x32_bf16 v[52:55], v[164:167], v[112:115], v[52:55]
s_waitcnt vmcnt(2) lgkmcnt(0)
s_barrier
v_mfma_f32_16x16x32_bf16 v[16:19], v[144:147], v[120:123], v[16:19]
v_mfma_f32_16x16x32_bf16 v[32:35], v[144:147], v[124:127], v[32:35]
v_mfma_f32_16x16x32_bf16 v[20:23], v[148:151], v[120:123], v[20:23]
v_mfma_f32_16x16x32_bf16 v[36:39], v[148:151], v[124:127], v[36:39]
v_mfma_f32_16x16x32_bf16 v[24:27], v[152:155], v[120:123], v[24:27]
v_mfma_f32_16x16x32_bf16 v[40:43], v[152:155], v[124:127], v[40:43]
v_mfma_f32_16x16x32_bf16 v[28:31], v[156:159], v[120:123], v[28:31]
v_mfma_f32_16x16x32_bf16 v[44:47], v[156:159], v[124:127], v[44:47]
v_mfma_f32_16x16x32_bf16 v[48:51], v[168:171], v[120:123], v[48:51]
v_mfma_f32_16x16x32_bf16 v[52:55], v[172:175], v[120:123], v[52:55]
k2_kernel_ordend:
v_lshlrev_b32 v5, 4, v186
s_lshl_b32 s3, s34, 1
s_add_u32 s10, s3, s33
s_lshl_b32 s10, s10, 12
s_xor_b32 s11, s10, 4096
v_add_u32 v6, s11, v5
v_add_u32 v7, s10, v5
v_and_b32 v2, 15, v186
v_lshrrev_b32 v3, 4, v186
s_nop 1
s_cmp_eq_u32 s33, 0
s_cbranch_scc0 k2_kernel_e1
ds_write_b128 v6, v[32:35] offset:0
ds_write_b128 v6, v[36:39] offset:1024
ds_write_b128 v6, v[40:43] offset:2048
ds_write_b128 v6, v[44:47] offset:3072
s_branch k2_kernel_e2
k2_kernel_e1:
ds_write_b128 v6, v[16:19] offset:0
ds_write_b128 v6, v[20:23] offset:1024
ds_write_b128 v6, v[24:27] offset:2048
ds_write_b128 v6, v[28:31] offset:3072
s_lshl_b32 s3, s34, 11
s_add_u32 s3, s3, 32768
v_add_u32 v8, s3, v5
ds_write_b128 v8, v[48:51] offset:0
ds_write_b128 v8, v[52:55] offset:1024
k2_kernel_e2:
s_waitcnt lgkmcnt(0)
s_barrier
ds_read_b128 v[128:131], v7 offset:0
ds_read_b128 v[132:135], v7 offset:1024
ds_read_b128 v[136:139], v7 offset:2048
ds_read_b128 v[140:143], v7 offset:3072
s_lshl_b32 s3, s34, 11
s_add_u32 s3, s3, 32768
v_add_u32 v8, s3, v5
ds_read_b128 v[144:147], v8 offset:0
ds_read_b128 v[148:151], v8 offset:1024
s_waitcnt lgkmcnt(0)
s_cmp_eq_u32 s33, 0
s_cbranch_scc0 k2_kernel_e3
v_add_f32 v128, v128, v16
v_add_f32 v129, v129, v17
v_add_f32 v130, v130, v18
v_add_f32 v131, v131, v19
v_add_f32 v132, v132, v20
v_add_f32 v133, v133, v21
v_add_f32 v134, v134, v22
v_add_f32 v135, v135, v23
v_add_f32 v136, v136, v24
v_add_f32 v137, v137, v25
v_add_f32 v138, v138, v26
v_add_f32 v139, v139, v27
v_add_f32 v140, v140, v28
v_add_f32 v141, v141, v29
v_add_f32 v142, v142, v30
v_add_f32 v143, v143, v31
s_branch k2_kernel_e4
k2_kernel_e3:
v_add_f32 v128, v128, v32
v_add_f32 v129, v129, v33
v_add_f32 v130, v130, v34
v_add_f32 v131, v131, v35
v_add_f32 v132, v132, v36
v_add_f32 v133, v133, v37
v_add_f32 v134, v134, v38
v_add_f32 v135, v135, v39
v_add_f32 v136, v136, v40
v_add_f32 v137, v137, v41
v_add_f32 v138, v138, v42
v_add_f32 v139, v139, v43
v_add_f32 v140, v140, v44
v_add_f32 v141, v141, v45
v_add_f32 v142, v142, v46
v_add_f32 v143, v143, v47
k2_kernel_e4:
s_mov_b32 s3, 0x3e8293ee
v_mul_f32 v128, s3, v128
v_mul_f32 v129, s3, v129
v_mul_f32 v130, s3, v130
v_mul_f32 v131, s3, v131
v_mul_f32 v132, s3, v132
v_mul_f32 v133, s3, v133
v_mul_f32 v134, s3, v134
v_mul_f32 v135, s3, v135
v_mul_f32 v136, s3, v136
v_mul_f32 v137, s3, v137
v_mul_f32 v138, s3, v138
v_mul_f32 v139, s3, v139
v_mul_f32 v140, s3, v140
v_mul_f32 v141, s3, v141
v_mul_f32 v142, s3, v142
v_mul_f32 v143, s3, v143
v_add_u32 v4, s55, v2
v_lshrrev_b32 v5, 5, v4
v_lshlrev_b32 v5, 11, v5
v_and_b32 v6, 31, v4
v_and_b32 v7, 1, v3
v_lshl_or_b32 v6, v7, 5, v6
v_lshl_add_u32 v5, v6, 4, v5
v_lshrrev_b32 v7, 1, v3
v_lshl_add_u32 v5, v7, 10, v5
s_lshl_b32 s3, s36, 18
s_add_u32 s3, s3, 8388608
s_add_u32 s10, s3, 131072
v_cvt_pk_bf16_f32 v8, v128, v129
v_cvt_pk_bf16_f32 v9, v130, v131
v_cvt_pk_bf16_f32 v10, v132, v133
v_cvt_pk_bf16_f32 v11, v134, v135
buffer_store_dwordx4 v[8:11], v5, s[24:27], s3 offen sc1
v_cvt_pk_bf16_f32 v12, v136, v137
v_cvt_pk_bf16_f32 v13, v138, v139
v_cvt_pk_bf16_f32 v14, v140, v141
v_cvt_pk_bf16_f32 v15, v142, v143
buffer_store_dwordx4 v[12:15], v5, s[24:27], s10 offen sc1
s_lshr_b32 s3, s36, 2
s_cmp_eq_u32 s3, s34
s_cbranch_scc0 k2_kernel_fin
s_cmp_eq_u32 s33, 0
s_cbranch_scc0 k2_kernel_fin
v_add_f32 v144, v144, v48
v_add_f32 v145, v145, v49
v_add_f32 v146, v146, v50
v_add_f32 v147, v147, v51
v_add_f32 v148, v148, v52
v_add_f32 v149, v149, v53
v_add_f32 v150, v150, v54
v_add_f32 v151, v151, v55
v_cvt_pk_bf16_f32 v16, v144, v145
v_cvt_pk_bf16_f32 v17, v146, v147
v_cvt_pk_bf16_f32 v18, v148, v149
v_cvt_pk_bf16_f32 v19, v150, v151
s_lshr_b32 s3, s36, 1
s_lshl_b32 s3, s3, 4
s_lshl_b32 s10, s35, 7
s_add_u32 s3, s3, s10
v_add_u32 v4, s3, v2
s_cmp_eq_u32 s56, 1
s_cbranch_scc1 k2_kernel_vst
v_lshrrev_b32 v5, 5, v4
v_lshlrev_b32 v5, 11, v5
v_and_b32 v6, 31, v4
v_and_b32 v7, 1, v3
v_lshl_or_b32 v6, v7, 5, v6
v_lshl_add_u32 v5, v6, 4, v5
v_lshrrev_b32 v7, 1, v3
v_lshl_add_u32 v5, v7, 10, v5
s_mov_b32 s3, 1048576
buffer_store_dwordx4 v[16:19], v5, s[24:27], s3 offen sc1
v_mov_b32 v20, 0
v_lshlrev_b32 v21, 16, v16
v_and_b32 v22, 0xffff0000, v16
v_fmac_f32 v20, v21, v21
v_fmac_f32 v20, v22, v22
v_lshlrev_b32 v21, 16, v17
v_and_b32 v22, 0xffff0000, v17
v_fmac_f32 v20, v21, v21
v_fmac_f32 v20, v22, v22
v_lshlrev_b32 v21, 16, v18
v_and_b32 v22, 0xffff0000, v18
v_fmac_f32 v20, v21, v21
v_fmac_f32 v20, v22, v22
v_lshlrev_b32 v21, 16, v19
v_and_b32 v22, 0xffff0000, v19
v_fmac_f32 v20, v21, v21
v_fmac_f32 v20, v22, v22
v_mov_b32 v21, v20
s_nop 1
v_permlane16_swap_b32 v20, v21
s_nop 1
v_add_f32 v20, v20, v21
v_mov_b32 v21, v20
s_nop 1
v_permlane32_swap_b32 v20, v21
s_nop 1
v_add_f32 v20, v20, v21
s_nop 1
v_max_f32_dpp v20, v20, v20 row_ror:8 row_mask:0xf bank_mask:0xf
s_nop 1
v_max_f32_dpp v20, v20, v20 row_ror:4 row_mask:0xf bank_mask:0xf
s_nop 1
v_max_f32_dpp v20, v20, v20 row_ror:2 row_mask:0xf bank_mask:0xf
s_nop 1
v_max_f32_dpp v20, v20, v20 row_ror:1 row_mask:0xf bank_mask:0xf
s_nop 1
s_lshl_b32 s3, s35, 3
s_lshr_b32 s10, s36, 1
s_add_u32 s3, s3, s10
s_lshl_b32 s3, s3, 2
s_add_u32 s3, s3, 65536
v_mov_b32 v21, 0
buffer_store_dword v20, v21, s[24:27], s3 offen
s_branch k2_kernel_fin
k2_kernel_vst:
v_lshlrev_b32 v5, 6, v4
v_lshl_add_u32 v5, v3, 4, v5
s_mov_b32 s3, 1310720
buffer_store_dwordx4 v[16:19], v5, s[24:27], s3 offen sc1
k2_kernel_fin:
k2_kernel_end:
s_endpgm
.section .rodata,"a"
.p2align 6
.amdhsa_kernel k2_kernel
  .amdhsa_next_free_vgpr 232
  .amdhsa_next_free_sgpr 102
  .amdhsa_accum_offset 232
  .amdhsa_group_segment_fixed_size 0
  .amdhsa_kernarg_size 112
  .amdhsa_user_sgpr_count 2
  .amdhsa_user_sgpr_kernarg_segment_ptr 1
  .amdhsa_system_sgpr_workgroup_id_x 1
.end_amdhsa_kernel
.text
.globl k3_kernel
.p2align 8
.type k3_kernel,@function
k3_kernel:
s_cmp_ge_u32 s2, 256
s_cbranch_scc1 k3_kernel_end
s_load_dwordx2 s[8:9], s[0:1], 104
s_load_dwordx4 s[4:7], s[0:1], 48
s_load_dwordx2 s[28:29], s[0:1], 80
v_lshrrev_b32 v1, 6, v0
v_and_b32 v139, 63, v0
v_readfirstlane_b32 s32, v1
s_lshr_b32 s33, s2, 3
s_and_b32 s34, s2, 7
s_lshl_b32 s34, s34, 3
s_add_u32 s34, s34, s32
v_lshlrev_b32 v136, 4, v139
s_lshl_b32 s3, s32, 10
v_add_u32 v138, s3, v136
s_lshl_b32 s40, s32, 10
v_lshrrev_b32 v2, 5, v139
v_bfe_u32 v3, v139, 2, 2
v_lshl_add_u32 v3, v2, 2, v3
v_lshlrev_b32 v3, 6, v3
v_bfe_u32 v4, v139, 4, 1
v_lshl_add_u32 v3, v4, 5, v3
v_and_b32 v4, 3, v139
v_lshl_add_u32 v3, v4, 3, v3
v_add_u32 v137, 8192, v3
v_and_b32 v4, 3, v139
v_bfe_u32 v5, v139, 2, 1
v_bfe_u32 v6, v139, 4, 1
v_xor_b32 v5, v5, v6
v_or_b32 v4, v4, v5
v_cmp_eq_u32 vcc, 0, v4
v_mov_b32 v5, 0x3f803f80
s_nop 0
v_cndmask_b32 v84, 0, v5, vcc
v_mov_b32 v85, v84
v_mov_b32 v86, v84
v_mov_b32 v87, v84
s_waitcnt lgkmcnt(0)
s_cmp_eq_u32 s32, 8
s_cbranch_scc1 k3_kernel_svc
s_add_u32 s12, s8, 1048576
s_addc_u32 s13, s9, 0
s_and_b32 s13, s13, 0xffff
s_mov_b32 s14, 131072
s_mov_b32 s15, 0x00020000
s_add_u32 s16, s8, 1310720
s_addc_u32 s17, s9, 0
s_and_b32 s17, s17, 0xffff
s_mov_b32 s18, 131072
s_mov_b32 s19, 0x00020000
s_mov_b32 s24, s8
s_and_b32 s25, s9, 0xffff
s_mov_b32 s26, 67108864
s_mov_b32 s27, 0x00020000
s_lshl_b32 s3, s33, 17
s_lshl_b32 s10, s34, 11
s_add_u32 s3, s3, s10
s_add_u32 s3, s3, 8388608
buffer_load_dwordx4 v[8:11], v136, s[24:27], s3 offen
buffer_load_dwordx4 v[12:15], v136, s[24:27], s3 offen offset:1024
v_lshlrev_b32 v4, 3, v139
s_mov_b32 s3, 65536
buffer_load_dwordx2 v[6:7], v4, s[24:27], s3 offen
s_mov_b32 s37, 0
s_add_u32 m0, s40, 0
s_nop 0
buffer_load_dwordx4 v138, s[12:15], s37 offen lds
s_add_u32 m0, s40, 8192
s_nop 0
buffer_load_dwordx4 v138, s[16:19], s37 offen lds
s_add_u32 s37, s37, 8192
s_add_u32 m0, s40, 16384
s_nop 0
buffer_load_dwordx4 v138, s[12:15], s37 offen lds
s_add_u32 m0, s40, 24576
s_nop 0
buffer_load_dwordx4 v138, s[16:19], s37 offen lds
s_add_u32 s37, s37, 8192
s_waitcnt vmcnt(4)
v_max_f32 v6, v6, v7
s_nop 1
v_max_f32_dpp v6, v6, v6 row_ror:8 row_mask:0xf bank_mask:0xf
s_nop 1
v_max_f32_dpp v6, v6, v6 row_ror:4 row_mask:0xf bank_mask:0xf
s_nop 1
v_max_f32_dpp v6, v6, v6 row_ror:2 row_mask:0xf bank_mask:0xf
s_nop 1
v_max_f32_dpp v6, v6, v6 row_ror:1 row_mask:0xf bank_mask:0xf
s_nop 1
v_mov_b32 v7, v6
s_nop 1
v_permlane16_swap_b32 v6, v7
s_nop 1
v_max_f32 v6, v6, v7
v_mov_b32 v7, v6
s_nop 1
v_permlane32_swap_b32 v6, v7
s_nop 1
v_max_f32 v6, v6, v7
v_mov_b32 v2, 0
v_lshlrev_b32 v3, 16, v8
v_and_b32 v4, 0xffff0000, v8
v_fmac_f32 v2, v3, v3
v_fmac_f32 v2, v4, v4
v_lshlrev_b32 v3, 16, v9
v_and_b32 v4, 0xffff0000, v9
v_fmac_f32 v2, v3, v3
v_fmac_f32 v2, v4, v4
v_lshlrev_b32 v3, 16, v10
v_and_b32 v4, 0xffff0000, v10
v_fmac_f32 v2, v3, v3
v_fmac_f32 v2, v4, v4
v_lshlrev_b32 v3, 16, v11
v_and_b32 v4, 0xffff0000, v11
v_fmac_f32 v2, v3, v3
v_fmac_f32 v2, v4, v4
v_lshlrev_b32 v3, 16, v12
v_and_b32 v4, 0xffff0000, v12
v_fmac_f32 v2, v3, v3
v_fmac_f32 v2, v4, v4
v_lshlrev_b32 v3, 16, v13
v_and_b32 v4, 0xffff0000, v13
v_fmac_f32 v2, v3, v3
v_fmac_f32 v2, v4, v4
v_lshlrev_b32 v3, 16, v14
v_and_b32 v4, 0xffff0000, v14
v_fmac_f32 v2, v3, v3
v_fmac_f32 v2, v4, v4
v_lshlrev_b32 v3, 16, v15
v_and_b32 v4, 0xffff0000, v15
v_fmac_f32 v2, v3, v3
v_fmac_f32 v2, v4, v4
v_mov_b32 v3, v2
s_nop 1
v_permlane32_swap_b32 v2, v3
s_nop 1
v_add_f32 v2, v2, v3
v_mul_f32 v2, v2, v6
v_sqrt_f32 v2, v2
s_nop 0
v_sub_f32 v140, 0, v2
s_setprio 1
s_mov_b32 s50, 0
k3_kernel_restart:
v_mov_b32 v16, v140
v_mov_b32 v17, v140
v_mov_b32 v18, v140
v_mov_b32 v19, v140
v_mov_b32 v20, v140
v_mov_b32 v21, v140
v_mov_b32 v22, v140
v_mov_b32 v23, v140
v_mov_b32 v24, v140
v_mov_b32 v25, v140
v_mov_b32 v26, v140
v_mov_b32 v27, v140
v_mov_b32 v28, v140
v_mov_b32 v29, v140
v_mov_b32 v30, v140
v_mov_b32 v31, v140
v_mov_b32 v64, 0
v_mov_b32 v65, 0
v_mov_b32 v66, 0
v_mov_b32 v67, 0
v_mov_b32 v68, 0
v_mov_b32 v69, 0
v_mov_b32 v70, 0
v_mov_b32 v71, 0
v_mov_b32 v72, 0
v_mov_b32 v73, 0
v_mov_b32 v74, 0
v_mov_b32 v75, 0
v_mov_b32 v76, 0
v_mov_b32 v77, 0
v_mov_b32 v78, 0
v_mov_b32 v79, 0
v_mov_b32 v80, 0
v_mov_b32 v81, 0
v_mov_b32 v82, 0
v_mov_b32 v83, 0
v_mov_b32 v96, 0
v_mov_b32 v97, 0
v_mov_b32 v98, 0
v_mov_b32 v99, 0
v_mov_b32 v100, 0
v_mov_b32 v101, 0
v_mov_b32 v102, 0
v_mov_b32 v103, 0
v_mov_b32 v128, 0
v_mov_b32 v129, 0
v_mov_b32 v130, 0
v_mov_b32 v131, 0
v_mov_b32 v132, 0
v_mov_b32 v133, 0
v_mov_b32 v134, 0
v_mov_b32 v135, 0
v_mov_b32 v62, 0
v_mov_b32 v63, 0
s_waitcnt vmcnt(2)
s_barrier
s_add_u32 m0, s40, 32768
s_nop 0
buffer_load_dwordx4 v138, s[12:15], s37 offen lds
s_add_u32 m0, s40, 40960
s_nop 0
buffer_load_dwordx4 v138, s[16:19], s37 offen lds
s_add_u32 s37, s37, 8192
ds_read_b128 v[104:107], v136 offset:0
ds_read_b128 v[108:111], v136 offset:1024
ds_read_b128 v[112:115], v136 offset:2048
ds_read_b128 v[116:119], v136 offset:3072
s_waitcnt lgkmcnt(0)
v_mfma_f32_32x32x16_bf16 v[32:47], v[104:107], v[8:11], v[16:31]
v_mfma_f32_32x32x16_bf16 v[32:47], v[108:111], v[12:15], v[32:47]
s_nop 7
s_nop 3
s_mov_b32 s48, 4
k3_kernel_loop:
s_waitcnt lgkmcnt(0)
v_cvt_pk_bf16_f32 v103, v62, v63
v_mfma_f32_32x32x16_bf16 v[48:63], v[112:115], v[8:11], v[16:31]
ds_read_b128 v[104:107], v136 offset:4096
ds_read_b128 v[108:111], v136 offset:5120
v_exp_f32 v32, v32
v_exp_f32 v33, v33
v_exp_f32 v34, v34
v_exp_f32 v35, v35
v_mfma_f32_32x32x16_bf16 v[48:63], v[116:119], v[12:15], v[48:63]
ds_read_b64_tr_b16 v[120:121], v137 offset:0
ds_read_b64_tr_b16 v[122:123], v137 offset:512
v_cvt_pk_bf16_f32 v88, v32, v33
v_exp_f32 v36, v36
v_exp_f32 v37, v37
v_cvt_pk_bf16_f32 v89, v34, v35
v_mfma_f32_32x32x16_bf16 v[64:79], v[128:131], v[96:99], v[64:79]
ds_read_b64_tr_b16 v[124:125], v137 offset:1024
ds_read_b64_tr_b16 v[126:127], v137 offset:1536
v_exp_f32 v38, v38
v_exp_f32 v39, v39
v_cvt_pk_bf16_f32 v90, v36, v37
v_exp_f32 v40, v40
v_mfma_f32_32x32x16_bf16 v[64:79], v[132:135], v[100:103], v[64:79]
v_exp_f32 v41, v41
v_cvt_pk_bf16_f32 v91, v38, v39
v_exp_f32 v42, v42
v_mfma_f32_16x16x32_bf16 v[80:83], v[84:87], v[96:99], v[80:83]
v_exp_f32 v43, v43
v_cvt_pk_bf16_f32 v92, v40, v41
v_exp_f32 v44, v44
v_exp_f32 v45, v45
v_mfma_f32_16x16x32_bf16 v[80:83], v[84:87], v[100:103], v[80:83]
v_cvt_pk_bf16_f32 v93, v42, v43
v_exp_f32 v46, v46
v_exp_f32 v47, v47
v_cvt_pk_bf16_f32 v94, v44, v45
s_waitcnt lgkmcnt(0)
v_cvt_pk_bf16_f32 v95, v46, v47
v_mfma_f32_32x32x16_bf16 v[32:47], v[104:107], v[8:11], v[16:31]
ds_read_b128 v[112:115], v136 offset:6144
ds_read_b128 v[116:119], v136 offset:7168
v_exp_f32 v48, v48
v_exp_f32 v49, v49
v_exp_f32 v50, v50
v_exp_f32 v51, v51
v_mfma_f32_32x32x16_bf16 v[32:47], v[108:111], v[12:15], v[32:47]
ds_read_b64_tr_b16 v[128:129], v137 offset:2048
ds_read_b64_tr_b16 v[130:131], v137 offset:2560
v_cvt_pk_bf16_f32 v96, v48, v49
v_exp_f32 v52, v52
v_exp_f32 v53, v53
v_cvt_pk_bf16_f32 v97, v50, v51
v_mfma_f32_32x32x16_bf16 v[64:79], v[120:123], v[88:91], v[64:79]
ds_read_b64_tr_b16 v[132:133], v137 offset:3072
ds_read_b64_tr_b16 v[134:135], v137 offset:3584
v_exp_f32 v54, v54
v_exp_f32 v55, v55
v_cvt_pk_bf16_f32 v98, v52, v53
v_exp_f32 v56, v56
v_mfma_f32_32x32x16_bf16 v[64:79], v[124:127], v[92:95], v[64:79]
v_exp_f32 v57, v57
v_cvt_pk_bf16_f32 v99, v54, v55
v_exp_f32 v58, v58
v_mfma_f32_16x16x32_bf16 v[80:83], v[84:87], v[88:91], v[80:83]
v_exp_f32 v59, v59
v_cvt_pk_bf16_f32 v100, v56, v57
v_exp_f32 v60, v60
v_exp_f32 v61, v61
v_mfma_f32_16x16x32_bf16 v[80:83], v[84:87], v[92:95], v[80:83]
v_cvt_pk_bf16_f32 v101, v58, v59
v_exp_f32 v62, v62
v_exp_f32 v63, v63
v_cvt_pk_bf16_f32 v102, v60, v61
s_waitcnt vmcnt(2) lgkmcnt(0)
s_barrier
v_cvt_pk_bf16_f32 v103, v62, v63
v_mfma_f32_32x32x16_bf16 v[48:63], v[112:115], v[8:11], v[16:31]
ds_read_b128 v[104:107], v136 offset:16384
ds_read_b128 v[108:111], v136 offset:17408
v_exp_f32 v32, v32
v_exp_f32 v33, v33
v_exp_f32 v34, v34
v_exp_f32 v35, v35
v_mfma_f32_32x32x16_bf16 v[48:63], v[116:119], v[12:15], v[48:63]
ds_read_b64_tr_b16 v[120:121], v137 offset:4096
ds_read_b64_tr_b16 v[122:123], v137 offset:4608
v_cvt_pk_bf16_f32 v88, v32, v33
v_exp_f32 v36, v36
v_exp_f32 v37, v37
v_cvt_pk_bf16_f32 v89, v34, v35
v_mfma_f32_32x32x16_bf16 v[64:79], v[128:131], v[96:99], v[64:79]
ds_read_b64_tr_b16 v[124:125], v137 offset:5120
ds_read_b64_tr_b16 v[126:127], v137 offset:5632
v_exp_f32 v38, v38
v_exp_f32 v39, v39
v_cvt_pk_bf16_f32 v90, v36, v37
v_exp_f32 v40, v40
v_mfma_f32_32x32x16_bf16 v[64:79], v[132:135], v[100:103], v[64:79]
s_add_u32 m0, s40, 49152
s_nop 0
buffer_load_dwordx4 v138, s[12:15], s37 offen lds
s_add_u32 m0, s40, 57344
s_nop 0
buffer_load_dwordx4 v138, s[16:19], s37 offen lds
s_add_u32 s37, s37, 8192
v_exp_f32 v41, v41
v_cvt_pk_bf16_f32 v91, v38, v39
v_exp_f32 v42, v42
v_mfma_f32_16x16x32_bf16 v[80:83], v[84:87], v[96:99], v[80:83]
v_exp_f32 v43, v43
v_cvt_pk_bf16_f32 v92, v40, v41
v_exp_f32 v44, v44
v_exp_f32 v45, v45
v_mfma_f32_16x16x32_bf16 v[80:83], v[84:87], v[100:103], v[80:83]
v_cvt_pk_bf16_f32 v93, v42, v43
v_exp_f32 v46, v46
v_exp_f32 v47, v47
v_cvt_pk_bf16_f32 v94, v44, v45
s_waitcnt lgkmcnt(0)
v_cvt_pk_bf16_f32 v95, v46, v47
v_mfma_f32_32x32x16_bf16 v[32:47], v[104:107], v[8:11], v[16:31]
ds_read_b128 v[112:115], v136 offset:18432
ds_read_b128 v[116:119], v136 offset:19456
v_exp_f32 v48, v48
v_exp_f32 v49, v49
v_exp_f32 v50, v50
v_exp_f32 v51, v51
v_mfma_f32_32x32x16_bf16 v[32:47], v[108:111], v[12:15], v[32:47]
ds_read_b64_tr_b16 v[128:129], v137 offset:6144
ds_read_b64_tr_b16 v[130:131], v137 offset:6656
v_cvt_pk_bf16_f32 v96, v48, v49
v_exp_f32 v52, v52
v_exp_f32 v53, v53
v_cvt_pk_bf16_f32 v97, v50, v51
v_mfma_f32_32x32x16_bf16 v[64:79], v[120:123], v[88:91], v[64:79]
ds_read_b64_tr_b16 v[132:133], v137 offset:7168
ds_read_b64_tr_b16 v[134:135], v137 offset:7680
v_exp_f32 v54, v54
v_exp_f32 v55, v55
v_cvt_pk_bf16_f32 v98, v52, v53
v_exp_f32 v56, v56
v_mfma_f32_32x32x16_bf16 v[64:79], v[124:127], v[92:95], v[64:79]
v_exp_f32 v57, v57
v_cvt_pk_bf16_f32 v99, v54, v55
v_exp_f32 v58, v58
v_mfma_f32_16x16x32_bf16 v[80:83], v[84:87], v[88:91], v[80:83]
v_exp_f32 v59, v59
v_cvt_pk_bf16_f32 v100, v56, v57
v_exp_f32 v60, v60
v_exp_f32 v61, v61
v_mfma_f32_16x16x32_bf16 v[80:83], v[84:87], v[92:95], v[80:83]
v_cvt_pk_bf16_f32 v101, v58, v59
v_exp_f32 v62, v62
v_exp_f32 v63, v63
v_cvt_pk_bf16_f32 v102, v60, v61
s_waitcnt lgkmcnt(0)
v_cvt_pk_bf16_f32 v103, v62, v63
v_mfma_f32_32x32x16_bf16 v[48:63], v[112:115], v[8:11], v[16:31]
ds_read_b128 v[104:107], v136 offset:20480
ds_read_b128 v[108:111], v136 offset:21504
v_exp_f32 v32, v32
v_exp_f32 v33, v33
v_exp_f32 v34, v34
v_exp_f32 v35, v35
v_mfma_f32_32x32x16_bf16 v[48:63], v[116:119], v[12:15], v[48:63]
ds_read_b64_tr_b16 v[120:121], v137 offset:16384
ds_read_b64_tr_b16 v[122:123], v137 offset:16896
v_cvt_pk_bf16_f32 v88, v32, v33
v_exp_f32 v36, v36
v_exp_f32 v37, v37
v_cvt_pk_bf16_f32 v89, v34, v35
v_mfma_f32_32x32x16_bf16 v[64:79], v[128:131], v[96:99], v[64:79]
ds_read_b64_tr_b16 v[124:125], v137 offset:17408
ds_read_b64_tr_b16 v[126:127], v137 offset:17920
v_exp_f32 v38, v38
v_exp_f32 v39, v39
v_cvt_pk_bf16_f32 v90, v36, v37
v_exp_f32 v40, v40
v_mfma_f32_32x32x16_bf16 v[64:79], v[132:135], v[100:103], v[64:79]
v_exp_f32 v41, v41
v_cvt_pk_bf16_f32 v91, v38, v39
v_exp_f32 v42, v42
v_mfma_f32_16x16x32_bf16 v[80:83], v[84:87], v[96:99], v[80:83]
v_exp_f32 v43, v43
v_cvt_pk_bf16_f32 v92, v40, v41
v_exp_f32 v44, v44
v_exp_f32 v45, v45
v_mfma_f32_16x16x32_bf16 v[80:83], v[84:87], v[100:103], v[80:83]
v_cvt_pk_bf16_f32 v93, v42, v43
v_exp_f32 v46, v46
v_exp_f32 v47, v47
v_cvt_pk_bf16_f32 v94, v44, v45
s_waitcnt lgkmcnt(0)
v_cvt_pk_bf16_f32 v95, v46, v47
v_mfma_f32_32x32x16_bf16 v[32:47], v[104:107], v[8:11], v[16:31]
ds_read_b128 v[112:115], v136 offset:22528
ds_read_b128 v[116:119], v136 offset:23552
v_exp_f32 v48, v48
v_exp_f32 v49, v49
v_exp_f32 v50, v50
v_exp_f32 v51, v51
v_mfma_f32_32x32x16_bf16 v[32:47], v[108:111], v[12:15], v[32:47]
ds_read_b64_tr_b16 v[128:129], v137 offset:18432
ds_read_b64_tr_b16 v[130:131], v137 offset:18944
v_cvt_pk_bf16_f32 v96, v48, v49
v_exp_f32 v52, v52
v_exp_f32 v53, v53
v_cvt_pk_bf16_f32 v97, v50, v51
v_mfma_f32_32x32x16_bf16 v[64:79], v[120:123], v[88:91], v[64:79]
ds_read_b64_tr_b16 v[132:133], v137 offset:19456
ds_read_b64_tr_b16 v[134:135], v137 offset:19968
v_exp_f32 v54, v54
v_exp_f32 v55, v55
v_cvt_pk_bf16_f32 v98, v52, v53
v_exp_f32 v56, v56
v_mfma_f32_32x32x16_bf16 v[64:79], v[124:127], v[92:95], v[64:79]
v_exp_f32 v57, v57
v_cvt_pk_bf16_f32 v99, v54, v55
v_exp_f32 v58, v58
v_mfma_f32_16x16x32_bf16 v[80:83], v[84:87], v[88:91], v[80:83]
v_exp_f32 v59, v59
v_cvt_pk_bf16_f32 v100, v56, v57
v_exp_f32 v60, v60
v_exp_f32 v61, v61
v_mfma_f32_16x16x32_bf16 v[80:83], v[84:87], v[92:95], v[80:83]
v_cvt_pk_bf16_f32 v101, v58, v59
v_exp_f32 v62, v62
v_exp_f32 v63, v63
v_cvt_pk_bf16_f32 v102, v60, v61
s_waitcnt vmcnt(2) lgkmcnt(0)
s_barrier
v_cvt_pk_bf16_f32 v103, v62, v63
v_mfma_f32_32x32x16_bf16 v[48:63], v[112:115], v[8:11], v[16:31]
ds_read_b128 v[104:107], v136 offset:32768
ds_read_b128 v[108:111], v136 offset:33792
v_exp_f32 v32, v32
v_exp_f32 v33, v33
v_exp_f32 v34, v34
v_exp_f32 v35, v35
v_mfma_f32_32x32x16_bf16 v[48:63], v[116:119], v[12:15], v[48:63]
ds_read_b64_tr_b16 v[120:121], v137 offset:20480
ds_read_b64_tr_b16 v[122:123], v137 offset:20992
v_cvt_pk_bf16_f32 v88, v32, v33
v_exp_f32 v36, v36
v_exp_f32 v37, v37
v_cvt_pk_bf16_f32 v89, v34, v35
v_mfma_f32_32x32x16_bf16 v[64:79], v[128:131], v[96:99], v[64:79]
ds_read_b64_tr_b16 v[124:125], v137 offset:21504
ds_read_b64_tr_b16 v[126:127], v137 offset:22016
v_exp_f32 v38, v38
v_exp_f32 v39, v39
v_cvt_pk_bf16_f32 v90, v36, v37
v_exp_f32 v40, v40
v_mfma_f32_32x32x16_bf16 v[64:79], v[132:135], v[100:103], v[64:79]
s_add_u32 m0, s40, 0
s_nop 0
buffer_load_dwordx4 v138, s[12:15], s37 offen lds
s_add_u32 m0, s40, 8192
s_nop 0
buffer_load_dwordx4 v138, s[16:19], s37 offen lds
s_add_u32 s37, s37, 8192
v_exp_f32 v41, v41
v_cvt_pk_bf16_f32 v91, v38, v39
v_exp_f32 v42, v42
v_mfma_f32_16x16x32_bf16 v[80:83], v[84:87], v[96:99], v[80:83]
v_exp_f32 v43, v43
v_cvt_pk_bf16_f32 v92, v40, v41
v_exp_f32 v44, v44
v_exp_f32 v45, v45
v_mfma_f32_16x16x32_bf16 v[80:83], v[84:87], v[100:103], v[80:83]
v_cvt_pk_bf16_f32 v93, v42, v43
v_exp_f32 v46, v46
v_exp_f32 v47, v47
v_cvt_pk_bf16_f32 v94, v44, v45
s_waitcnt lgkmcnt(0)
v_cvt_pk_bf16_f32 v95, v46, v47
v_mfma_f32_32x32x16_bf16 v[32:47], v[104:107], v[8:11], v[16:31]
ds_read_b128 v[112:115], v136 offset:34816
ds_read_b128 v[116:119], v136 offset:35840
v_exp_f32 v48, v48
v_exp_f32 v49, v49
v_exp_f32 v50, v50
v_exp_f32 v51, v51
v_mfma_f32_32x32x16_bf16 v[32:47], v[108:111], v[12:15], v[32:47]
ds_read_b64_tr_b16 v[128:129], v137 offset:22528
ds_read_b64_tr_b16 v[130:131], v137 offset:23040
v_cvt_pk_bf16_f32 v96, v48, v49
v_exp_f32 v52, v52
v_exp_f32 v53, v53
v_cvt_pk_bf16_f32 v97, v50, v51
v_mfma_f32_32x32x16_bf16 v[64:79], v[120:123], v[88:91], v[64:79]
ds_read_b64_tr_b16 v[132:133], v137 offset:23552
ds_read_b64_tr_b16 v[134:135], v137 offset:24064
v_exp_f32 v54, v54
v_exp_f32 v55, v55
v_cvt_pk_bf16_f32 v98, v52, v53
v_exp_f32 v56, v56
v_mfma_f32_32x32x16_bf16 v[64:79], v[124:127], v[92:95], v[64:79]
v_exp_f32 v57, v57
v_cvt_pk_bf16_f32 v99, v54, v55
v_exp_f32 v58, v58
v_mfma_f32_16x16x32_bf16 v[80:83], v[84:87], v[88:91], v[80:83]
v_exp_f32 v59, v59
v_cvt_pk_bf16_f32 v100, v56, v57
v_exp_f32 v60, v60
v_exp_f32 v61, v61
v_mfma_f32_16x16x32_bf16 v[80:83], v[84:87], v[92:95], v[80:83]
v_cvt_pk_bf16_f32 v101, v58, v59
v_exp_f32 v62, v62
v_exp_f32 v63, v63
v_cvt_pk_bf16_f32 v102, v60, v61
s_waitcnt lgkmcnt(0)
v_cvt_pk_bf16_f32 v103, v62, v63
v_mfma_f32_32x32x16_bf16 v[48:63], v[112:115], v[8:11], v[16:31]
ds_read_b128 v[104:107], v136 offset:36864
ds_read_b128 v[108:111], v136 offset:37888
v_exp_f32 v32, v32
v_exp_f32 v33, v33
v_exp_f32 v34, v34
v_exp_f32 v35, v35
v_mfma_f32_32x32x16_bf16 v[48:63], v[116:119], v[12:15], v[48:63]
ds_read_b64_tr_b16 v[120:121], v137 offset:32768
ds_read_b64_tr_b16 v[122:123], v137 offset:33280
v_cvt_pk_bf16_f32 v88, v32, v33
v_exp_f32 v36, v36
v_exp_f32 v37, v37
v_cvt_pk_bf16_f32 v89, v34, v35
v_mfma_f32_32x32x16_bf16 v[64:79], v[128:131], v[96:99], v[64:79]
ds_read_b64_tr_b16 v[124:125], v137 offset:33792
ds_read_b64_tr_b16 v[126:127], v137 offset:34304
v_exp_f32 v38, v38
v_exp_f32 v39, v39
v_cvt_pk_bf16_f32 v90, v36, v37
v_exp_f32 v40, v40
v_mfma_f32_32x32x16_bf16 v[64:79], v[132:135], v[100:103], v[64:79]
v_exp_f32 v41, v41
v_cvt_pk_bf16_f32 v91, v38, v39
v_exp_f32 v42, v42
v_mfma_f32_16x16x32_bf16 v[80:83], v[84:87], v[96:99], v[80:83]
v_exp_f32 v43, v43
v_cvt_pk_bf16_f32 v92, v40, v41
v_exp_f32 v44, v44
v_exp_f32 v45, v45
v_mfma_f32_16x16x32_bf16 v[80:83], v[84:87], v[100:103], v[80:83]
v_cvt_pk_bf16_f32 v93, v42, v43
v_exp_f32 v46, v46
v_exp_f32 v47, v47
v_cvt_pk_bf16_f32 v94, v44, v45
s_waitcnt lgkmcnt(0)
v_cvt_pk_bf16_f32 v95, v46, v47
v_mfma_f32_32x32x16_bf16 v[32:47], v[104:107], v[8:11], v[16:31]
ds_read_b128 v[112:115], v136 offset:38912
ds_read_b128 v[116:119], v136 offset:39936
v_exp_f32 v48, v48
v_exp_f32 v49, v49
v_exp_f32 v50, v50
v_exp_f32 v51, v51
v_mfma_f32_32x32x16_bf16 v[32:47], v[108:111], v[12:15], v[32:47]
ds_read_b64_tr_b16 v[128:129], v137 offset:34816
ds_read_b64_tr_b16 v[130:131], v137 offset:35328
v_cvt_pk_bf16_f32 v96, v48, v49
v_exp_f32 v52, v52
v_exp_f32 v53, v53
v_cvt_pk_bf16_f32 v97, v50, v51
v_mfma_f32_32x32x16_bf16 v[64:79], v[120:123], v[88:91], v[64:79]
ds_read_b64_tr_b16 v[132:133], v137 offset:35840
ds_read_b64_tr_b16 v[134:135], v137 offset:36352
v_exp_f32 v54, v54
v_exp_f32 v55, v55
v_cvt_pk_bf16_f32 v98, v52, v53
v_exp_f32 v56, v56
v_mfma_f32_32x32x16_bf16 v[64:79], v[124:127], v[92:95], v[64:79]
v_exp_f32 v57, v57
v_cvt_pk_bf16_f32 v99, v54, v55
v_exp_f32 v58, v58
v_mfma_f32_16x16x32_bf16 v[80:83], v[84:87], v[88:91], v[80:83]
v_exp_f32 v59, v59
v_cvt_pk_bf16_f32 v100, v56, v57
v_exp_f32 v60, v60
v_exp_f32 v61, v61
v_mfma_f32_16x16x32_bf16 v[80:83], v[84:87], v[92:95], v[80:83]
v_cvt_pk_bf16_f32 v101, v58, v59
v_exp_f32 v62, v62
v_exp_f32 v63, v63
v_cvt_pk_bf16_f32 v102, v60, v61
s_waitcnt vmcnt(2) lgkmcnt(0)
s_barrier
v_cvt_pk_bf16_f32 v103, v62, v63
v_mfma_f32_32x32x16_bf16 v[48:63], v[112:115], v[8:11], v[16:31]
ds_read_b128 v[104:107], v136 offset:49152
ds_read_b128 v[108:111], v136 offset:50176
v_exp_f32 v32, v32
v_exp_f32 v33, v33
v_exp_f32 v34, v34
v_exp_f32 v35, v35
v_mfma_f32_32x32x16_bf16 v[48:63], v[116:119], v[12:15], v[48:63]
ds_read_b64_tr_b16 v[120:121], v137 offset:36864
ds_read_b64_tr_b16 v[122:123], v137 offset:37376
v_cvt_pk_bf16_f32 v88, v32, v33
v_exp_f32 v36, v36
v_exp_f32 v37, v37
v_cvt_pk_bf16_f32 v89, v34, v35
v_mfma_f32_32x32x16_bf16 v[64:79], v[128:131], v[96:99], v[64:79]
ds_read_b64_tr_b16 v[124:125], v137 offset:37888
ds_read_b64_tr_b16 v[126:127], v137 offset:38400
v_exp_f32 v38, v38
v_exp_f32 v39, v39
v_cvt_pk_bf16_f32 v90, v36, v37
v_exp_f32 v40, v40
v_mfma_f32_32x32x16_bf16 v[64:79], v[132:135], v[100:103], v[64:79]
s_add_u32 m0, s40, 16384
s_nop 0
buffer_load_dwordx4 v138, s[12:15], s37 offen lds
s_add_u32 m0, s40, 24576
s_nop 0
buffer_load_dwordx4 v138, s[16:19], s37 offen lds
s_add_u32 s37, s37, 8192
v_exp_f32 v41, v41
v_cvt_pk_bf16_f32 v91, v38, v39
v_exp_f32 v42, v42
v_mfma_f32_16x16x32_bf16 v[80:83], v[84:87], v[96:99], v[80:83]
v_exp_f32 v43, v43
v_cvt_pk_bf16_f32 v92, v40, v41
v_exp_f32 v44, v44
v_exp_f32 v45, v45
v_mfma_f32_16x16x32_bf16 v[80:83], v[84:87], v[100:103], v[80:83]
v_cvt_pk_bf16_f32 v93, v42, v43
v_exp_f32 v46, v46
v_exp_f32 v47, v47
v_cvt_pk_bf16_f32 v94, v44, v45
s_waitcnt lgkmcnt(0)
v_cvt_pk_bf16_f32 v95, v46, v47
v_mfma_f32_32x32x16_bf16 v[32:47], v[104:107], v[8:11], v[16:31]
ds_read_b128 v[112:115], v136 offset:51200
ds_read_b128 v[116:119], v136 offset:52224
v_exp_f32 v48, v48
v_exp_f32 v49, v49
v_exp_f32 v50, v50
v_exp_f32 v51, v51
v_mfma_f32_32x32x16_bf16 v[32:47], v[108:111], v[12:15], v[32:47]
ds_read_b64_tr_b16 v[128:129], v137 offset:38912
ds_read_b64_tr_b16 v[130:131], v137 offset:39424
v_cvt_pk_bf16_f32 v96, v48, v49
v_exp_f32 v52, v52
v_exp_f32 v53, v53
v_cvt_pk_bf16_f32 v97, v50, v51
v_mfma_f32_32x32x16_bf16 v[64:79], v[120:123], v[88:91], v[64:79]
ds_read_b64_tr_b16 v[132:133], v137 offset:39936
ds_read_b64_tr_b16 v[134:135], v137 offset:40448
v_exp_f32 v54, v54
v_exp_f32 v55, v55
v_cvt_pk_bf16_f32 v98, v52, v53
v_exp_f32 v56, v56
v_mfma_f32_32x32x16_bf16 v[64:79], v[124:127], v[92:95], v[64:79]
v_exp_f32 v57, v57
v_cvt_pk_bf16_f32 v99, v54, v55
v_exp_f32 v58, v58
v_mfma_f32_16x16x32_bf16 v[80:83], v[84:87], v[88:91], v[80:83]
v_exp_f32 v59, v59
v_cvt_pk_bf16_f32 v100, v56, v57
v_exp_f32 v60, v60
v_exp_f32 v61, v61
v_mfma_f32_16x16x32_bf16 v[80:83], v[84:87], v[92:95], v[80:83]
v_cvt_pk_bf16_f32 v101, v58, v59
v_exp_f32 v62, v62
v_exp_f32 v63, v63
v_cvt_pk_bf16_f32 v102, v60, v61
s_waitcnt lgkmcnt(0)
v_cvt_pk_bf16_f32 v103, v62, v63
v_mfma_f32_32x32x16_bf16 v[48:63], v[112:115], v[8:11], v[16:31]
ds_read_b128 v[104:107], v136 offset:53248
ds_read_b128 v[108:111], v136 offset:54272
v_exp_f32 v32, v32
v_exp_f32 v33, v33
v_exp_f32 v34, v34
v_exp_f32 v35, v35
v_mfma_f32_32x32x16_bf16 v[48:63], v[116:119], v[12:15], v[48:63]
ds_read_b64_tr_b16 v[120:121], v137 offset:49152
ds_read_b64_tr_b16 v[122:123], v137 offset:49664
v_cvt_pk_bf16_f32 v88, v32, v33
v_exp_f32 v36, v36
v_exp_f32 v37, v37
v_cvt_pk_bf16_f32 v89, v34, v35
v_mfma_f32_32x32x16_bf16 v[64:79], v[128:131], v[96:99], v[64:79]
ds_read_b64_tr_b16 v[124:125], v137 offset:50176
ds_read_b64_tr_b16 v[126:127], v137 offset:50688
v_exp_f32 v38, v38
v_exp_f32 v39, v39
v_cvt_pk_bf16_f32 v90, v36, v37
v_exp_f32 v40, v40
v_mfma_f32_32x32x16_bf16 v[64:79], v[132:135], v[100:103], v[64:79]
v_exp_f32 v41, v41
v_cvt_pk_bf16_f32 v91, v38, v39
v_exp_f32 v42, v42
v_mfma_f32_16x16x32_bf16 v[80:83], v[84:87], v[96:99], v[80:83]
v_exp_f32 v43, v43
v_cvt_pk_bf16_f32 v92, v40, v41
v_exp_f32 v44, v44
v_exp_f32 v45, v45
v_mfma_f32_16x16x32_bf16 v[80:83], v[84:87], v[100:103], v[80:83]
v_cvt_pk_bf16_f32 v93, v42, v43
v_exp_f32 v46, v46
v_exp_f32 v47, v47
v_cvt_pk_bf16_f32 v94, v44, v45
s_waitcnt lgkmcnt(0)
v_cvt_pk_bf16_f32 v95, v46, v47
v_mfma_f32_32x32x16_bf16 v[32:47], v[104:107], v[8:11], v[16:31]
ds_read_b128 v[112:115], v136 offset:55296
ds_read_b128 v[116:119], v136 offset:56320
v_exp_f32 v48, v48
v_exp_f32 v49, v49
v_exp_f32 v50, v50
v_exp_f32 v51, v51
v_mfma_f32_32x32x16_bf16 v[32:47], v[108:111], v[12:15], v[32:47]
ds_read_b64_tr_b16 v[128:129], v137 offset:51200
ds_read_b64_tr_b16 v[130:131], v137 offset:51712
v_cvt_pk_bf16_f32 v96, v48, v49
v_exp_f32 v52, v52
v_exp_f32 v53, v53
v_cvt_pk_bf16_f32 v97, v50, v51
v_mfma_f32_32x32x16_bf16 v[64:79], v[120:123], v[88:91], v[64:79]
ds_read_b64_tr_b16 v[132:133], v137 offset:52224
ds_read_b64_tr_b16 v[134:135], v137 offset:52736
v_exp_f32 v54, v54
v_exp_f32 v55, v55
v_cvt_pk_bf16_f32 v98, v52, v53
v_exp_f32 v56, v56
v_mfma_f32_32x32x16_bf16 v[64:79], v[124:127], v[92:95], v[64:79]
v_exp_f32 v57, v57
v_cvt_pk_bf16_f32 v99, v54, v55
v_exp_f32 v58, v58
v_mfma_f32_16x16x32_bf16 v[80:83], v[84:87], v[88:91], v[80:83]
v_exp_f32 v59, v59
v_cvt_pk_bf16_f32 v100, v56, v57
v_exp_f32 v60, v60
v_exp_f32 v61, v61
v_mfma_f32_16x16x32_bf16 v[80:83], v[84:87], v[92:95], v[80:83]
v_cvt_pk_bf16_f32 v101, v58, v59
v_exp_f32 v62, v62
v_exp_f32 v63, v63
v_cvt_pk_bf16_f32 v102, v60, v61
s_waitcnt vmcnt(2) lgkmcnt(0)
s_barrier
v_cvt_pk_bf16_f32 v103, v62, v63
v_mfma_f32_32x32x16_bf16 v[48:63], v[112:115], v[8:11], v[16:31]
ds_read_b128 v[104:107], v136 offset:0
ds_read_b128 v[108:111], v136 offset:1024
v_exp_f32 v32, v32
v_exp_f32 v33, v33
v_exp_f32 v34, v34
v_exp_f32 v35, v35
v_mfma_f32_32x32x16_bf16 v[48:63], v[116:119], v[12:15], v[48:63]
ds_read_b64_tr_b16 v[120:121], v137 offset:53248
ds_read_b64_tr_b16 v[122:123], v137 offset:53760
v_cvt_pk_bf16_f32 v88, v32, v33
v_exp_f32 v36, v36
v_exp_f32 v37, v37
v_cvt_pk_bf16_f32 v89, v34, v35
v_mfma_f32_32x32x16_bf16 v[64:79], v[128:131], v[96:99], v[64:79]
ds_read_b64_tr_b16 v[124:125], v137 offset:54272
ds_read_b64_tr_b16 v[126:127], v137 offset:54784
v_exp_f32 v38, v38
v_exp_f32 v39, v39
v_cvt_pk_bf16_f32 v90, v36, v37
v_exp_f32 v40, v40
v_mfma_f32_32x32x16_bf16 v[64:79], v[132:135], v[100:103], v[64:79]
s_add_u32 m0, s40, 32768
s_nop 0
buffer_load_dwordx4 v138, s[12:15], s37 offen lds
s_add_u32 m0, s40, 40960
s_nop 0
buffer_load_dwordx4 v138, s[16:19], s37 offen lds
s_add_u32 s37, s37, 8192
v_exp_f32 v41, v41
v_cvt_pk_bf16_f32 v91, v38, v39
v_exp_f32 v42, v42
v_mfma_f32_16x16x32_bf16 v[80:83], v[84:87], v[96:99], v[80:83]
v_exp_f32 v43, v43
v_cvt_pk_bf16_f32 v92, v40, v41
v_exp_f32 v44, v44
v_exp_f32 v45, v45
v_mfma_f32_16x16x32_bf16 v[80:83], v[84:87], v[100:103], v[80:83]
v_cvt_pk_bf16_f32 v93, v42, v43
v_exp_f32 v46, v46
v_exp_f32 v47, v47
v_cvt_pk_bf16_f32 v94, v44, v45
s_waitcnt lgkmcnt(0)
v_cvt_pk_bf16_f32 v95, v46, v47
v_mfma_f32_32x32x16_bf16 v[32:47], v[104:107], v[8:11], v[16:31]
ds_read_b128 v[112:115], v136 offset:2048
ds_read_b128 v[116:119], v136 offset:3072
v_exp_f32 v48, v48
v_exp_f32 v49, v49
v_exp_f32 v50, v50
v_exp_f32 v51, v51
v_mfma_f32_32x32x16_bf16 v[32:47], v[108:111], v[12:15], v[32:47]
ds_read_b64_tr_b16 v[128:129], v137 offset:55296
ds_read_b64_tr_b16 v[130:131], v137 offset:55808
v_cvt_pk_bf16_f32 v96, v48, v49
v_exp_f32 v52, v52
v_exp_f32 v53, v53
v_cvt_pk_bf16_f32 v97, v50, v51
v_mfma_f32_32x32x16_bf16 v[64:79], v[120:123], v[88:91], v[64:79]
ds_read_b64_tr_b16 v[132:133], v137 offset:56320
ds_read_b64_tr_b16 v[134:135], v137 offset:56832
v_exp_f32 v54, v54
v_exp_f32 v55, v55
v_cvt_pk_bf16_f32 v98, v52, v53
v_exp_f32 v56, v56
v_mfma_f32_32x32x16_bf16 v[64:79], v[124:127], v[92:95], v[64:79]
v_exp_f32 v57, v57
v_cvt_pk_bf16_f32 v99, v54, v55
v_exp_f32 v58, v58
v_mfma_f32_16x16x32_bf16 v[80:83], v[84:87], v[88:91], v[80:83]
v_exp_f32 v59, v59
v_cvt_pk_bf16_f32 v100, v56, v57
v_exp_f32 v60, v60
v_exp_f32 v61, v61
v_mfma_f32_16x16x32_bf16 v[80:83], v[84:87], v[92:95], v[80:83]
v_cvt_pk_bf16_f32 v101, v58, v59
v_exp_f32 v62, v62
v_exp_f32 v63, v63
v_cvt_pk_bf16_f32 v102, v60, v61
s_sub_u32 s48, s48, 1
s_cmp_lg_u32 s48, 0
s_cbranch_scc1 k3_kernel_loop
s_waitcnt lgkmcnt(0)
v_cvt_pk_bf16_f32 v103, v62, v63
s_nop 1
v_mfma_f32_32x32x16_bf16 v[64:79], v[128:131], v[96:99], v[64:79]
v_mfma_f32_32x32x16_bf16 v[64:79], v[132:135], v[100:103], v[64:79]
v_mfma_f32_16x16x32_bf16 v[80:83], v[84:87], v[96:99], v[80:83]
v_mfma_f32_16x16x32_bf16 v[80:83], v[84:87], v[100:103], v[80:83]
s_nop 15
s_nop 7
s_waitcnt vmcnt(0)
s_barrier
s_cmp_eq_u32 s50, 1
s_cbranch_scc1 k3_kernel_out
v_mov_b32 v2, 0x17800000
v_cmp_nge_f32 vcc, v80, v2
v_mov_b32 v3, 0
v_mov_b32 v4, 65536
ds_write_b32 v4, v3
s_waitcnt lgkmcnt(0)
s_barrier
s_cmp_eq_u64 vcc, 0
s_cbranch_scc1 k3_kernel_noflag
v_mov_b32 v3, 1
ds_write_b32 v4, v3
k3_kernel_noflag:
s_waitcnt lgkmcnt(0)
s_barrier
ds_read_b32 v3, v4
s_waitcnt lgkmcnt(0)
v_readfirstlane_b32 s3, v3
s_cmp_eq_u32 s3, 0
s_cbranch_scc1 k3_kernel_out
v_mov_b32 v140, 0xff800000
s_mov_b32 s37, 0
s_mov_b32 s48, 16
k3_kernel_mx:
s_barrier
s_add_u32 m0, s40, 0
s_nop 0
buffer_load_dwordx4 v138, s[12:15], s37 offen lds
s_add_u32 m0, s40, 8192
s_nop 0
buffer_load_dwordx4 v138, s[16:19], s37 offen lds
s_add_u32 s37, s37, 8192
s_waitcnt vmcnt(0)
s_barrier
ds_read_b128 v[104:107], v136 offset:0
ds_read_b128 v[108:111], v136 offset:1024
s_waitcnt lgkmcnt(0)
v_mfma_f32_32x32x16_bf16 v[32:47], v[104:107], v[8:11], 0
v_mfma_f32_32x32x16_bf16 v[32:47], v[108:111], v[12:15], v[32:47]
s_nop 15
v_max3_f32 v140, v32, v33, v140
v_max3_f32 v140, v34, v35, v140
v_max3_f32 v140, v36, v37, v140
v_max3_f32 v140, v38, v39, v140
v_max3_f32 v140, v40, v41, v140
v_max3_f32 v140, v42, v43, v140
v_max3_f32 v140, v44, v45, v140
v_max3_f32 v140, v46, v47, v140
ds_read_b128 v[104:107], v136 offset:2048
ds_read_b128 v[108:111], v136 offset:3072
s_waitcnt lgkmcnt(0)
v_mfma_f32_32x32x16_bf16 v[32:47], v[104:107], v[8:11], 0
v_mfma_f32_32x32x16_bf16 v[32:47], v[108:111], v[12:15], v[32:47]
s_nop 15
v_max3_f32 v140, v32, v33, v140
v_max3_f32 v140, v34, v35, v140
v_max3_f32 v140, v36, v37, v140
v_max3_f32 v140, v38, v39, v140
v_max3_f32 v140, v40, v41, v140
v_max3_f32 v140, v42, v43, v140
v_max3_f32 v140, v44, v45, v140
v_max3_f32 v140, v46, v47, v140
ds_read_b128 v[104:107], v136 offset:4096
ds_read_b128 v[108:111], v136 offset:5120
s_waitcnt lgkmcnt(0)
v_mfma_f32_32x32x16_bf16 v[32:47], v[104:107], v[8:11], 0
v_mfma_f32_32x32x16_bf16 v[32:47], v[108:111], v[12:15], v[32:47]
s_nop 15
v_max3_f32 v140, v32, v33, v140
v_max3_f32 v140, v34, v35, v140
v_max3_f32 v140, v36, v37, v140
v_max3_f32 v140, v38, v39, v140
v_max3_f32 v140, v40, v41, v140
v_max3_f32 v140, v42, v43, v140
v_max3_f32 v140, v44, v45, v140
v_max3_f32 v140, v46, v47, v140
ds_read_b128 v[104:107], v136 offset:6144
ds_read_b128 v[108:111], v136 offset:7168
s_waitcnt lgkmcnt(0)
v_mfma_f32_32x32x16_bf16 v[32:47], v[104:107], v[8:11], 0
v_mfma_f32_32x32x16_bf16 v[32:47], v[108:111], v[12:15], v[32:47]
s_nop 15
v_max3_f32 v140, v32, v33, v140
v_max3_f32 v140, v34, v35, v140
v_max3_f32 v140, v36, v37, v140
v_max3_f32 v140, v38, v39, v140
v_max3_f32 v140, v40, v41, v140
v_max3_f32 v140, v42, v43, v140
v_max3_f32 v140, v44, v45, v140
v_max3_f32 v140, v46, v47, v140
s_sub_u32 s48, s48, 1
s_cmp_lg_u32 s48, 0
s_cbranch_scc1 k3_kernel_mx
v_mov_b32 v3, v140
s_nop 1
v_permlane32_swap_b32 v140, v3
s_nop 1
v_max_f32 v140, v140, v3
v_sub_f32 v140, 0, v140
s_mov_b32 s50, 1
s_mov_b32 s37, 0
s_barrier
s_add_u32 m0, s40, 0
s_nop 0
buffer_load_dwordx4 v138, s[12:15], s37 offen lds
s_add_u32 m0, s40, 8192
s_nop 0
buffer_load_dwordx4 v138, s[16:19], s37 offen lds
s_add_u32 s37, s37, 8192
s_add_u32 m0, s40, 16384
s_nop 0
buffer_load_dwordx4 v138, s[12:15], s37 offen lds
s_add_u32 m0, s40, 24576
s_nop 0
buffer_load_dwordx4 v138, s[16:19], s37 offen lds
s_add_u32 s37, s37, 8192
s_branch k3_kernel_restart
k3_kernel_out:
v_rcp_f32 v2, v80
s_nop 0
v_mul_f32 v64, v64, v2
v_mul_f32 v65, v65, v2
v_mul_f32 v66, v66, v2
v_mul_f32 v67, v67, v2
v_mul_f32 v68, v68, v2
v_mul_f32 v69, v69, v2
v_mul_f32 v70, v70, v2
v_mul_f32 v71, v71, v2
v_mul_f32 v72, v72, v2
v_mul_f32 v73, v73, v2
v_mul_f32 v74, v74, v2
v_mul_f32 v75, v75, v2
v_mul_f32 v76, v76, v2
v_mul_f32 v77, v77, v2
v_mul_f32 v78, v78, v2
v_mul_f32 v79, v79, v2
v_cvt_pk_bf16_f32 v8, v64, v65
v_cvt_pk_bf16_f32 v9, v66, v67
v_cvt_pk_bf16_f32 v10, v68, v69
v_cvt_pk_bf16_f32 v11, v70, v71
v_cvt_pk_bf16_f32 v12, v72, v73
v_cvt_pk_bf16_f32 v13, v74, v75
v_cvt_pk_bf16_f32 v14, v76, v77
v_cvt_pk_bf16_f32 v15, v78, v79
v_and_b32 v3, 31, v139
v_lshrrev_b32 v4, 4, v3
v_lshlrev_b32 v4, 10, v4
v_and_b32 v5, 15, v3
v_lshl_add_u32 v4, v5, 4, v4
v_lshrrev_b32 v5, 5, v139
v_lshl_add_u32 v4, v5, 9, v4
s_lshl_b32 s3, s33, 17
s_lshl_b32 s10, s34, 11
s_add_u32 s3, s3, s10
s_add_u32 s3, s3, 12582912
buffer_store_dwordx4 v[8:11], v4, s[24:27], s3 offen sc1
buffer_store_dwordx4 v[12:15], v4, s[24:27], s3 offen offset:256 sc1
s_endpgm
k3_kernel_svc:
s_mov_b32 s24, s8
s_and_b32 s25, s9, 0xffff
s_mov_b32 s26, 67108864
s_mov_b32 s27, 0x00020000
v_lshlrev_b32 v9, 4, v139
s_load_dwordx2 s[34:35], s[0:1], 32
s_load_dwordx2 s[36:37], s[0:1], 64
s_load_dwordx2 s[44:45], s[0:1], 96
s_waitcnt lgkmcnt(0)
s_mov_b32 s40, s44
s_and_b32 s41, s45, 0xffff
s_mov_b32 s42, 256
s_mov_b32 s43, 0x00020000
s_cmp_ge_u32 s2, 224
s_cbranch_scc1 k3_kernel_sv3
s_cmp_ge_u32 s2, 64
s_cbranch_scc1 k3_kernel_sv2
s_barrier
s_and_b32 s3, s2, 31
s_lshl_b32 s3, s3, 6
s_cmp_ge_u32 s2, 32
s_cselect_b32 s38, 5, 2
s_lshl_b32 s38, s38, 11
s_add_u32 s38, s38, s3
s_add_u32 s12, s28, s38
s_addc_u32 s13, s29, 0
s_and_b32 s13, s13, 0xffff
s_sub_u32 s14, 12582912, s38
s_mov_b32 s15, 0x00020000
v_lshrrev_b32 v4, 2, v139
s_mov_b32 s3, 12288
v_mul_lo_u32 v4, v4, s3
v_and_b32 v5, 3, v139
v_lshl_add_u32 v4, v5, 4, v4
v_and_b32 v2, 15, v139
v_lshrrev_b32 v3, 4, v139
v_lshlrev_b32 v3, 4, v3
v_add_u32 v3, 49152, v3
v_cmp_eq_u32 vcc, 0, v2
v_mov_b32 v6, 0x7f000000
s_nop 0
v_cndmask_b32 v3, v6, v3, vcc
s_mov_b32 s10, 0
s_mov_b32 s11, 66560
v_lshrrev_b32 v6, 4, v139
v_bfe_u32 v5, v139, 2, 2
v_lshl_add_u32 v5, v6, 3, v5
v_lshlrev_b32 v5, 6, v5
v_and_b32 v6, 3, v139
v_lshl_add_u32 v5, v6, 3, v5
v_add_u32 v5, 66560, v5
v_mov_b32 v112, 0
v_mov_b32 v113, 0
v_mov_b32 v114, 0
v_mov_b32 v115, 0
v_mov_b32 v116, 0
v_mov_b32 v117, 0
v_mov_b32 v118, 0
v_mov_b32 v119, 0
buffer_load_dwordx4 v[48:51], v3, s[24:27], 0 offen offset:0
buffer_load_dwordx4 v[52:55], v3, s[24:27], 0 offen offset:64
buffer_load_dwordx4 v[56:59], v3, s[24:27], 0 offen offset:128
buffer_load_dwordx4 v[60:63], v3, s[24:27], 0 offen offset:192
buffer_load_dwordx4 v[64:67], v3, s[24:27], 0 offen offset:256
buffer_load_dwordx4 v[68:71], v3, s[24:27], 0 offen offset:320
buffer_load_dwordx4 v[72:75], v3, s[24:27], 0 offen offset:384
buffer_load_dwordx4 v[76:79], v3, s[24:27], 0 offen offset:448
buffer_load_dwordx4 v[80:83], v3, s[24:27], 0 offen offset:512
buffer_load_dwordx4 v[84:87], v3, s[24:27], 0 offen offset:576
buffer_load_dwordx4 v[88:91], v3, s[24:27], 0 offen offset:640
buffer_load_dwordx4 v[92:95], v3, s[24:27], 0 offen offset:704
buffer_load_dwordx4 v[96:99], v3, s[24:27], 0 offen offset:768
buffer_load_dwordx4 v[100:103], v3, s[24:27], 0 offen offset:832
buffer_load_dwordx4 v[104:107], v3, s[24:27], 0 offen offset:896
buffer_load_dwordx4 v[108:111], v3, s[24:27], 0 offen offset:960
s_mov_b32 s49, 24
k3_kernel_m_svd0:
s_mov_b32 m0, s11
s_add_u32 s11, s11, 1024
buffer_load_dwordx4 v4, s[12:15], s10 offen lds
s_add_u32 s10, s10, 196608
s_sub_u32 s49, s49, 1
s_cmp_lg_u32 s49, 0
s_cbranch_scc1 k3_kernel_m_svd0
s_barrier
s_mov_b32 s49, 24
k3_kernel_m_svd1:
s_mov_b32 m0, s11
s_add_u32 s11, s11, 1024
buffer_load_dwordx4 v4, s[12:15], s10 offen lds
s_add_u32 s10, s10, 196608
s_sub_u32 s49, s49, 1
s_cmp_lg_u32 s49, 0
s_cbranch_scc1 k3_kernel_m_svd1
s_barrier
s_mov_b32 s49, 16
k3_kernel_m_svd2:
s_mov_b32 m0, s11
s_add_u32 s11, s11, 1024
buffer_load_dwordx4 v4, s[12:15], s10 offen lds
s_add_u32 s10, s10, 196608
s_sub_u32 s49, s49, 1
s_cmp_lg_u32 s49, 0
s_cbranch_scc1 k3_kernel_m_svd2
s_barrier
s_mov_b32 s20, s34
s_and_b32 s21, s35, 0xffff
s_mov_b32 s22, 2097152
s_mov_b32 s23, 0x00020000
s_lshl_b32 s30, s2, 13
s_mov_b32 m0, 132096
s_mov_b32 s49, 8
k3_kernel_pf0:
buffer_load_dwordx4 v9, s[20:23], s30 offen lds
s_add_u32 s30, s30, 1024
s_sub_u32 s49, s49, 1
s_cmp_lg_u32 s49, 0
s_cbranch_scc1 k3_kernel_pf0
s_barrier
s_barrier
s_barrier
s_waitcnt vmcnt(8)
ds_read_b64_tr_b16 v[16:17], v5 offset:0
ds_read_b64_tr_b16 v[18:19], v5 offset:256
ds_read_b64_tr_b16 v[20:21], v5 offset:32
ds_read_b64_tr_b16 v[22:23], v5 offset:288
ds_read_b64_tr_b16 v[24:25], v5 offset:2048
ds_read_b64_tr_b16 v[26:27], v5 offset:2304
ds_read_b64_tr_b16 v[28:29], v5 offset:2080
ds_read_b64_tr_b16 v[30:31], v5 offset:2336
ds_read_b64_tr_b16 v[32:33], v5 offset:4096
ds_read_b64_tr_b16 v[34:35], v5 offset:4352
ds_read_b64_tr_b16 v[36:37], v5 offset:4128
ds_read_b64_tr_b16 v[38:39], v5 offset:4384
ds_read_b64_tr_b16 v[40:41], v5 offset:6144
ds_read_b64_tr_b16 v[42:43], v5 offset:6400
ds_read_b64_tr_b16 v[44:45], v5 offset:6176
ds_read_b64_tr_b16 v[46:47], v5 offset:6432
s_waitcnt lgkmcnt(0)
v_mfma_f32_16x16x32_bf16 v[112:115], v[16:19], v[48:51], v[112:115]
v_mfma_f32_16x16x32_bf16 v[116:119], v[20:23], v[48:51], v[116:119]
v_mfma_f32_16x16x32_bf16 v[112:115], v[24:27], v[52:55], v[112:115]
v_mfma_f32_16x16x32_bf16 v[116:119], v[28:31], v[52:55], v[116:119]
v_mfma_f32_16x16x32_bf16 v[112:115], v[32:35], v[56:59], v[112:115]
v_mfma_f32_16x16x32_bf16 v[116:119], v[36:39], v[56:59], v[116:119]
v_mfma_f32_16x16x32_bf16 v[112:115], v[40:43], v[60:63], v[112:115]
v_mfma_f32_16x16x32_bf16 v[116:119], v[44:47], v[60:63], v[116:119]
ds_read_b64_tr_b16 v[16:17], v5 offset:8192
ds_read_b64_tr_b16 v[18:19], v5 offset:8448
ds_read_b64_tr_b16 v[20:21], v5 offset:8224
ds_read_b64_tr_b16 v[22:23], v5 offset:8480
ds_read_b64_tr_b16 v[24:25], v5 offset:10240
ds_read_b64_tr_b16 v[26:27], v5 offset:10496
ds_read_b64_tr_b16 v[28:29], v5 offset:10272
ds_read_b64_tr_b16 v[30:31], v5 offset:10528
ds_read_b64_tr_b16 v[32:33], v5 offset:12288
ds_read_b64_tr_b16 v[34:35], v5 offset:12544
ds_read_b64_tr_b16 v[36:37], v5 offset:12320
ds_read_b64_tr_b16 v[38:39], v5 offset:12576
ds_read_b64_tr_b16 v[40:41], v5 offset:14336
ds_read_b64_tr_b16 v[42:43], v5 offset:14592
ds_read_b64_tr_b16 v[44:45], v5 offset:14368
ds_read_b64_tr_b16 v[46:47], v5 offset:14624
s_waitcnt lgkmcnt(0)
v_mfma_f32_16x16x32_bf16 v[112:115], v[16:19], v[64:67], v[112:115]
v_mfma_f32_16x16x32_bf16 v[116:119], v[20:23], v[64:67], v[116:119]
v_mfma_f32_16x16x32_bf16 v[112:115], v[24:27], v[68:71], v[112:115]
v_mfma_f32_16x16x32_bf16 v[116:119], v[28:31], v[68:71], v[116:119]
v_mfma_f32_16x16x32_bf16 v[112:115], v[32:35], v[72:75], v[112:115]
v_mfma_f32_16x16x32_bf16 v[116:119], v[36:39], v[72:75], v[116:119]
v_mfma_f32_16x16x32_bf16 v[112:115], v[40:43], v[76:79], v[112:115]
v_mfma_f32_16x16x32_bf16 v[116:119], v[44:47], v[76:79], v[116:119]
ds_read_b64_tr_b16 v[16:17], v5 offset:16384
ds_read_b64_tr_b16 v[18:19], v5 offset:16640
ds_read_b64_tr_b16 v[20:21], v5 offset:16416
ds_read_b64_tr_b16 v[22:23], v5 offset:16672
ds_read_b64_tr_b16 v[24:25], v5 offset:18432
ds_read_b64_tr_b16 v[26:27], v5 offset:18688
ds_read_b64_tr_b16 v[28:29], v5 offset:18464
ds_read_b64_tr_b16 v[30:31], v5 offset:18720
ds_read_b64_tr_b16 v[32:33], v5 offset:20480
ds_read_b64_tr_b16 v[34:35], v5 offset:20736
ds_read_b64_tr_b16 v[36:37], v5 offset:20512
ds_read_b64_tr_b16 v[38:39], v5 offset:20768
ds_read_b64_tr_b16 v[40:41], v5 offset:22528
ds_read_b64_tr_b16 v[42:43], v5 offset:22784
ds_read_b64_tr_b16 v[44:45], v5 offset:22560
ds_read_b64_tr_b16 v[46:47], v5 offset:22816
s_waitcnt lgkmcnt(0)
v_mfma_f32_16x16x32_bf16 v[112:115], v[16:19], v[80:83], v[112:115]
v_mfma_f32_16x16x32_bf16 v[116:119], v[20:23], v[80:83], v[116:119]
v_mfma_f32_16x16x32_bf16 v[112:115], v[24:27], v[84:87], v[112:115]
v_mfma_f32_16x16x32_bf16 v[116:119], v[28:31], v[84:87], v[116:119]
v_mfma_f32_16x16x32_bf16 v[112:115], v[32:35], v[88:91], v[112:115]
v_mfma_f32_16x16x32_bf16 v[116:119], v[36:39], v[88:91], v[116:119]
v_mfma_f32_16x16x32_bf16 v[112:115], v[40:43], v[92:95], v[112:115]
v_mfma_f32_16x16x32_bf16 v[116:119], v[44:47], v[92:95], v[116:119]
ds_read_b64_tr_b16 v[16:17], v5 offset:24576
ds_read_b64_tr_b16 v[18:19], v5 offset:24832
ds_read_b64_tr_b16 v[20:21], v5 offset:24608
ds_read_b64_tr_b16 v[22:23], v5 offset:24864
ds_read_b64_tr_b16 v[24:25], v5 offset:26624
ds_read_b64_tr_b16 v[26:27], v5 offset:26880
ds_read_b64_tr_b16 v[28:29], v5 offset:26656
ds_read_b64_tr_b16 v[30:31], v5 offset:26912
ds_read_b64_tr_b16 v[32:33], v5 offset:28672
ds_read_b64_tr_b16 v[34:35], v5 offset:28928
ds_read_b64_tr_b16 v[36:37], v5 offset:28704
ds_read_b64_tr_b16 v[38:39], v5 offset:28960
ds_read_b64_tr_b16 v[40:41], v5 offset:30720
ds_read_b64_tr_b16 v[42:43], v5 offset:30976
ds_read_b64_tr_b16 v[44:45], v5 offset:30752
ds_read_b64_tr_b16 v[46:47], v5 offset:31008
s_waitcnt lgkmcnt(0)
v_mfma_f32_16x16x32_bf16 v[112:115], v[16:19], v[96:99], v[112:115]
v_mfma_f32_16x16x32_bf16 v[116:119], v[20:23], v[96:99], v[116:119]
v_mfma_f32_16x16x32_bf16 v[112:115], v[24:27], v[100:103], v[112:115]
v_mfma_f32_16x16x32_bf16 v[116:119], v[28:31], v[100:103], v[116:119]
v_mfma_f32_16x16x32_bf16 v[112:115], v[32:35], v[104:107], v[112:115]
v_mfma_f32_16x16x32_bf16 v[116:119], v[36:39], v[104:107], v[116:119]
v_mfma_f32_16x16x32_bf16 v[112:115], v[40:43], v[108:111], v[112:115]
v_mfma_f32_16x16x32_bf16 v[116:119], v[44:47], v[108:111], v[116:119]
buffer_load_dwordx4 v[48:51], v3, s[24:27], 0 offen offset:1024
buffer_load_dwordx4 v[52:55], v3, s[24:27], 0 offen offset:1088
buffer_load_dwordx4 v[56:59], v3, s[24:27], 0 offen offset:1152
buffer_load_dwordx4 v[60:63], v3, s[24:27], 0 offen offset:1216
buffer_load_dwordx4 v[64:67], v3, s[24:27], 0 offen offset:1280
buffer_load_dwordx4 v[68:71], v3, s[24:27], 0 offen offset:1344
buffer_load_dwordx4 v[72:75], v3, s[24:27], 0 offen offset:1408
buffer_load_dwordx4 v[76:79], v3, s[24:27], 0 offen offset:1472
buffer_load_dwordx4 v[80:83], v3, s[24:27], 0 offen offset:1536
buffer_load_dwordx4 v[84:87], v3, s[24:27], 0 offen offset:1600
buffer_load_dwordx4 v[88:91], v3, s[24:27], 0 offen offset:1664
buffer_load_dwordx4 v[92:95], v3, s[24:27], 0 offen offset:1728
buffer_load_dwordx4 v[96:99], v3, s[24:27], 0 offen offset:1792
buffer_load_dwordx4 v[100:103], v3, s[24:27], 0 offen offset:1856
buffer_load_dwordx4 v[104:107], v3, s[24:27], 0 offen offset:1920
buffer_load_dwordx4 v[108:111], v3, s[24:27], 0 offen offset:1984
s_barrier
s_waitcnt vmcnt(0)
ds_read_b64_tr_b16 v[16:17], v5 offset:32768
ds_read_b64_tr_b16 v[18:19], v5 offset:33024
ds_read_b64_tr_b16 v[20:21], v5 offset:32800
ds_read_b64_tr_b16 v[22:23], v5 offset:33056
ds_read_b64_tr_b16 v[24:25], v5 offset:34816
ds_read_b64_tr_b16 v[26:27], v5 offset:35072
ds_read_b64_tr_b16 v[28:29], v5 offset:34848
ds_read_b64_tr_b16 v[30:31], v5 offset:35104
ds_read_b64_tr_b16 v[32:33], v5 offset:36864
ds_read_b64_tr_b16 v[34:35], v5 offset:37120
ds_read_b64_tr_b16 v[36:37], v5 offset:36896
ds_read_b64_tr_b16 v[38:39], v5 offset:37152
ds_read_b64_tr_b16 v[40:41], v5 offset:38912
ds_read_b64_tr_b16 v[42:43], v5 offset:39168
ds_read_b64_tr_b16 v[44:45], v5 offset:38944
ds_read_b64_tr_b16 v[46:47], v5 offset:39200
s_waitcnt lgkmcnt(0)
v_mfma_f32_16x16x32_bf16 v[112:115], v[16:19], v[48:51], v[112:115]
v_mfma_f32_16x16x32_bf16 v[116:119], v[20:23], v[48:51], v[116:119]
v_mfma_f32_16x16x32_bf16 v[112:115], v[24:27], v[52:55], v[112:115]
v_mfma_f32_16x16x32_bf16 v[116:119], v[28:31], v[52:55], v[116:119]
v_mfma_f32_16x16x32_bf16 v[112:115], v[32:35], v[56:59], v[112:115]
v_mfma_f32_16x16x32_bf16 v[116:119], v[36:39], v[56:59], v[116:119]
v_mfma_f32_16x16x32_bf16 v[112:115], v[40:43], v[60:63], v[112:115]
v_mfma_f32_16x16x32_bf16 v[116:119], v[44:47], v[60:63], v[116:119]
ds_read_b64_tr_b16 v[16:17], v5 offset:40960
ds_read_b64_tr_b16 v[18:19], v5 offset:41216
ds_read_b64_tr_b16 v[20:21], v5 offset:40992
ds_read_b64_tr_b16 v[22:23], v5 offset:41248
ds_read_b64_tr_b16 v[24:25], v5 offset:43008
ds_read_b64_tr_b16 v[26:27], v5 offset:43264
ds_read_b64_tr_b16 v[28:29], v5 offset:43040
ds_read_b64_tr_b16 v[30:31], v5 offset:43296
ds_read_b64_tr_b16 v[32:33], v5 offset:45056
ds_read_b64_tr_b16 v[34:35], v5 offset:45312
ds_read_b64_tr_b16 v[36:37], v5 offset:45088
ds_read_b64_tr_b16 v[38:39], v5 offset:45344
ds_read_b64_tr_b16 v[40:41], v5 offset:47104
ds_read_b64_tr_b16 v[42:43], v5 offset:47360
ds_read_b64_tr_b16 v[44:45], v5 offset:47136
ds_read_b64_tr_b16 v[46:47], v5 offset:47392
s_waitcnt lgkmcnt(0)
v_mfma_f32_16x16x32_bf16 v[112:115], v[16:19], v[64:67], v[112:115]
v_mfma_f32_16x16x32_bf16 v[116:119], v[20:23], v[64:67], v[116:119]
v_mfma_f32_16x16x32_bf16 v[112:115], v[24:27], v[68:71], v[112:115]
v_mfma_f32_16x16x32_bf16 v[116:119], v[28:31], v[68:71], v[116:119]
v_mfma_f32_16x16x32_bf16 v[112:115], v[32:35], v[72:75], v[112:115]
v_mfma_f32_16x16x32_bf16 v[116:119], v[36:39], v[72:75], v[116:119]
v_mfma_f32_16x16x32_bf16 v[112:115], v[40:43], v[76:79], v[112:115]
v_mfma_f32_16x16x32_bf16 v[116:119], v[44:47], v[76:79], v[116:119]
ds_read_b64_tr_b16 v[16:17], v5 offset:49152
ds_read_b64_tr_b16 v[18:19], v5 offset:49408
ds_read_b64_tr_b16 v[20:21], v5 offset:49184
ds_read_b64_tr_b16 v[22:23], v5 offset:49440
ds_read_b64_tr_b16 v[24:25], v5 offset:51200
ds_read_b64_tr_b16 v[26:27], v5 offset:51456
ds_read_b64_tr_b16 v[28:29], v5 offset:51232
ds_read_b64_tr_b16 v[30:31], v5 offset:51488
ds_read_b64_tr_b16 v[32:33], v5 offset:53248
ds_read_b64_tr_b16 v[34:35], v5 offset:53504
ds_read_b64_tr_b16 v[36:37], v5 offset:53280
ds_read_b64_tr_b16 v[38:39], v5 offset:53536
ds_read_b64_tr_b16 v[40:41], v5 offset:55296
ds_read_b64_tr_b16 v[42:43], v5 offset:55552
ds_read_b64_tr_b16 v[44:45], v5 offset:55328
ds_read_b64_tr_b16 v[46:47], v5 offset:55584
s_waitcnt lgkmcnt(0)
v_mfma_f32_16x16x32_bf16 v[112:115], v[16:19], v[80:83], v[112:115]
v_mfma_f32_16x16x32_bf16 v[116:119], v[20:23], v[80:83], v[116:119]
v_mfma_f32_16x16x32_bf16 v[112:115], v[24:27], v[84:87], v[112:115]
v_mfma_f32_16x16x32_bf16 v[116:119], v[28:31], v[84:87], v[116:119]
v_mfma_f32_16x16x32_bf16 v[112:115], v[32:35], v[88:91], v[112:115]
v_mfma_f32_16x16x32_bf16 v[116:119], v[36:39], v[88:91], v[116:119]
v_mfma_f32_16x16x32_bf16 v[112:115], v[40:43], v[92:95], v[112:115]
v_mfma_f32_16x16x32_bf16 v[116:119], v[44:47], v[92:95], v[116:119]
ds_read_b64_tr_b16 v[16:17], v5 offset:57344
ds_read_b64_tr_b16 v[18:19], v5 offset:57600
ds_read_b64_tr_b16 v[20:21], v5 offset:57376
ds_read_b64_tr_b16 v[22:23], v5 offset:57632
ds_read_b64_tr_b16 v[24:25], v5 offset:59392
ds_read_b64_tr_b16 v[26:27], v5 offset:59648
ds_read_b64_tr_b16 v[28:29], v5 offset:59424
ds_read_b64_tr_b16 v[30:31], v5 offset:59680
ds_read_b64_tr_b16 v[32:33], v5 offset:61440
ds_read_b64_tr_b16 v[34:35], v5 offset:61696
ds_read_b64_tr_b16 v[36:37], v5 offset:61472
ds_read_b64_tr_b16 v[38:39], v5 offset:61728
ds_read_b64_tr_b16 v[40:41], v5 offset:63488
ds_read_b64_tr_b16 v[42:43], v5 offset:63744
ds_read_b64_tr_b16 v[44:45], v5 offset:63520
ds_read_b64_tr_b16 v[46:47], v5 offset:63776
s_waitcnt lgkmcnt(0)
v_mfma_f32_16x16x32_bf16 v[112:115], v[16:19], v[96:99], v[112:115]
v_mfma_f32_16x16x32_bf16 v[116:119], v[20:23], v[96:99], v[116:119]
v_mfma_f32_16x16x32_bf16 v[112:115], v[24:27], v[100:103], v[112:115]
v_mfma_f32_16x16x32_bf16 v[116:119], v[28:31], v[100:103], v[116:119]
v_mfma_f32_16x16x32_bf16 v[112:115], v[32:35], v[104:107], v[112:115]
v_mfma_f32_16x16x32_bf16 v[116:119], v[36:39], v[104:107], v[116:119]
v_mfma_f32_16x16x32_bf16 v[112:115], v[40:43], v[108:111], v[112:115]
v_mfma_f32_16x16x32_bf16 v[116:119], v[44:47], v[108:111], v[116:119]
s_nop 7
s_nop 1
v_cvt_pk_bf16_f32 v112, v112, v112
v_lshlrev_b32 v112, 16, v112
v_cvt_pk_bf16_f32 v113, v113, v113
v_lshlrev_b32 v113, 16, v113
v_cvt_pk_bf16_f32 v114, v114, v114
v_lshlrev_b32 v114, 16, v114
v_cvt_pk_bf16_f32 v115, v115, v115
v_lshlrev_b32 v115, 16, v115
v_cvt_pk_bf16_f32 v116, v116, v116
v_lshlrev_b32 v116, 16, v116
v_cvt_pk_bf16_f32 v117, v117, v117
v_lshlrev_b32 v117, 16, v117
v_cvt_pk_bf16_f32 v118, v118, v118
v_lshlrev_b32 v118, 16, v118
v_cvt_pk_bf16_f32 v119, v119, v119
v_lshlrev_b32 v119, 16, v119
v_lshrrev_b32 v6, 4, v139
v_lshlrev_b32 v7, 4, v6
s_lshl_b32 s3, s38, 1
s_add_u32 s3, s3, 0
v_cmp_eq_u32 vcc, 0, v2
s_and_saveexec_b64 s[30:31], vcc
buffer_store_dwordx4 v[112:115], v7, s[24:27], s3 offen sc1
buffer_store_dwordx4 v[116:119], v7, s[24:27], s3 offen offset:64 sc1
s_mov_b64 exec, s[30:31]
s_lshl_b32 s53, s2, 1
s_sub_u32 s3, s53, 127
s_cmp_ge_u32 s2, 64
s_cselect_b32 s53, s3, s53
s_cmp_ge_u32 s2, 128
s_cselect_b32 s53, s2, s53
s_cmp_ge_u32 s53, 112
s_cselect_b32 s47, 1, 0
s_cselect_b32 s12, s6, s4
s_cselect_b32 s13, s7, s5
s_mul_i32 s3, s47, 112
s_sub_u32 s48, s53, s3
s_lshl_b32 s3, s48, 6
s_add_u32 s12, s12, s3
s_addc_u32 s13, s13, 0
s_and_b32 s13, s13, 0xffff
s_sub_u32 s14, 7340032, s3
s_mov_b32 s15, 0x00020000
v_lshrrev_b32 v4, 2, v139
s_mov_b32 s3, 7168
v_mul_lo_u32 v4, v4, s3
v_and_b32 v5, 3, v139
v_lshl_add_u32 v4, v5, 4, v4
v_and_b32 v2, 15, v139
v_lshrrev_b32 v3, 4, v139
v_lshlrev_b32 v3, 4, v3
v_lshlrev_b32 v6, 11, v2
v_sub_u32 v3, v3, v6
v_add_u32 v3, 40960, v3
v_cmp_gt_u32 vcc, 2, v2
v_mov_b32 v6, 0x7f000000
s_nop 0
v_cndmask_b32 v3, v6, v3, vcc
s_mov_b32 s10, 0
s_mov_b32 s11, 66560
v_lshrrev_b32 v6, 4, v139
v_bfe_u32 v5, v139, 2, 2
v_lshl_add_u32 v5, v6, 3, v5
v_lshlrev_b32 v5, 6, v5
v_and_b32 v6, 3, v139
v_lshl_add_u32 v5, v6, 3, v5
v_add_u32 v5, 66560, v5
v_mov_b32 v112, 0
v_mov_b32 v113, 0
v_mov_b32 v114, 0
v_mov_b32 v115, 0
v_mov_b32 v116, 0
v_mov_b32 v117, 0
v_mov_b32 v118, 0
v_mov_b32 v119, 0
buffer_load_dwordx4 v[48:51], v3, s[24:27], 0 offen offset:0
buffer_load_dwordx4 v[52:55], v3, s[24:27], 0 offen offset:64
buffer_load_dwordx4 v[56:59], v3, s[24:27], 0 offen offset:128
buffer_load_dwordx4 v[60:63], v3, s[24:27], 0 offen offset:192
buffer_load_dwordx4 v[64:67], v3, s[24:27], 0 offen offset:256
buffer_load_dwordx4 v[68:71], v3, s[24:27], 0 offen offset:320
buffer_load_dwordx4 v[72:75], v3, s[24:27], 0 offen offset:384
buffer_load_dwordx4 v[76:79], v3, s[24:27], 0 offen offset:448
buffer_load_dwordx4 v[80:83], v3, s[24:27], 0 offen offset:512
buffer_load_dwordx4 v[84:87], v3, s[24:27], 0 offen offset:576
buffer_load_dwordx4 v[88:91], v3, s[24:27], 0 offen offset:640
buffer_load_dwordx4 v[92:95], v3, s[24:27], 0 offen offset:704
buffer_load_dwordx4 v[96:99], v3, s[24:27], 0 offen offset:768
buffer_load_dwordx4 v[100:103], v3, s[24:27], 0 offen offset:832
buffer_load_dwordx4 v[104:107], v3, s[24:27], 0 offen offset:896
buffer_load_dwordx4 v[108:111], v3, s[24:27], 0 offen offset:960
s_mov_b32 s49, 16
k3_kernel_u1_svd0:
s_mov_b32 m0, s11
s_add_u32 s11, s11, 1024
buffer_load_dwordx4 v4, s[12:15], s10 offen lds
s_add_u32 s10, s10, 114688
s_sub_u32 s49, s49, 1
s_cmp_lg_u32 s49, 0
s_cbranch_scc1 k3_kernel_u1_svd0
s_barrier
s_mov_b32 s49, 24
k3_kernel_u1_svd1:
s_mov_b32 m0, s11
s_add_u32 s11, s11, 1024
buffer_load_dwordx4 v4, s[12:15], s10 offen lds
s_add_u32 s10, s10, 114688
s_sub_u32 s49, s49, 1
s_cmp_lg_u32 s49, 0
s_cbranch_scc1 k3_kernel_u1_svd1
s_barrier
s_mov_b32 s49, 24
k3_kernel_u1_svd2:
s_mov_b32 m0, s11
s_add_u32 s11, s11, 1024
buffer_load_dwordx4 v4, s[12:15], s10 offen lds
s_add_u32 s10, s10, 114688
s_sub_u32 s49, s49, 1
s_cmp_lg_u32 s49, 0
s_cbranch_scc1 k3_kernel_u1_svd2
s_barrier
s_barrier
s_barrier
s_barrier
s_waitcnt vmcnt(0)
ds_read_b64_tr_b16 v[16:17], v5 offset:0
ds_read_b64_tr_b16 v[18:19], v5 offset:256
ds_read_b64_tr_b16 v[20:21], v5 offset:32
ds_read_b64_tr_b16 v[22:23], v5 offset:288
ds_read_b64_tr_b16 v[24:25], v5 offset:2048
ds_read_b64_tr_b16 v[26:27], v5 offset:2304
ds_read_b64_tr_b16 v[28:29], v5 offset:2080
ds_read_b64_tr_b16 v[30:31], v5 offset:2336
ds_read_b64_tr_b16 v[32:33], v5 offset:4096
ds_read_b64_tr_b16 v[34:35], v5 offset:4352
ds_read_b64_tr_b16 v[36:37], v5 offset:4128
ds_read_b64_tr_b16 v[38:39], v5 offset:4384
ds_read_b64_tr_b16 v[40:41], v5 offset:6144
ds_read_b64_tr_b16 v[42:43], v5 offset:6400
ds_read_b64_tr_b16 v[44:45], v5 offset:6176
ds_read_b64_tr_b16 v[46:47], v5 offset:6432
s_waitcnt lgkmcnt(0)
v_mfma_f32_16x16x32_bf16 v[112:115], v[16:19], v[48:51], v[112:115]
v_mfma_f32_16x16x32_bf16 v[116:119], v[20:23], v[48:51], v[116:119]
v_mfma_f32_16x16x32_bf16 v[112:115], v[24:27], v[52:55], v[112:115]
v_mfma_f32_16x16x32_bf16 v[116:119], v[28:31], v[52:55], v[116:119]
v_mfma_f32_16x16x32_bf16 v[112:115], v[32:35], v[56:59], v[112:115]
v_mfma_f32_16x16x32_bf16 v[116:119], v[36:39], v[56:59], v[116:119]
v_mfma_f32_16x16x32_bf16 v[112:115], v[40:43], v[60:63], v[112:115]
v_mfma_f32_16x16x32_bf16 v[116:119], v[44:47], v[60:63], v[116:119]
ds_read_b64_tr_b16 v[16:17], v5 offset:8192
ds_read_b64_tr_b16 v[18:19], v5 offset:8448
ds_read_b64_tr_b16 v[20:21], v5 offset:8224
ds_read_b64_tr_b16 v[22:23], v5 offset:8480
ds_read_b64_tr_b16 v[24:25], v5 offset:10240
ds_read_b64_tr_b16 v[26:27], v5 offset:10496
ds_read_b64_tr_b16 v[28:29], v5 offset:10272
ds_read_b64_tr_b16 v[30:31], v5 offset:10528
ds_read_b64_tr_b16 v[32:33], v5 offset:12288
ds_read_b64_tr_b16 v[34:35], v5 offset:12544
ds_read_b64_tr_b16 v[36:37], v5 offset:12320
ds_read_b64_tr_b16 v[38:39], v5 offset:12576
ds_read_b64_tr_b16 v[40:41], v5 offset:14336
ds_read_b64_tr_b16 v[42:43], v5 offset:14592
ds_read_b64_tr_b16 v[44:45], v5 offset:14368
ds_read_b64_tr_b16 v[46:47], v5 offset:14624
s_waitcnt lgkmcnt(0)
v_mfma_f32_16x16x32_bf16 v[112:115], v[16:19], v[64:67], v[112:115]
v_mfma_f32_16x16x32_bf16 v[116:119], v[20:23], v[64:67], v[116:119]
v_mfma_f32_16x16x32_bf16 v[112:115], v[24:27], v[68:71], v[112:115]
v_mfma_f32_16x16x32_bf16 v[116:119], v[28:31], v[68:71], v[116:119]
v_mfma_f32_16x16x32_bf16 v[112:115], v[32:35], v[72:75], v[112:115]
v_mfma_f32_16x16x32_bf16 v[116:119], v[36:39], v[72:75], v[116:119]
v_mfma_f32_16x16x32_bf16 v[112:115], v[40:43], v[76:79], v[112:115]
v_mfma_f32_16x16x32_bf16 v[116:119], v[44:47], v[76:79], v[116:119]
ds_read_b64_tr_b16 v[16:17], v5 offset:16384
ds_read_b64_tr_b16 v[18:19], v5 offset:16640
ds_read_b64_tr_b16 v[20:21], v5 offset:16416
ds_read_b64_tr_b16 v[22:23], v5 offset:16672
ds_read_b64_tr_b16 v[24:25], v5 offset:18432
ds_read_b64_tr_b16 v[26:27], v5 offset:18688
ds_read_b64_tr_b16 v[28:29], v5 offset:18464
ds_read_b64_tr_b16 v[30:31], v5 offset:18720
ds_read_b64_tr_b16 v[32:33], v5 offset:20480
ds_read_b64_tr_b16 v[34:35], v5 offset:20736
ds_read_b64_tr_b16 v[36:37], v5 offset:20512
ds_read_b64_tr_b16 v[38:39], v5 offset:20768
ds_read_b64_tr_b16 v[40:41], v5 offset:22528
ds_read_b64_tr_b16 v[42:43], v5 offset:22784
ds_read_b64_tr_b16 v[44:45], v5 offset:22560
ds_read_b64_tr_b16 v[46:47], v5 offset:22816
s_waitcnt lgkmcnt(0)
v_mfma_f32_16x16x32_bf16 v[112:115], v[16:19], v[80:83], v[112:115]
v_mfma_f32_16x16x32_bf16 v[116:119], v[20:23], v[80:83], v[116:119]
v_mfma_f32_16x16x32_bf16 v[112:115], v[24:27], v[84:87], v[112:115]
v_mfma_f32_16x16x32_bf16 v[116:119], v[28:31], v[84:87], v[116:119]
v_mfma_f32_16x16x32_bf16 v[112:115], v[32:35], v[88:91], v[112:115]
v_mfma_f32_16x16x32_bf16 v[116:119], v[36:39], v[88:91], v[116:119]
v_mfma_f32_16x16x32_bf16 v[112:115], v[40:43], v[92:95], v[112:115]
v_mfma_f32_16x16x32_bf16 v[116:119], v[44:47], v[92:95], v[116:119]
ds_read_b64_tr_b16 v[16:17], v5 offset:24576
ds_read_b64_tr_b16 v[18:19], v5 offset:24832
ds_read_b64_tr_b16 v[20:21], v5 offset:24608
ds_read_b64_tr_b16 v[22:23], v5 offset:24864
ds_read_b64_tr_b16 v[24:25], v5 offset:26624
ds_read_b64_tr_b16 v[26:27], v5 offset:26880
ds_read_b64_tr_b16 v[28:29], v5 offset:26656
ds_read_b64_tr_b16 v[30:31], v5 offset:26912
ds_read_b64_tr_b16 v[32:33], v5 offset:28672
ds_read_b64_tr_b16 v[34:35], v5 offset:28928
ds_read_b64_tr_b16 v[36:37], v5 offset:28704
ds_read_b64_tr_b16 v[38:39], v5 offset:28960
ds_read_b64_tr_b16 v[40:41], v5 offset:30720
ds_read_b64_tr_b16 v[42:43], v5 offset:30976
ds_read_b64_tr_b16 v[44:45], v5 offset:30752
ds_read_b64_tr_b16 v[46:47], v5 offset:31008
s_waitcnt lgkmcnt(0)
v_mfma_f32_16x16x32_bf16 v[112:115], v[16:19], v[96:99], v[112:115]
v_mfma_f32_16x16x32_bf16 v[116:119], v[20:23], v[96:99], v[116:119]
v_mfma_f32_16x16x32_bf16 v[112:115], v[24:27], v[100:103], v[112:115]
v_mfma_f32_16x16x32_bf16 v[116:119], v[28:31], v[100:103], v[116:119]
v_mfma_f32_16x16x32_bf16 v[112:115], v[32:35], v[104:107], v[112:115]
v_mfma_f32_16x16x32_bf16 v[116:119], v[36:39], v[104:107], v[116:119]
v_mfma_f32_16x16x32_bf16 v[112:115], v[40:43], v[108:111], v[112:115]
v_mfma_f32_16x16x32_bf16 v[116:119], v[44:47], v[108:111], v[116:119]
buffer_load_dwordx4 v[48:51], v3, s[24:27], 0 offen offset:1024
buffer_load_dwordx4 v[52:55], v3, s[24:27], 0 offen offset:1088
buffer_load_dwordx4 v[56:59], v3, s[24:27], 0 offen offset:1152
buffer_load_dwordx4 v[60:63], v3, s[24:27], 0 offen offset:1216
buffer_load_dwordx4 v[64:67], v3, s[24:27], 0 offen offset:1280
buffer_load_dwordx4 v[68:71], v3, s[24:27], 0 offen offset:1344
buffer_load_dwordx4 v[72:75], v3, s[24:27], 0 offen offset:1408
buffer_load_dwordx4 v[76:79], v3, s[24:27], 0 offen offset:1472
buffer_load_dwordx4 v[80:83], v3, s[24:27], 0 offen offset:1536
buffer_load_dwordx4 v[84:87], v3, s[24:27], 0 offen offset:1600
buffer_load_dwordx4 v[88:91], v3, s[24:27], 0 offen offset:1664
buffer_load_dwordx4 v[92:95], v3, s[24:27], 0 offen offset:1728
buffer_load_dwordx4 v[96:99], v3, s[24:27], 0 offen offset:1792
buffer_load_dwordx4 v[100:103], v3, s[24:27], 0 offen offset:1856
buffer_load_dwordx4 v[104:107], v3, s[24:27], 0 offen offset:1920
buffer_load_dwordx4 v[108:111], v3, s[24:27], 0 offen offset:1984
s_barrier
s_barrier
s_waitcnt vmcnt(0)
ds_read_b64_tr_b16 v[16:17], v5 offset:32768
ds_read_b64_tr_b16 v[18:19], v5 offset:33024
ds_read_b64_tr_b16 v[20:21], v5 offset:32800
ds_read_b64_tr_b16 v[22:23], v5 offset:33056
ds_read_b64_tr_b16 v[24:25], v5 offset:34816
ds_read_b64_tr_b16 v[26:27], v5 offset:35072
ds_read_b64_tr_b16 v[28:29], v5 offset:34848
ds_read_b64_tr_b16 v[30:31], v5 offset:35104
ds_read_b64_tr_b16 v[32:33], v5 offset:36864
ds_read_b64_tr_b16 v[34:35], v5 offset:37120
ds_read_b64_tr_b16 v[36:37], v5 offset:36896
ds_read_b64_tr_b16 v[38:39], v5 offset:37152
ds_read_b64_tr_b16 v[40:41], v5 offset:38912
ds_read_b64_tr_b16 v[42:43], v5 offset:39168
ds_read_b64_tr_b16 v[44:45], v5 offset:38944
ds_read_b64_tr_b16 v[46:47], v5 offset:39200
s_waitcnt lgkmcnt(0)
v_mfma_f32_16x16x32_bf16 v[112:115], v[16:19], v[48:51], v[112:115]
v_mfma_f32_16x16x32_bf16 v[116:119], v[20:23], v[48:51], v[116:119]
v_mfma_f32_16x16x32_bf16 v[112:115], v[24:27], v[52:55], v[112:115]
v_mfma_f32_16x16x32_bf16 v[116:119], v[28:31], v[52:55], v[116:119]
v_mfma_f32_16x16x32_bf16 v[112:115], v[32:35], v[56:59], v[112:115]
v_mfma_f32_16x16x32_bf16 v[116:119], v[36:39], v[56:59], v[116:119]
v_mfma_f32_16x16x32_bf16 v[112:115], v[40:43], v[60:63], v[112:115]
v_mfma_f32_16x16x32_bf16 v[116:119], v[44:47], v[60:63], v[116:119]
ds_read_b64_tr_b16 v[16:17], v5 offset:40960
ds_read_b64_tr_b16 v[18:19], v5 offset:41216
ds_read_b64_tr_b16 v[20:21], v5 offset:40992
ds_read_b64_tr_b16 v[22:23], v5 offset:41248
ds_read_b64_tr_b16 v[24:25], v5 offset:43008
ds_read_b64_tr_b16 v[26:27], v5 offset:43264
ds_read_b64_tr_b16 v[28:29], v5 offset:43040
ds_read_b64_tr_b16 v[30:31], v5 offset:43296
ds_read_b64_tr_b16 v[32:33], v5 offset:45056
ds_read_b64_tr_b16 v[34:35], v5 offset:45312
ds_read_b64_tr_b16 v[36:37], v5 offset:45088
ds_read_b64_tr_b16 v[38:39], v5 offset:45344
ds_read_b64_tr_b16 v[40:41], v5 offset:47104
ds_read_b64_tr_b16 v[42:43], v5 offset:47360
ds_read_b64_tr_b16 v[44:45], v5 offset:47136
ds_read_b64_tr_b16 v[46:47], v5 offset:47392
s_waitcnt lgkmcnt(0)
v_mfma_f32_16x16x32_bf16 v[112:115], v[16:19], v[64:67], v[112:115]
v_mfma_f32_16x16x32_bf16 v[116:119], v[20:23], v[64:67], v[116:119]
v_mfma_f32_16x16x32_bf16 v[112:115], v[24:27], v[68:71], v[112:115]
v_mfma_f32_16x16x32_bf16 v[116:119], v[28:31], v[68:71], v[116:119]
v_mfma_f32_16x16x32_bf16 v[112:115], v[32:35], v[72:75], v[112:115]
v_mfma_f32_16x16x32_bf16 v[116:119], v[36:39], v[72:75], v[116:119]
v_mfma_f32_16x16x32_bf16 v[112:115], v[40:43], v[76:79], v[112:115]
v_mfma_f32_16x16x32_bf16 v[116:119], v[44:47], v[76:79], v[116:119]
ds_read_b64_tr_b16 v[16:17], v5 offset:49152
ds_read_b64_tr_b16 v[18:19], v5 offset:49408
ds_read_b64_tr_b16 v[20:21], v5 offset:49184
ds_read_b64_tr_b16 v[22:23], v5 offset:49440
ds_read_b64_tr_b16 v[24:25], v5 offset:51200
ds_read_b64_tr_b16 v[26:27], v5 offset:51456
ds_read_b64_tr_b16 v[28:29], v5 offset:51232
ds_read_b64_tr_b16 v[30:31], v5 offset:51488
ds_read_b64_tr_b16 v[32:33], v5 offset:53248
ds_read_b64_tr_b16 v[34:35], v5 offset:53504
ds_read_b64_tr_b16 v[36:37], v5 offset:53280
ds_read_b64_tr_b16 v[38:39], v5 offset:53536
ds_read_b64_tr_b16 v[40:41], v5 offset:55296
ds_read_b64_tr_b16 v[42:43], v5 offset:55552
ds_read_b64_tr_b16 v[44:45], v5 offset:55328
ds_read_b64_tr_b16 v[46:47], v5 offset:55584
s_waitcnt lgkmcnt(0)
v_mfma_f32_16x16x32_bf16 v[112:115], v[16:19], v[80:83], v[112:115]
v_mfma_f32_16x16x32_bf16 v[116:119], v[20:23], v[80:83], v[116:119]
v_mfma_f32_16x16x32_bf16 v[112:115], v[24:27], v[84:87], v[112:115]
v_mfma_f32_16x16x32_bf16 v[116:119], v[28:31], v[84:87], v[116:119]
v_mfma_f32_16x16x32_bf16 v[112:115], v[32:35], v[88:91], v[112:115]
v_mfma_f32_16x16x32_bf16 v[116:119], v[36:39], v[88:91], v[116:119]
v_mfma_f32_16x16x32_bf16 v[112:115], v[40:43], v[92:95], v[112:115]
v_mfma_f32_16x16x32_bf16 v[116:119], v[44:47], v[92:95], v[116:119]
ds_read_b64_tr_b16 v[16:17], v5 offset:57344
ds_read_b64_tr_b16 v[18:19], v5 offset:57600
ds_read_b64_tr_b16 v[20:21], v5 offset:57376
ds_read_b64_tr_b16 v[22:23], v5 offset:57632
ds_read_b64_tr_b16 v[24:25], v5 offset:59392
ds_read_b64_tr_b16 v[26:27], v5 offset:59648
ds_read_b64_tr_b16 v[28:29], v5 offset:59424
ds_read_b64_tr_b16 v[30:31], v5 offset:59680
ds_read_b64_tr_b16 v[32:33], v5 offset:61440
ds_read_b64_tr_b16 v[34:35], v5 offset:61696
ds_read_b64_tr_b16 v[36:37], v5 offset:61472
ds_read_b64_tr_b16 v[38:39], v5 offset:61728
ds_read_b64_tr_b16 v[40:41], v5 offset:63488
ds_read_b64_tr_b16 v[42:43], v5 offset:63744
ds_read_b64_tr_b16 v[44:45], v5 offset:63520
ds_read_b64_tr_b16 v[46:47], v5 offset:63776
s_waitcnt lgkmcnt(0)
v_mfma_f32_16x16x32_bf16 v[112:115], v[16:19], v[96:99], v[112:115]
v_mfma_f32_16x16x32_bf16 v[116:119], v[20:23], v[96:99], v[116:119]
v_mfma_f32_16x16x32_bf16 v[112:115], v[24:27], v[100:103], v[112:115]
v_mfma_f32_16x16x32_bf16 v[116:119], v[28:31], v[100:103], v[116:119]
v_mfma_f32_16x16x32_bf16 v[112:115], v[32:35], v[104:107], v[112:115]
v_mfma_f32_16x16x32_bf16 v[116:119], v[36:39], v[104:107], v[116:119]
v_mfma_f32_16x16x32_bf16 v[112:115], v[40:43], v[108:111], v[112:115]
v_mfma_f32_16x16x32_bf16 v[116:119], v[44:47], v[108:111], v[116:119]
s_nop 7
s_nop 1
s_mov_b32 s3, 14336
v_mul_lo_u32 v7, v2, s3
v_lshrrev_b32 v6, 4, v139
v_lshl_add_u32 v7, v6, 4, v7
s_mul_i32 s3, s47, 28672
s_lshl_b32 s10, s48, 7
s_add_u32 s3, s3, s10
s_add_u32 s3, s3, 131072
v_cmp_gt_u32 vcc, 2, v2
s_and_saveexec_b64 s[30:31], vcc
buffer_store_dwordx4 v[112:115], v7, s[24:27], s3 offen sc1
buffer_store_dwordx4 v[116:119], v7, s[24:27], s3 offen offset:64 sc1
s_mov_b64 exec, s[30:31]
s_barrier
s_endpgm
k3_kernel_sv2:
s_barrier
s_mov_b32 s20, s34
s_and_b32 s21, s35, 0xffff
s_mov_b32 s22, 2097152
s_mov_b32 s23, 0x00020000
s_lshl_b32 s30, s2, 13
s_mov_b32 m0, 132096
s_mov_b32 s49, 8
k3_kernel_pf1:
buffer_load_dwordx4 v9, s[20:23], s30 offen lds
s_add_u32 s30, s30, 1024
s_sub_u32 s49, s49, 1
s_cmp_lg_u32 s49, 0
s_cbranch_scc1 k3_kernel_pf1
s_barrier
s_lshl_b32 s53, s2, 1
s_sub_u32 s3, s53, 127
s_cmp_ge_u32 s2, 64
s_cselect_b32 s53, s3, s53
s_cmp_ge_u32 s2, 128
s_cselect_b32 s53, s2, s53
s_cmp_ge_u32 s53, 112
s_cselect_b32 s47, 1, 0
s_cselect_b32 s12, s6, s4
s_cselect_b32 s13, s7, s5
s_mul_i32 s3, s47, 112
s_sub_u32 s48, s53, s3
s_lshl_b32 s3, s48, 6
s_add_u32 s12, s12, s3
s_addc_u32 s13, s13, 0
s_and_b32 s13, s13, 0xffff
s_sub_u32 s14, 7340032, s3
s_mov_b32 s15, 0x00020000
v_lshrrev_b32 v4, 2, v139
s_mov_b32 s3, 7168
v_mul_lo_u32 v4, v4, s3
v_and_b32 v5, 3, v139
v_lshl_add_u32 v4, v5, 4, v4
v_and_b32 v2, 15, v139
v_lshrrev_b32 v3, 4, v139
v_lshlrev_b32 v3, 4, v3
v_lshlrev_b32 v6, 11, v2
v_sub_u32 v3, v3, v6
v_add_u32 v3, 40960, v3
v_cmp_gt_u32 vcc, 2, v2
v_mov_b32 v6, 0x7f000000
s_nop 0
v_cndmask_b32 v3, v6, v3, vcc
s_mov_b32 s10, 0
s_mov_b32 s11, 66560
v_lshrrev_b32 v6, 4, v139
v_bfe_u32 v5, v139, 2, 2
v_lshl_add_u32 v5, v6, 3, v5
v_lshlrev_b32 v5, 6, v5
v_and_b32 v6, 3, v139
v_lshl_add_u32 v5, v6, 3, v5
v_add_u32 v5, 66560, v5
v_mov_b32 v112, 0
v_mov_b32 v113, 0
v_mov_b32 v114, 0
v_mov_b32 v115, 0
v_mov_b32 v116, 0
v_mov_b32 v117, 0
v_mov_b32 v118, 0
v_mov_b32 v119, 0
s_mov_b32 s49, 10
k3_kernel_u2_svd0:
s_mov_b32 m0, s11
s_add_u32 s11, s11, 1024
buffer_load_dwordx4 v4, s[12:15], s10 offen lds
s_add_u32 s10, s10, 114688
s_sub_u32 s49, s49, 1
s_cmp_lg_u32 s49, 0
s_cbranch_scc1 k3_kernel_u2_svd0
s_barrier
s_mov_b32 s49, 14
k3_kernel_u2_svd1:
s_mov_b32 m0, s11
s_add_u32 s11, s11, 1024
buffer_load_dwordx4 v4, s[12:15], s10 offen lds
s_add_u32 s10, s10, 114688
s_sub_u32 s49, s49, 1
s_cmp_lg_u32 s49, 0
s_cbranch_scc1 k3_kernel_u2_svd1
s_barrier
s_mov_b32 s49, 14
k3_kernel_u2_svd2:
s_mov_b32 m0, s11
s_add_u32 s11, s11, 1024
buffer_load_dwordx4 v4, s[12:15], s10 offen lds
s_add_u32 s10, s10, 114688
s_sub_u32 s49, s49, 1
s_cmp_lg_u32 s49, 0
s_cbranch_scc1 k3_kernel_u2_svd2
s_barrier
s_mov_b32 s49, 14
k3_kernel_u2_svd3:
s_mov_b32 m0, s11
s_add_u32 s11, s11, 1024
buffer_load_dwordx4 v4, s[12:15], s10 offen lds
s_add_u32 s10, s10, 114688
s_sub_u32 s49, s49, 1
s_cmp_lg_u32 s49, 0
s_cbranch_scc1 k3_kernel_u2_svd3
s_barrier
s_mov_b32 s49, 12
k3_kernel_u2_svd4:
s_mov_b32 m0, s11
s_add_u32 s11, s11, 1024
buffer_load_dwordx4 v4, s[12:15], s10 offen lds
s_add_u32 s10, s10, 114688
s_sub_u32 s49, s49, 1
s_cmp_lg_u32 s49, 0
s_cbranch_scc1 k3_kernel_u2_svd4
s_barrier
s_mov_b32 s16, s36
s_and_b32 s17, s37, 0xffff
s_mov_b32 s18, 7340032
s_mov_b32 s19, 0x00020000
v_lshrrev_b32 v6, 3, v139
s_mov_b32 s3, 458752
v_mul_lo_u32 v6, v6, s3
v_and_b32 v7, 7, v139
v_lshlrev_b32 v7, 4, v7
v_xor_b32 v8, 0, v7
v_add_u32 v124, v6, v8
v_xor_b32 v8, 32, v7
v_add_u32 v125, v6, v8
v_xor_b32 v8, 64, v7
v_add_u32 v126, v6, v8
v_xor_b32 v8, 96, v7
v_add_u32 v127, v6, v8
v_lshrrev_b32 v6, 3, v139
v_add_u32 v6, 8, v6
s_mov_b32 s3, 458752
v_mul_lo_u32 v6, v6, s3
v_and_b32 v7, 7, v139
v_lshlrev_b32 v7, 4, v7
v_xor_b32 v8, 0, v7
v_add_u32 v128, v6, v8
v_xor_b32 v8, 32, v7
v_add_u32 v129, v6, v8
v_xor_b32 v8, 64, v7
v_add_u32 v130, v6, v8
v_xor_b32 v8, 96, v7
v_add_u32 v131, v6, v8
s_sub_u32 s50, s2, 64
s_lshl_b32 s51, s50, 15
s_mul_i32 s3, s50, 4682
s_lshr_b32 s3, s3, 16
s_mul_i32 s10, s3, 14
s_sub_u32 s10, s50, s10
s_mul_i32 s3, s3, 7
s_cmp_ge_u32 s10, 7
s_cselect_b32 s11, 1, 0
s_sub_u32 s11, s10, s11
s_lshr_b32 s52, s11, 1
s_and_b32 s11, s11, 1
s_cmp_eq_u32 s10, 6
s_cselect_b32 s52, 6, s52
s_cselect_b32 s11, 0, s11
s_cmp_eq_u32 s10, 13
s_cselect_b32 s52, 6, s52
s_cselect_b32 s11, 1, s11
s_add_u32 s52, s52, s3
s_and_b32 s3, s52, 1
s_lshl_b32 s3, s3, 12
s_lshl_b32 s11, s11, 11
s_add_u32 s3, s3, s11
s_lshr_b32 s52, s52, 1
s_lshl_b32 s52, s52, 13
s_add_u32 s52, s52, s3
s_add_u32 s52, s52, 40894464
s_add_u32 s3, s51, 0
buffer_load_dwordx4 v[48:51], v9, s[16:19], s3 offen
s_add_u32 s3, s51, 1024
buffer_load_dwordx4 v[52:55], v9, s[16:19], s3 offen
s_add_u32 s3, s51, 2048
buffer_load_dwordx4 v[56:59], v9, s[16:19], s3 offen
s_add_u32 s3, s51, 3072
buffer_load_dwordx4 v[60:63], v9, s[16:19], s3 offen
s_add_u32 s3, s51, 4096
buffer_load_dwordx4 v[64:67], v9, s[16:19], s3 offen
s_add_u32 s3, s51, 5120
buffer_load_dwordx4 v[68:71], v9, s[16:19], s3 offen
s_add_u32 s3, s51, 6144
buffer_load_dwordx4 v[72:75], v9, s[16:19], s3 offen
s_add_u32 s3, s51, 7168
buffer_load_dwordx4 v[76:79], v9, s[16:19], s3 offen
s_add_u32 s3, s51, 8192
buffer_load_dwordx4 v[80:83], v9, s[16:19], s3 offen
s_add_u32 s3, s51, 9216
buffer_load_dwordx4 v[84:87], v9, s[16:19], s3 offen
s_add_u32 s3, s51, 10240
buffer_load_dwordx4 v[88:91], v9, s[16:19], s3 offen
s_add_u32 s3, s51, 11264
buffer_load_dwordx4 v[92:95], v9, s[16:19], s3 offen
s_add_u32 s3, s51, 12288
buffer_load_dwordx4 v[96:99], v9, s[16:19], s3 offen
s_add_u32 s3, s51, 13312
buffer_load_dwordx4 v[100:103], v9, s[16:19], s3 offen
s_add_u32 s3, s51, 14336
buffer_load_dwordx4 v[104:107], v9, s[16:19], s3 offen
s_add_u32 s3, s51, 15360
buffer_load_dwordx4 v[108:111], v9, s[16:19], s3 offen
s_barrier
s_barrier
s_waitcnt vmcnt(0)
s_add_u32 s3, s52, 0
buffer_store_dwordx4 v[48:51], v124, s[24:27], s3 offen sc1
s_add_u32 s3, s52, 0
buffer_store_dwordx4 v[52:55], v128, s[24:27], s3 offen sc1
s_add_u32 s3, s52, 128
buffer_store_dwordx4 v[56:59], v124, s[24:27], s3 offen sc1
s_add_u32 s3, s52, 128
buffer_store_dwordx4 v[60:63], v128, s[24:27], s3 offen sc1
s_add_u32 s3, s52, 256
buffer_store_dwordx4 v[64:67], v125, s[24:27], s3 offen sc1
s_add_u32 s3, s52, 256
buffer_store_dwordx4 v[68:71], v129, s[24:27], s3 offen sc1
s_add_u32 s3, s52, 384
buffer_store_dwordx4 v[72:75], v125, s[24:27], s3 offen sc1
s_add_u32 s3, s52, 384
buffer_store_dwordx4 v[76:79], v129, s[24:27], s3 offen sc1
s_add_u32 s3, s52, 512
buffer_store_dwordx4 v[80:83], v126, s[24:27], s3 offen sc1
s_add_u32 s3, s52, 512
buffer_store_dwordx4 v[84:87], v130, s[24:27], s3 offen sc1
s_add_u32 s3, s52, 640
buffer_store_dwordx4 v[88:91], v126, s[24:27], s3 offen sc1
s_add_u32 s3, s52, 640
buffer_store_dwordx4 v[92:95], v130, s[24:27], s3 offen sc1
s_add_u32 s3, s52, 768
buffer_store_dwordx4 v[96:99], v127, s[24:27], s3 offen sc1
s_add_u32 s3, s52, 768
buffer_store_dwordx4 v[100:103], v131, s[24:27], s3 offen sc1
s_add_u32 s3, s52, 896
buffer_store_dwordx4 v[104:107], v127, s[24:27], s3 offen sc1
s_add_u32 s3, s52, 896
buffer_store_dwordx4 v[108:111], v131, s[24:27], s3 offen sc1
s_add_u32 s3, s51, 16384
buffer_load_dwordx4 v[48:51], v9, s[16:19], s3 offen
s_add_u32 s3, s51, 17408
buffer_load_dwordx4 v[52:55], v9, s[16:19], s3 offen
s_add_u32 s3, s51, 18432
buffer_load_dwordx4 v[56:59], v9, s[16:19], s3 offen
s_add_u32 s3, s51, 19456
buffer_load_dwordx4 v[60:63], v9, s[16:19], s3 offen
s_add_u32 s3, s51, 20480
buffer_load_dwordx4 v[64:67], v9, s[16:19], s3 offen
s_add_u32 s3, s51, 21504
buffer_load_dwordx4 v[68:71], v9, s[16:19], s3 offen
s_add_u32 s3, s51, 22528
buffer_load_dwordx4 v[72:75], v9, s[16:19], s3 offen
s_add_u32 s3, s51, 23552
buffer_load_dwordx4 v[76:79], v9, s[16:19], s3 offen
s_add_u32 s3, s51, 24576
buffer_load_dwordx4 v[80:83], v9, s[16:19], s3 offen
s_add_u32 s3, s51, 25600
buffer_load_dwordx4 v[84:87], v9, s[16:19], s3 offen
s_add_u32 s3, s51, 26624
buffer_load_dwordx4 v[88:91], v9, s[16:19], s3 offen
s_add_u32 s3, s51, 27648
buffer_load_dwordx4 v[92:95], v9, s[16:19], s3 offen
s_add_u32 s3, s51, 28672
buffer_load_dwordx4 v[96:99], v9, s[16:19], s3 offen
s_add_u32 s3, s51, 29696
buffer_load_dwordx4 v[100:103], v9, s[16:19], s3 offen
s_add_u32 s3, s51, 30720
buffer_load_dwordx4 v[104:107], v9, s[16:19], s3 offen
s_add_u32 s3, s51, 31744
buffer_load_dwordx4 v[108:111], v9, s[16:19], s3 offen
s_barrier
s_barrier
s_waitcnt vmcnt(0)
s_add_u32 s3, s52, 1024
buffer_store_dwordx4 v[48:51], v124, s[24:27], s3 offen sc1
s_add_u32 s3, s52, 1024
buffer_store_dwordx4 v[52:55], v128, s[24:27], s3 offen sc1
s_add_u32 s3, s52, 1152
buffer_store_dwordx4 v[56:59], v124, s[24:27], s3 offen sc1
s_add_u32 s3, s52, 1152
buffer_store_dwordx4 v[60:63], v128, s[24:27], s3 offen sc1
s_add_u32 s3, s52, 1280
buffer_store_dwordx4 v[64:67], v125, s[24:27], s3 offen sc1
s_add_u32 s3, s52, 1280
buffer_store_dwordx4 v[68:71], v129, s[24:27], s3 offen sc1
s_add_u32 s3, s52, 1408
buffer_store_dwordx4 v[72:75], v125, s[24:27], s3 offen sc1
s_add_u32 s3, s52, 1408
buffer_store_dwordx4 v[76:79], v129, s[24:27], s3 offen sc1
s_add_u32 s3, s52, 1536
buffer_store_dwordx4 v[80:83], v126, s[24:27], s3 offen sc1
s_add_u32 s3, s52, 1536
buffer_store_dwordx4 v[84:87], v130, s[24:27], s3 offen sc1
s_add_u32 s3, s52, 1664
buffer_store_dwordx4 v[88:91], v126, s[24:27], s3 offen sc1
s_add_u32 s3, s52, 1664
buffer_store_dwordx4 v[92:95], v130, s[24:27], s3 offen sc1
s_add_u32 s3, s52, 1792
buffer_store_dwordx4 v[96:99], v127, s[24:27], s3 offen sc1
s_add_u32 s3, s52, 1792
buffer_store_dwordx4 v[100:103], v131, s[24:27], s3 offen sc1
s_add_u32 s3, s52, 1920
buffer_store_dwordx4 v[104:107], v127, s[24:27], s3 offen sc1
s_add_u32 s3, s52, 1920
buffer_store_dwordx4 v[108:111], v131, s[24:27], s3 offen sc1
buffer_load_dwordx4 v[48:51], v3, s[24:27], 0 offen offset:0
buffer_load_dwordx4 v[52:55], v3, s[24:27], 0 offen offset:64
buffer_load_dwordx4 v[56:59], v3, s[24:27], 0 offen offset:128
buffer_load_dwordx4 v[60:63], v3, s[24:27], 0 offen offset:192
buffer_load_dwordx4 v[64:67], v3, s[24:27], 0 offen offset:256
buffer_load_dwordx4 v[68:71], v3, s[24:27], 0 offen offset:320
buffer_load_dwordx4 v[72:75], v3, s[24:27], 0 offen offset:384
buffer_load_dwordx4 v[76:79], v3, s[24:27], 0 offen offset:448
buffer_load_dwordx4 v[80:83], v3, s[24:27], 0 offen offset:512
buffer_load_dwordx4 v[84:87], v3, s[24:27], 0 offen offset:576
buffer_load_dwordx4 v[88:91], v3, s[24:27], 0 offen offset:640
buffer_load_dwordx4 v[92:95], v3, s[24:27], 0 offen offset:704
buffer_load_dwordx4 v[96:99], v3, s[24:27], 0 offen offset:768
buffer_load_dwordx4 v[100:103], v3, s[24:27], 0 offen offset:832
buffer_load_dwordx4 v[104:107], v3, s[24:27], 0 offen offset:896
buffer_load_dwordx4 v[108:111], v3, s[24:27], 0 offen offset:960
s_barrier
s_barrier
s_waitcnt vmcnt(0)
ds_read_b64_tr_b16 v[16:17], v5 offset:0
ds_read_b64_tr_b16 v[18:19], v5 offset:256
ds_read_b64_tr_b16 v[20:21], v5 offset:32
ds_read_b64_tr_b16 v[22:23], v5 offset:288
ds_read_b64_tr_b16 v[24:25], v5 offset:2048
ds_read_b64_tr_b16 v[26:27], v5 offset:2304
ds_read_b64_tr_b16 v[28:29], v5 offset:2080
ds_read_b64_tr_b16 v[30:31], v5 offset:2336
ds_read_b64_tr_b16 v[32:33], v5 offset:4096
ds_read_b64_tr_b16 v[34:35], v5 offset:4352
ds_read_b64_tr_b16 v[36:37], v5 offset:4128
ds_read_b64_tr_b16 v[38:39], v5 offset:4384
ds_read_b64_tr_b16 v[40:41], v5 offset:6144
ds_read_b64_tr_b16 v[42:43], v5 offset:6400
ds_read_b64_tr_b16 v[44:45], v5 offset:6176
ds_read_b64_tr_b16 v[46:47], v5 offset:6432
s_waitcnt lgkmcnt(0)
v_mfma_f32_16x16x32_bf16 v[112:115], v[16:19], v[48:51], v[112:115]
v_mfma_f32_16x16x32_bf16 v[116:119], v[20:23], v[48:51], v[116:119]
v_mfma_f32_16x16x32_bf16 v[112:115], v[24:27], v[52:55], v[112:115]
v_mfma_f32_16x16x32_bf16 v[116:119], v[28:31], v[52:55], v[116:119]
v_mfma_f32_16x16x32_bf16 v[112:115], v[32:35], v[56:59], v[112:115]
v_mfma_f32_16x16x32_bf16 v[116:119], v[36:39], v[56:59], v[116:119]
v_mfma_f32_16x16x32_bf16 v[112:115], v[40:43], v[60:63], v[112:115]
v_mfma_f32_16x16x32_bf16 v[116:119], v[44:47], v[60:63], v[116:119]
ds_read_b64_tr_b16 v[16:17], v5 offset:8192
ds_read_b64_tr_b16 v[18:19], v5 offset:8448
ds_read_b64_tr_b16 v[20:21], v5 offset:8224
ds_read_b64_tr_b16 v[22:23], v5 offset:8480
ds_read_b64_tr_b16 v[24:25], v5 offset:10240
ds_read_b64_tr_b16 v[26:27], v5 offset:10496
ds_read_b64_tr_b16 v[28:29], v5 offset:10272
ds_read_b64_tr_b16 v[30:31], v5 offset:10528
ds_read_b64_tr_b16 v[32:33], v5 offset:12288
ds_read_b64_tr_b16 v[34:35], v5 offset:12544
ds_read_b64_tr_b16 v[36:37], v5 offset:12320
ds_read_b64_tr_b16 v[38:39], v5 offset:12576
ds_read_b64_tr_b16 v[40:41], v5 offset:14336
ds_read_b64_tr_b16 v[42:43], v5 offset:14592
ds_read_b64_tr_b16 v[44:45], v5 offset:14368
ds_read_b64_tr_b16 v[46:47], v5 offset:14624
s_waitcnt lgkmcnt(0)
v_mfma_f32_16x16x32_bf16 v[112:115], v[16:19], v[64:67], v[112:115]
v_mfma_f32_16x16x32_bf16 v[116:119], v[20:23], v[64:67], v[116:119]
v_mfma_f32_16x16x32_bf16 v[112:115], v[24:27], v[68:71], v[112:115]
v_mfma_f32_16x16x32_bf16 v[116:119], v[28:31], v[68:71], v[116:119]
v_mfma_f32_16x16x32_bf16 v[112:115], v[32:35], v[72:75], v[112:115]
v_mfma_f32_16x16x32_bf16 v[116:119], v[36:39], v[72:75], v[116:119]
v_mfma_f32_16x16x32_bf16 v[112:115], v[40:43], v[76:79], v[112:115]
v_mfma_f32_16x16x32_bf16 v[116:119], v[44:47], v[76:79], v[116:119]
s_barrier
ds_read_b64_tr_b16 v[16:17], v5 offset:16384
ds_read_b64_tr_b16 v[18:19], v5 offset:16640
ds_read_b64_tr_b16 v[20:21], v5 offset:16416
ds_read_b64_tr_b16 v[22:23], v5 offset:16672
ds_read_b64_tr_b16 v[24:25], v5 offset:18432
ds_read_b64_tr_b16 v[26:27], v5 offset:18688
ds_read_b64_tr_b16 v[28:29], v5 offset:18464
ds_read_b64_tr_b16 v[30:31], v5 offset:18720
ds_read_b64_tr_b16 v[32:33], v5 offset:20480
ds_read_b64_tr_b16 v[34:35], v5 offset:20736
ds_read_b64_tr_b16 v[36:37], v5 offset:20512
ds_read_b64_tr_b16 v[38:39], v5 offset:20768
ds_read_b64_tr_b16 v[40:41], v5 offset:22528
ds_read_b64_tr_b16 v[42:43], v5 offset:22784
ds_read_b64_tr_b16 v[44:45], v5 offset:22560
ds_read_b64_tr_b16 v[46:47], v5 offset:22816
s_waitcnt lgkmcnt(0)
v_mfma_f32_16x16x32_bf16 v[112:115], v[16:19], v[80:83], v[112:115]
v_mfma_f32_16x16x32_bf16 v[116:119], v[20:23], v[80:83], v[116:119]
v_mfma_f32_16x16x32_bf16 v[112:115], v[24:27], v[84:87], v[112:115]
v_mfma_f32_16x16x32_bf16 v[116:119], v[28:31], v[84:87], v[116:119]
v_mfma_f32_16x16x32_bf16 v[112:115], v[32:35], v[88:91], v[112:115]
v_mfma_f32_16x16x32_bf16 v[116:119], v[36:39], v[88:91], v[116:119]
v_mfma_f32_16x16x32_bf16 v[112:115], v[40:43], v[92:95], v[112:115]
v_mfma_f32_16x16x32_bf16 v[116:119], v[44:47], v[92:95], v[116:119]
ds_read_b64_tr_b16 v[16:17], v5 offset:24576
ds_read_b64_tr_b16 v[18:19], v5 offset:24832
ds_read_b64_tr_b16 v[20:21], v5 offset:24608
ds_read_b64_tr_b16 v[22:23], v5 offset:24864
ds_read_b64_tr_b16 v[24:25], v5 offset:26624
ds_read_b64_tr_b16 v[26:27], v5 offset:26880
ds_read_b64_tr_b16 v[28:29], v5 offset:26656
ds_read_b64_tr_b16 v[30:31], v5 offset:26912
ds_read_b64_tr_b16 v[32:33], v5 offset:28672
ds_read_b64_tr_b16 v[34:35], v5 offset:28928
ds_read_b64_tr_b16 v[36:37], v5 offset:28704
ds_read_b64_tr_b16 v[38:39], v5 offset:28960
ds_read_b64_tr_b16 v[40:41], v5 offset:30720
ds_read_b64_tr_b16 v[42:43], v5 offset:30976
ds_read_b64_tr_b16 v[44:45], v5 offset:30752
ds_read_b64_tr_b16 v[46:47], v5 offset:31008
s_waitcnt lgkmcnt(0)
v_mfma_f32_16x16x32_bf16 v[112:115], v[16:19], v[96:99], v[112:115]
v_mfma_f32_16x16x32_bf16 v[116:119], v[20:23], v[96:99], v[116:119]
v_mfma_f32_16x16x32_bf16 v[112:115], v[24:27], v[100:103], v[112:115]
v_mfma_f32_16x16x32_bf16 v[116:119], v[28:31], v[100:103], v[116:119]
v_mfma_f32_16x16x32_bf16 v[112:115], v[32:35], v[104:107], v[112:115]
v_mfma_f32_16x16x32_bf16 v[116:119], v[36:39], v[104:107], v[116:119]
v_mfma_f32_16x16x32_bf16 v[112:115], v[40:43], v[108:111], v[112:115]
v_mfma_f32_16x16x32_bf16 v[116:119], v[44:47], v[108:111], v[116:119]
buffer_load_dwordx4 v[48:51], v3, s[24:27], 0 offen offset:1024
buffer_load_dwordx4 v[52:55], v3, s[24:27], 0 offen offset:1088
buffer_load_dwordx4 v[56:59], v3, s[24:27], 0 offen offset:1152
buffer_load_dwordx4 v[60:63], v3, s[24:27], 0 offen offset:1216
buffer_load_dwordx4 v[64:67], v3, s[24:27], 0 offen offset:1280
buffer_load_dwordx4 v[68:71], v3, s[24:27], 0 offen offset:1344
buffer_load_dwordx4 v[72:75], v3, s[24:27], 0 offen offset:1408
buffer_load_dwordx4 v[76:79], v3, s[24:27], 0 offen offset:1472
buffer_load_dwordx4 v[80:83], v3, s[24:27], 0 offen offset:1536
buffer_load_dwordx4 v[84:87], v3, s[24:27], 0 offen offset:1600
buffer_load_dwordx4 v[88:91], v3, s[24:27], 0 offen offset:1664
buffer_load_dwordx4 v[92:95], v3, s[24:27], 0 offen offset:1728
buffer_load_dwordx4 v[96:99], v3, s[24:27], 0 offen offset:1792
buffer_load_dwordx4 v[100:103], v3, s[24:27], 0 offen offset:1856
buffer_load_dwordx4 v[104:107], v3, s[24:27], 0 offen offset:1920
buffer_load_dwordx4 v[108:111], v3, s[24:27], 0 offen offset:1984
s_barrier
s_waitcnt vmcnt(0)
ds_read_b64_tr_b16 v[16:17], v5 offset:32768
ds_read_b64_tr_b16 v[18:19], v5 offset:33024
ds_read_b64_tr_b16 v[20:21], v5 offset:32800
ds_read_b64_tr_b16 v[22:23], v5 offset:33056
ds_read_b64_tr_b16 v[24:25], v5 offset:34816
ds_read_b64_tr_b16 v[26:27], v5 offset:35072
ds_read_b64_tr_b16 v[28:29], v5 offset:34848
ds_read_b64_tr_b16 v[30:31], v5 offset:35104
ds_read_b64_tr_b16 v[32:33], v5 offset:36864
ds_read_b64_tr_b16 v[34:35], v5 offset:37120
ds_read_b64_tr_b16 v[36:37], v5 offset:36896
ds_read_b64_tr_b16 v[38:39], v5 offset:37152
ds_read_b64_tr_b16 v[40:41], v5 offset:38912
ds_read_b64_tr_b16 v[42:43], v5 offset:39168
ds_read_b64_tr_b16 v[44:45], v5 offset:38944
ds_read_b64_tr_b16 v[46:47], v5 offset:39200
s_waitcnt lgkmcnt(0)
v_mfma_f32_16x16x32_bf16 v[112:115], v[16:19], v[48:51], v[112:115]
v_mfma_f32_16x16x32_bf16 v[116:119], v[20:23], v[48:51], v[116:119]
v_mfma_f32_16x16x32_bf16 v[112:115], v[24:27], v[52:55], v[112:115]
v_mfma_f32_16x16x32_bf16 v[116:119], v[28:31], v[52:55], v[116:119]
v_mfma_f32_16x16x32_bf16 v[112:115], v[32:35], v[56:59], v[112:115]
v_mfma_f32_16x16x32_bf16 v[116:119], v[36:39], v[56:59], v[116:119]
v_mfma_f32_16x16x32_bf16 v[112:115], v[40:43], v[60:63], v[112:115]
v_mfma_f32_16x16x32_bf16 v[116:119], v[44:47], v[60:63], v[116:119]
ds_read_b64_tr_b16 v[16:17], v5 offset:40960
ds_read_b64_tr_b16 v[18:19], v5 offset:41216
ds_read_b64_tr_b16 v[20:21], v5 offset:40992
ds_read_b64_tr_b16 v[22:23], v5 offset:41248
ds_read_b64_tr_b16 v[24:25], v5 offset:43008
ds_read_b64_tr_b16 v[26:27], v5 offset:43264
ds_read_b64_tr_b16 v[28:29], v5 offset:43040
ds_read_b64_tr_b16 v[30:31], v5 offset:43296
ds_read_b64_tr_b16 v[32:33], v5 offset:45056
ds_read_b64_tr_b16 v[34:35], v5 offset:45312
ds_read_b64_tr_b16 v[36:37], v5 offset:45088
ds_read_b64_tr_b16 v[38:39], v5 offset:45344
ds_read_b64_tr_b16 v[40:41], v5 offset:47104
ds_read_b64_tr_b16 v[42:43], v5 offset:47360
ds_read_b64_tr_b16 v[44:45], v5 offset:47136
ds_read_b64_tr_b16 v[46:47], v5 offset:47392
s_waitcnt lgkmcnt(0)
v_mfma_f32_16x16x32_bf16 v[112:115], v[16:19], v[64:67], v[112:115]
v_mfma_f32_16x16x32_bf16 v[116:119], v[20:23], v[64:67], v[116:119]
v_mfma_f32_16x16x32_bf16 v[112:115], v[24:27], v[68:71], v[112:115]
v_mfma_f32_16x16x32_bf16 v[116:119], v[28:31], v[68:71], v[116:119]
v_mfma_f32_16x16x32_bf16 v[112:115], v[32:35], v[72:75], v[112:115]
v_mfma_f32_16x16x32_bf16 v[116:119], v[36:39], v[72:75], v[116:119]
v_mfma_f32_16x16x32_bf16 v[112:115], v[40:43], v[76:79], v[112:115]
v_mfma_f32_16x16x32_bf16 v[116:119], v[44:47], v[76:79], v[116:119]
s_barrier
ds_read_b64_tr_b16 v[16:17], v5 offset:49152
ds_read_b64_tr_b16 v[18:19], v5 offset:49408
ds_read_b64_tr_b16 v[20:21], v5 offset:49184
ds_read_b64_tr_b16 v[22:23], v5 offset:49440
ds_read_b64_tr_b16 v[24:25], v5 offset:51200
ds_read_b64_tr_b16 v[26:27], v5 offset:51456
ds_read_b64_tr_b16 v[28:29], v5 offset:51232
ds_read_b64_tr_b16 v[30:31], v5 offset:51488
ds_read_b64_tr_b16 v[32:33], v5 offset:53248
ds_read_b64_tr_b16 v[34:35], v5 offset:53504
ds_read_b64_tr_b16 v[36:37], v5 offset:53280
ds_read_b64_tr_b16 v[38:39], v5 offset:53536
ds_read_b64_tr_b16 v[40:41], v5 offset:55296
ds_read_b64_tr_b16 v[42:43], v5 offset:55552
ds_read_b64_tr_b16 v[44:45], v5 offset:55328
ds_read_b64_tr_b16 v[46:47], v5 offset:55584
s_waitcnt lgkmcnt(0)
v_mfma_f32_16x16x32_bf16 v[112:115], v[16:19], v[80:83], v[112:115]
v_mfma_f32_16x16x32_bf16 v[116:119], v[20:23], v[80:83], v[116:119]
v_mfma_f32_16x16x32_bf16 v[112:115], v[24:27], v[84:87], v[112:115]
v_mfma_f32_16x16x32_bf16 v[116:119], v[28:31], v[84:87], v[116:119]
v_mfma_f32_16x16x32_bf16 v[112:115], v[32:35], v[88:91], v[112:115]
v_mfma_f32_16x16x32_bf16 v[116:119], v[36:39], v[88:91], v[116:119]
v_mfma_f32_16x16x32_bf16 v[112:115], v[40:43], v[92:95], v[112:115]
v_mfma_f32_16x16x32_bf16 v[116:119], v[44:47], v[92:95], v[116:119]
ds_read_b64_tr_b16 v[16:17], v5 offset:57344
ds_read_b64_tr_b16 v[18:19], v5 offset:57600
ds_read_b64_tr_b16 v[20:21], v5 offset:57376
ds_read_b64_tr_b16 v[22:23], v5 offset:57632
ds_read_b64_tr_b16 v[24:25], v5 offset:59392
ds_read_b64_tr_b16 v[26:27], v5 offset:59648
ds_read_b64_tr_b16 v[28:29], v5 offset:59424
ds_read_b64_tr_b16 v[30:31], v5 offset:59680
ds_read_b64_tr_b16 v[32:33], v5 offset:61440
ds_read_b64_tr_b16 v[34:35], v5 offset:61696
ds_read_b64_tr_b16 v[36:37], v5 offset:61472
ds_read_b64_tr_b16 v[38:39], v5 offset:61728
ds_read_b64_tr_b16 v[40:41], v5 offset:63488
ds_read_b64_tr_b16 v[42:43], v5 offset:63744
ds_read_b64_tr_b16 v[44:45], v5 offset:63520
ds_read_b64_tr_b16 v[46:47], v5 offset:63776
s_waitcnt lgkmcnt(0)
v_mfma_f32_16x16x32_bf16 v[112:115], v[16:19], v[96:99], v[112:115]
v_mfma_f32_16x16x32_bf16 v[116:119], v[20:23], v[96:99], v[116:119]
v_mfma_f32_16x16x32_bf16 v[112:115], v[24:27], v[100:103], v[112:115]
v_mfma_f32_16x16x32_bf16 v[116:119], v[28:31], v[100:103], v[116:119]
v_mfma_f32_16x16x32_bf16 v[112:115], v[32:35], v[104:107], v[112:115]
v_mfma_f32_16x16x32_bf16 v[116:119], v[36:39], v[104:107], v[116:119]
v_mfma_f32_16x16x32_bf16 v[112:115], v[40:43], v[108:111], v[112:115]
v_mfma_f32_16x16x32_bf16 v[116:119], v[44:47], v[108:111], v[116:119]
s_nop 7
s_nop 1
s_mov_b32 s3, 14336
v_mul_lo_u32 v7, v2, s3
v_lshrrev_b32 v6, 4, v139
v_lshl_add_u32 v7, v6, 4, v7
s_mul_i32 s3, s47, 28672
s_lshl_b32 s10, s48, 7
s_add_u32 s3, s3, s10
s_add_u32 s3, s3, 131072
v_cmp_gt_u32 vcc, 2, v2
s_and_saveexec_b64 s[30:31], vcc
buffer_store_dwordx4 v[112:115], v7, s[24:27], s3 offen sc1
buffer_store_dwordx4 v[116:119], v7, s[24:27], s3 offen offset:64 sc1
s_mov_b64 exec, s[30:31]
s_barrier
s_endpgm
k3_kernel_sv3:
s_barrier
s_mov_b32 s20, s34
s_and_b32 s21, s35, 0xffff
s_mov_b32 s22, 2097152
s_mov_b32 s23, 0x00020000
s_lshl_b32 s30, s2, 13
s_mov_b32 m0, 132096
s_mov_b32 s49, 8
k3_kernel_pf2:
buffer_load_dwordx4 v9, s[20:23], s30 offen lds
s_add_u32 s30, s30, 1024
s_sub_u32 s49, s49, 1
s_cmp_lg_u32 s49, 0
s_cbranch_scc1 k3_kernel_pf2
s_barrier
s_barrier
s_barrier
s_barrier
s_barrier
s_mov_b32 s16, s36
s_and_b32 s17, s37, 0xffff
s_mov_b32 s18, 7340032
s_mov_b32 s19, 0x00020000
v_lshrrev_b32 v6, 3, v139
s_mov_b32 s3, 458752
v_mul_lo_u32 v6, v6, s3
v_and_b32 v7, 7, v139
v_lshlrev_b32 v7, 4, v7
v_xor_b32 v8, 0, v7
v_add_u32 v124, v6, v8
v_xor_b32 v8, 32, v7
v_add_u32 v125, v6, v8
v_xor_b32 v8, 64, v7
v_add_u32 v126, v6, v8
v_xor_b32 v8, 96, v7
v_add_u32 v127, v6, v8
v_lshrrev_b32 v6, 3, v139
v_add_u32 v6, 8, v6
s_mov_b32 s3, 458752
v_mul_lo_u32 v6, v6, s3
v_and_b32 v7, 7, v139
v_lshlrev_b32 v7, 4, v7
v_xor_b32 v8, 0, v7
v_add_u32 v128, v6, v8
v_xor_b32 v8, 32, v7
v_add_u32 v129, v6, v8
v_xor_b32 v8, 64, v7
v_add_u32 v130, v6, v8
v_xor_b32 v8, 96, v7
v_add_u32 v131, v6, v8
s_sub_u32 s50, s2, 224
s_lshl_b32 s50, s50, 1
s_add_u32 s50, s50, 160
s_lshl_b32 s51, s50, 15
s_mul_i32 s3, s50, 4682
s_lshr_b32 s3, s3, 16
s_mul_i32 s10, s3, 14
s_sub_u32 s10, s50, s10
s_mul_i32 s3, s3, 7
s_cmp_ge_u32 s10, 7
s_cselect_b32 s11, 1, 0
s_sub_u32 s11, s10, s11
s_lshr_b32 s52, s11, 1
s_and_b32 s11, s11, 1
s_cmp_eq_u32 s10, 6
s_cselect_b32 s52, 6, s52
s_cselect_b32 s11, 0, s11
s_cmp_eq_u32 s10, 13
s_cselect_b32 s52, 6, s52
s_cselect_b32 s11, 1, s11
s_add_u32 s52, s52, s3
s_and_b32 s3, s52, 1
s_lshl_b32 s3, s3, 12
s_lshl_b32 s11, s11, 11
s_add_u32 s3, s3, s11
s_lshr_b32 s52, s52, 1
s_lshl_b32 s52, s52, 13
s_add_u32 s52, s52, s3
s_add_u32 s52, s52, 40894464
s_add_u32 s3, s51, 0
buffer_load_dwordx4 v[48:51], v9, s[16:19], s3 offen
s_add_u32 s3, s51, 1024
buffer_load_dwordx4 v[52:55], v9, s[16:19], s3 offen
s_add_u32 s3, s51, 2048
buffer_load_dwordx4 v[56:59], v9, s[16:19], s3 offen
s_add_u32 s3, s51, 3072
buffer_load_dwordx4 v[60:63], v9, s[16:19], s3 offen
s_add_u32 s3, s51, 4096
buffer_load_dwordx4 v[64:67], v9, s[16:19], s3 offen
s_add_u32 s3, s51, 5120
buffer_load_dwordx4 v[68:71], v9, s[16:19], s3 offen
s_add_u32 s3, s51, 6144
buffer_load_dwordx4 v[72:75], v9, s[16:19], s3 offen
s_add_u32 s3, s51, 7168
buffer_load_dwordx4 v[76:79], v9, s[16:19], s3 offen
s_add_u32 s3, s51, 8192
buffer_load_dwordx4 v[80:83], v9, s[16:19], s3 offen
s_add_u32 s3, s51, 9216
buffer_load_dwordx4 v[84:87], v9, s[16:19], s3 offen
s_add_u32 s3, s51, 10240
buffer_load_dwordx4 v[88:91], v9, s[16:19], s3 offen
s_add_u32 s3, s51, 11264
buffer_load_dwordx4 v[92:95], v9, s[16:19], s3 offen
s_add_u32 s3, s51, 12288
buffer_load_dwordx4 v[96:99], v9, s[16:19], s3 offen
s_add_u32 s3, s51, 13312
buffer_load_dwordx4 v[100:103], v9, s[16:19], s3 offen
s_add_u32 s3, s51, 14336
buffer_load_dwordx4 v[104:107], v9, s[16:19], s3 offen
s_add_u32 s3, s51, 15360
buffer_load_dwordx4 v[108:111], v9, s[16:19], s3 offen
s_barrier
s_barrier
s_waitcnt vmcnt(0)
s_add_u32 s3, s52, 0
buffer_store_dwordx4 v[48:51], v124, s[24:27], s3 offen sc1
s_add_u32 s3, s52, 0
buffer_store_dwordx4 v[52:55], v128, s[24:27], s3 offen sc1
s_add_u32 s3, s52, 128
buffer_store_dwordx4 v[56:59], v124, s[24:27], s3 offen sc1
s_add_u32 s3, s52, 128
buffer_store_dwordx4 v[60:63], v128, s[24:27], s3 offen sc1
s_add_u32 s3, s52, 256
buffer_store_dwordx4 v[64:67], v125, s[24:27], s3 offen sc1
s_add_u32 s3, s52, 256
buffer_store_dwordx4 v[68:71], v129, s[24:27], s3 offen sc1
s_add_u32 s3, s52, 384
buffer_store_dwordx4 v[72:75], v125, s[24:27], s3 offen sc1
s_add_u32 s3, s52, 384
buffer_store_dwordx4 v[76:79], v129, s[24:27], s3 offen sc1
s_add_u32 s3, s52, 512
buffer_store_dwordx4 v[80:83], v126, s[24:27], s3 offen sc1
s_add_u32 s3, s52, 512
buffer_store_dwordx4 v[84:87], v130, s[24:27], s3 offen sc1
s_add_u32 s3, s52, 640
buffer_store_dwordx4 v[88:91], v126, s[24:27], s3 offen sc1
s_add_u32 s3, s52, 640
buffer_store_dwordx4 v[92:95], v130, s[24:27], s3 offen sc1
s_add_u32 s3, s52, 768
buffer_store_dwordx4 v[96:99], v127, s[24:27], s3 offen sc1
s_add_u32 s3, s52, 768
buffer_store_dwordx4 v[100:103], v131, s[24:27], s3 offen sc1
s_add_u32 s3, s52, 896
buffer_store_dwordx4 v[104:107], v127, s[24:27], s3 offen sc1
s_add_u32 s3, s52, 896
buffer_store_dwordx4 v[108:111], v131, s[24:27], s3 offen sc1
s_add_u32 s3, s51, 16384
buffer_load_dwordx4 v[48:51], v9, s[16:19], s3 offen
s_add_u32 s3, s51, 17408
buffer_load_dwordx4 v[52:55], v9, s[16:19], s3 offen
s_add_u32 s3, s51, 18432
buffer_load_dwordx4 v[56:59], v9, s[16:19], s3 offen
s_add_u32 s3, s51, 19456
buffer_load_dwordx4 v[60:63], v9, s[16:19], s3 offen
s_add_u32 s3, s51, 20480
buffer_load_dwordx4 v[64:67], v9, s[16:19], s3 offen
s_add_u32 s3, s51, 21504
buffer_load_dwordx4 v[68:71], v9, s[16:19], s3 offen
s_add_u32 s3, s51, 22528
buffer_load_dwordx4 v[72:75], v9, s[16:19], s3 offen
s_add_u32 s3, s51, 23552
buffer_load_dwordx4 v[76:79], v9, s[16:19], s3 offen
s_add_u32 s3, s51, 24576
buffer_load_dwordx4 v[80:83], v9, s[16:19], s3 offen
s_add_u32 s3, s51, 25600
buffer_load_dwordx4 v[84:87], v9, s[16:19], s3 offen
s_add_u32 s3, s51, 26624
buffer_load_dwordx4 v[88:91], v9, s[16:19], s3 offen
s_add_u32 s3, s51, 27648
buffer_load_dwordx4 v[92:95], v9, s[16:19], s3 offen
s_add_u32 s3, s51, 28672
buffer_load_dwordx4 v[96:99], v9, s[16:19], s3 offen
s_add_u32 s3, s51, 29696
buffer_load_dwordx4 v[100:103], v9, s[16:19], s3 offen
s_add_u32 s3, s51, 30720
buffer_load_dwordx4 v[104:107], v9, s[16:19], s3 offen
s_add_u32 s3, s51, 31744
buffer_load_dwordx4 v[108:111], v9, s[16:19], s3 offen
s_barrier
s_barrier
s_waitcnt vmcnt(0)
s_add_u32 s3, s52, 1024
buffer_store_dwordx4 v[48:51], v124, s[24:27], s3 offen sc1
s_add_u32 s3, s52, 1024
buffer_store_dwordx4 v[52:55], v128, s[24:27], s3 offen sc1
s_add_u32 s3, s52, 1152
buffer_store_dwordx4 v[56:59], v124, s[24:27], s3 offen sc1
s_add_u32 s3, s52, 1152
buffer_store_dwordx4 v[60:63], v128, s[24:27], s3 offen sc1
s_add_u32 s3, s52, 1280
buffer_store_dwordx4 v[64:67], v125, s[24:27], s3 offen sc1
s_add_u32 s3, s52, 1280
buffer_store_dwordx4 v[68:71], v129, s[24:27], s3 offen sc1
s_add_u32 s3, s52, 1408
buffer_store_dwordx4 v[72:75], v125, s[24:27], s3 offen sc1
s_add_u32 s3, s52, 1408
buffer_store_dwordx4 v[76:79], v129, s[24:27], s3 offen sc1
s_add_u32 s3, s52, 1536
buffer_store_dwordx4 v[80:83], v126, s[24:27], s3 offen sc1
s_add_u32 s3, s52, 1536
buffer_store_dwordx4 v[84:87], v130, s[24:27], s3 offen sc1
s_add_u32 s3, s52, 1664
buffer_store_dwordx4 v[88:91], v126, s[24:27], s3 offen sc1
s_add_u32 s3, s52, 1664
buffer_store_dwordx4 v[92:95], v130, s[24:27], s3 offen sc1
s_add_u32 s3, s52, 1792
buffer_store_dwordx4 v[96:99], v127, s[24:27], s3 offen sc1
s_add_u32 s3, s52, 1792
buffer_store_dwordx4 v[100:103], v131, s[24:27], s3 offen sc1
s_add_u32 s3, s52, 1920
buffer_store_dwordx4 v[104:107], v127, s[24:27], s3 offen sc1
s_add_u32 s3, s52, 1920
buffer_store_dwordx4 v[108:111], v131, s[24:27], s3 offen sc1
s_sub_u32 s50, s2, 224
s_lshl_b32 s50, s50, 1
s_add_u32 s50, s50, 161
s_lshl_b32 s51, s50, 15
s_mul_i32 s3, s50, 4682
s_lshr_b32 s3, s3, 16
s_mul_i32 s10, s3, 14
s_sub_u32 s10, s50, s10
s_mul_i32 s3, s3, 7
s_cmp_ge_u32 s10, 7
s_cselect_b32 s11, 1, 0
s_sub_u32 s11, s10, s11
s_lshr_b32 s52, s11, 1
s_and_b32 s11, s11, 1
s_cmp_eq_u32 s10, 6
s_cselect_b32 s52, 6, s52
s_cselect_b32 s11, 0, s11
s_cmp_eq_u32 s10, 13
s_cselect_b32 s52, 6, s52
s_cselect_b32 s11, 1, s11
s_add_u32 s52, s52, s3
s_and_b32 s3, s52, 1
s_lshl_b32 s3, s3, 12
s_lshl_b32 s11, s11, 11
s_add_u32 s3, s3, s11
s_lshr_b32 s52, s52, 1
s_lshl_b32 s52, s52, 13
s_add_u32 s52, s52, s3
s_add_u32 s52, s52, 40894464
s_add_u32 s3, s51, 0
buffer_load_dwordx4 v[48:51], v9, s[16:19], s3 offen
s_add_u32 s3, s51, 1024
buffer_load_dwordx4 v[52:55], v9, s[16:19], s3 offen
s_add_u32 s3, s51, 2048
buffer_load_dwordx4 v[56:59], v9, s[16:19], s3 offen
s_add_u32 s3, s51, 3072
buffer_load_dwordx4 v[60:63], v9, s[16:19], s3 offen
s_add_u32 s3, s51, 4096
buffer_load_dwordx4 v[64:67], v9, s[16:19], s3 offen
s_add_u32 s3, s51, 5120
buffer_load_dwordx4 v[68:71], v9, s[16:19], s3 offen
s_add_u32 s3, s51, 6144
buffer_load_dwordx4 v[72:75], v9, s[16:19], s3 offen
s_add_u32 s3, s51, 7168
buffer_load_dwordx4 v[76:79], v9, s[16:19], s3 offen
s_add_u32 s3, s51, 8192
buffer_load_dwordx4 v[80:83], v9, s[16:19], s3 offen
s_add_u32 s3, s51, 9216
buffer_load_dwordx4 v[84:87], v9, s[16:19], s3 offen
s_add_u32 s3, s51, 10240
buffer_load_dwordx4 v[88:91], v9, s[16:19], s3 offen
s_add_u32 s3, s51, 11264
buffer_load_dwordx4 v[92:95], v9, s[16:19], s3 offen
s_add_u32 s3, s51, 12288
buffer_load_dwordx4 v[96:99], v9, s[16:19], s3 offen
s_add_u32 s3, s51, 13312
buffer_load_dwordx4 v[100:103], v9, s[16:19], s3 offen
s_add_u32 s3, s51, 14336
buffer_load_dwordx4 v[104:107], v9, s[16:19], s3 offen
s_add_u32 s3, s51, 15360
buffer_load_dwordx4 v[108:111], v9, s[16:19], s3 offen
s_barrier
s_barrier
s_waitcnt vmcnt(0)
s_add_u32 s3, s52, 0
buffer_store_dwordx4 v[48:51], v124, s[24:27], s3 offen sc1
s_add_u32 s3, s52, 0
buffer_store_dwordx4 v[52:55], v128, s[24:27], s3 offen sc1
s_add_u32 s3, s52, 128
buffer_store_dwordx4 v[56:59], v124, s[24:27], s3 offen sc1
s_add_u32 s3, s52, 128
buffer_store_dwordx4 v[60:63], v128, s[24:27], s3 offen sc1
s_add_u32 s3, s52, 256
buffer_store_dwordx4 v[64:67], v125, s[24:27], s3 offen sc1
s_add_u32 s3, s52, 256
buffer_store_dwordx4 v[68:71], v129, s[24:27], s3 offen sc1
s_add_u32 s3, s52, 384
buffer_store_dwordx4 v[72:75], v125, s[24:27], s3 offen sc1
s_add_u32 s3, s52, 384
buffer_store_dwordx4 v[76:79], v129, s[24:27], s3 offen sc1
s_add_u32 s3, s52, 512
buffer_store_dwordx4 v[80:83], v126, s[24:27], s3 offen sc1
s_add_u32 s3, s52, 512
buffer_store_dwordx4 v[84:87], v130, s[24:27], s3 offen sc1
s_add_u32 s3, s52, 640
buffer_store_dwordx4 v[88:91], v126, s[24:27], s3 offen sc1
s_add_u32 s3, s52, 640
buffer_store_dwordx4 v[92:95], v130, s[24:27], s3 offen sc1
s_add_u32 s3, s52, 768
buffer_store_dwordx4 v[96:99], v127, s[24:27], s3 offen sc1
s_add_u32 s3, s52, 768
buffer_store_dwordx4 v[100:103], v131, s[24:27], s3 offen sc1
s_add_u32 s3, s52, 896
buffer_store_dwordx4 v[104:107], v127, s[24:27], s3 offen sc1
s_add_u32 s3, s52, 896
buffer_store_dwordx4 v[108:111], v131, s[24:27], s3 offen sc1
s_add_u32 s3, s51, 16384
buffer_load_dwordx4 v[48:51], v9, s[16:19], s3 offen
s_add_u32 s3, s51, 17408
buffer_load_dwordx4 v[52:55], v9, s[16:19], s3 offen
s_add_u32 s3, s51, 18432
buffer_load_dwordx4 v[56:59], v9, s[16:19], s3 offen
s_add_u32 s3, s51, 19456
buffer_load_dwordx4 v[60:63], v9, s[16:19], s3 offen
s_add_u32 s3, s51, 20480
buffer_load_dwordx4 v[64:67], v9, s[16:19], s3 offen
s_add_u32 s3, s51, 21504
buffer_load_dwordx4 v[68:71], v9, s[16:19], s3 offen
s_add_u32 s3, s51, 22528
buffer_load_dwordx4 v[72:75], v9, s[16:19], s3 offen
s_add_u32 s3, s51, 23552
buffer_load_dwordx4 v[76:79], v9, s[16:19], s3 offen
s_add_u32 s3, s51, 24576
buffer_load_dwordx4 v[80:83], v9, s[16:19], s3 offen
s_add_u32 s3, s51, 25600
buffer_load_dwordx4 v[84:87], v9, s[16:19], s3 offen
s_add_u32 s3, s51, 26624
buffer_load_dwordx4 v[88:91], v9, s[16:19], s3 offen
s_add_u32 s3, s51, 27648
buffer_load_dwordx4 v[92:95], v9, s[16:19], s3 offen
s_add_u32 s3, s51, 28672
buffer_load_dwordx4 v[96:99], v9, s[16:19], s3 offen
s_add_u32 s3, s51, 29696
buffer_load_dwordx4 v[100:103], v9, s[16:19], s3 offen
s_add_u32 s3, s51, 30720
buffer_load_dwordx4 v[104:107], v9, s[16:19], s3 offen
s_add_u32 s3, s51, 31744
buffer_load_dwordx4 v[108:111], v9, s[16:19], s3 offen
s_barrier
s_barrier
s_waitcnt vmcnt(0)
s_add_u32 s3, s52, 1024
buffer_store_dwordx4 v[48:51], v124, s[24:27], s3 offen sc1
s_add_u32 s3, s52, 1024
buffer_store_dwordx4 v[52:55], v128, s[24:27], s3 offen sc1
s_add_u32 s3, s52, 1152
buffer_store_dwordx4 v[56:59], v124, s[24:27], s3 offen sc1
s_add_u32 s3, s52, 1152
buffer_store_dwordx4 v[60:63], v128, s[24:27], s3 offen sc1
s_add_u32 s3, s52, 1280
buffer_store_dwordx4 v[64:67], v125, s[24:27], s3 offen sc1
s_add_u32 s3, s52, 1280
buffer_store_dwordx4 v[68:71], v129, s[24:27], s3 offen sc1
s_add_u32 s3, s52, 1408
buffer_store_dwordx4 v[72:75], v125, s[24:27], s3 offen sc1
s_add_u32 s3, s52, 1408
buffer_store_dwordx4 v[76:79], v129, s[24:27], s3 offen sc1
s_add_u32 s3, s52, 1536
buffer_store_dwordx4 v[80:83], v126, s[24:27], s3 offen sc1
s_add_u32 s3, s52, 1536
buffer_store_dwordx4 v[84:87], v130, s[24:27], s3 offen sc1
s_add_u32 s3, s52, 1664
buffer_store_dwordx4 v[88:91], v126, s[24:27], s3 offen sc1
s_add_u32 s3, s52, 1664
buffer_store_dwordx4 v[92:95], v130, s[24:27], s3 offen sc1
s_add_u32 s3, s52, 1792
buffer_store_dwordx4 v[96:99], v127, s[24:27], s3 offen sc1
s_add_u32 s3, s52, 1792
buffer_store_dwordx4 v[100:103], v131, s[24:27], s3 offen sc1
s_add_u32 s3, s52, 1920
buffer_store_dwordx4 v[104:107], v127, s[24:27], s3 offen sc1
s_add_u32 s3, s52, 1920
buffer_store_dwordx4 v[108:111], v131, s[24:27], s3 offen sc1
s_barrier
s_barrier
s_barrier
s_endpgm
k3_kernel_end:
s_endpgm
.section .rodata,"a"
.p2align 6
.amdhsa_kernel k3_kernel
  .amdhsa_next_free_vgpr 144
  .amdhsa_next_free_sgpr 102
  .amdhsa_accum_offset 144
  .amdhsa_group_segment_fixed_size 0
  .amdhsa_kernarg_size 112
  .amdhsa_user_sgpr_count 2
  .amdhsa_user_sgpr_kernarg_segment_ptr 1
  .amdhsa_system_sgpr_workgroup_id_x 1
.end_amdhsa_kernel
.text
.globl k4_kernel
.p2align 8
.type k4_kernel,@function
k4_kernel:
s_cmp_ge_u32 s2, 256
s_cbranch_scc1 k4_kernel_end
s_load_dwordx2 s[4:5], s[0:1], 32
s_load_dwordx2 s[8:9], s[0:1], 104
s_load_dwordx2 s[44:45], s[0:1], 0
v_lshrrev_b32 v1, 6, v0
v_and_b32 v138, 63, v0
v_readfirstlane_b32 s32, v1
s_and_b32 s3, s2, 7
s_lshr_b32 s10, s2, 3
s_lshr_b32 s35, s3, 1
s_lshl_b32 s35, s35, 2
s_and_b32 s11, s10, 3
s_add_u32 s35, s35, s11
s_and_b32 s36, s3, 1
s_lshl_b32 s36, s36, 3
s_lshr_b32 s11, s10, 2
s_add_u32 s36, s36, s11
s_lshr_b32 s33, s32, 2
s_and_b32 s34, s32, 3
s_mov_b32 s41, 0
v_lshlrev_b32 v128, 4, v138
s_lshl_b32 s3, s34, 11
s_lshl_b32 s10, s35, 13
s_add_u32 s3, s3, s10
s_lshl_b32 s10, s33, 17
s_add_u32 s3, s3, s10
v_add_u32 v128, s3, v128
s_lshl_b32 s10, s41, 10
v_add_u32 v129, 1024, v128
v_subrev_u32 v129, s10, v129
v_add_u32 v128, s10, v128
v_lshrrev_b32 v2, 3, v138
s_lshl_b32 s3, s32, 3
v_add_u32 v3, s3, v2
v_bfe_u32 v4, v3, 1, 1
v_bfe_u32 v5, v3, 3, 1
v_lshl_or_b32 v4, v5, 1, v4
v_bfe_u32 v5, v138, 1, 2
v_xor_b32 v5, v5, v4
v_and_b32 v6, 1, v138
v_lshl_or_b32 v5, v5, 1, v6
v_lshlrev_b32 v5, 4, v5
v_lshl_add_u32 v130, v3, 11, v5
s_lshl_b32 s40, s32, 10
s_waitcnt lgkmcnt(0)
s_add_u32 s12, s8, 12582912
s_addc_u32 s13, s9, 0
s_and_b32 s13, s13, 0xffff
s_mov_b32 s14, 4194304
s_mov_b32 s15, 0x00020000
s_lshl_b32 s3, s36, 7
s_add_u32 s16, s4, s3
s_addc_u32 s17, s5, 0
s_and_b32 s17, s17, 0xffff
s_sub_u32 s18, 2097152, s3
s_mov_b32 s19, 0x00020000
s_mov_b32 s24, s8
s_and_b32 s25, s9, 0xffff
s_mov_b32 s26, 67108864
s_mov_b32 s27, 0x00020000
s_mov_b32 s28, s44
s_and_b32 s29, s45, 0xffff
s_mov_b32 s30, 4194304
s_mov_b32 s31, 0x00020000
s_mov_b32 s37, 0
s_mov_b32 s39, 0
s_mov_b32 s38, 0
v_and_b32 v2, 15, v138
v_lshrrev_b32 v3, 4, v138
s_add_u32 m0, s40, 0
s_nop 0
buffer_load_dwordx4 v130, s[16:19], s38 offen lds
s_add_u32 s38, s38, 131072
s_add_u32 m0, s40, 8192
s_nop 0
buffer_load_dwordx4 v130, s[16:19], s38 offen lds
s_add_u32 s38, s38, 131072
buffer_load_dwordx4 v[48:51], v128, s[12:15], s37 offen
buffer_load_dwordx4 v[52:55], v129, s[12:15], s37 offen
s_add_u32 s37, s37, 262144
s_add_u32 m0, s40, 16384
s_nop 0
buffer_load_dwordx4 v130, s[16:19], s38 offen lds
s_add_u32 s38, s38, 131072
buffer_load_dwordx4 v[56:59], v128, s[12:15], s37 offen
buffer_load_dwordx4 v[60:63], v129, s[12:15], s37 offen
s_add_u32 s37, s37, 262144
s_add_u32 m0, s40, 24576
s_nop 0
buffer_load_dwordx4 v130, s[16:19], s38 offen lds
s_add_u32 s38, s38, 131072
buffer_load_dwordx4 v[64:67], v128, s[12:15], s37 offen
buffer_load_dwordx4 v[68:71], v129, s[12:15], s37 offen
s_add_u32 s37, s37, 262144
s_add_u32 m0, s40, 32768
s_nop 0
buffer_load_dwordx4 v130, s[16:19], s38 offen lds
s_add_u32 s38, s38, 131072
buffer_load_dwordx4 v[72:75], v128, s[12:15], s37 offen
buffer_load_dwordx4 v[76:79], v129, s[12:15], s37 offen
s_add_u32 s37, s37, 262144
s_xor_b32 s55, s33, s41
s_lshl_b32 s55, s55, 4
s_lshl_b32 s3, s34, 5
s_add_u32 s55, s55, s3
s_lshl_b32 s3, s35, 7
s_add_u32 s55, s55, s3
v_bfe_u32 v4, v138, 2, 2
v_lshl_add_u32 v5, v3, 3, v4
v_bfe_u32 v6, v5, 1, 1
v_bfe_u32 v7, v5, 3, 1
v_lshl_or_b32 v6, v7, 1, v6
s_lshl_b32 s3, s33, 5
v_add_u32 v5, s3, v5
v_and_b32 v7, 3, v138
v_lshlrev_b32 v7, 3, v7
v_lshl_add_u32 v7, v5, 7, v7
v_xor_b32 v8, 0, v6
v_lshl_add_u32 v132, v8, 5, v7
v_xor_b32 v8, 1, v6
v_lshl_add_u32 v133, v8, 5, v7
v_xor_b32 v8, 2, v6
v_lshl_add_u32 v134, v8, 5, v7
v_xor_b32 v8, 3, v6
v_lshl_add_u32 v135, v8, 5, v7
v_mov_b32 v16, 0
v_mov_b32 v17, 0
v_mov_b32 v18, 0
v_mov_b32 v19, 0
v_mov_b32 v20, 0
v_mov_b32 v21, 0
v_mov_b32 v22, 0
v_mov_b32 v23, 0
v_mov_b32 v24, 0
v_mov_b32 v25, 0
v_mov_b32 v26, 0
v_mov_b32 v27, 0
v_mov_b32 v28, 0
v_mov_b32 v29, 0
v_mov_b32 v30, 0
v_mov_b32 v31, 0
v_mov_b32 v32, 0
v_mov_b32 v33, 0
v_mov_b32 v34, 0
v_mov_b32 v35, 0
v_mov_b32 v36, 0
v_mov_b32 v37, 0
v_mov_b32 v38, 0
v_mov_b32 v39, 0
v_mov_b32 v40, 0
v_mov_b32 v41, 0
v_mov_b32 v42, 0
v_mov_b32 v43, 0
v_mov_b32 v44, 0
v_mov_b32 v45, 0
v_mov_b32 v46, 0
v_mov_b32 v47, 0
s_waitcnt vmcnt(12)
s_barrier
ds_read_b64_tr_b16 v[96:97], v132 offset:0
ds_read_b64_tr_b16 v[98:99], v132 offset:512
ds_read_b64_tr_b16 v[100:101], v133 offset:0
ds_read_b64_tr_b16 v[102:103], v133 offset:512
ds_read_b64_tr_b16 v[104:105], v134 offset:0
ds_read_b64_tr_b16 v[106:107], v134 offset:512
ds_read_b64_tr_b16 v[108:109], v135 offset:0
ds_read_b64_tr_b16 v[110:111], v135 offset:512
s_waitcnt vmcnt(9) lgkmcnt(0)
s_barrier
v_mfma_f32_16x16x32_bf16 v[16:19], v[96:99], v[48:51], v[16:19]
ds_read_b64_tr_b16 v[112:113], v132 offset:8192
ds_read_b64_tr_b16 v[114:115], v132 offset:8704
v_mfma_f32_16x16x32_bf16 v[32:35], v[96:99], v[52:55], v[32:35]
ds_read_b64_tr_b16 v[116:117], v133 offset:8192
ds_read_b64_tr_b16 v[118:119], v133 offset:8704
v_mfma_f32_16x16x32_bf16 v[20:23], v[100:103], v[48:51], v[20:23]
ds_read_b64_tr_b16 v[120:121], v134 offset:8192
ds_read_b64_tr_b16 v[122:123], v134 offset:8704
v_mfma_f32_16x16x32_bf16 v[36:39], v[100:103], v[52:55], v[36:39]
ds_read_b64_tr_b16 v[124:125], v135 offset:8192
v_mfma_f32_16x16x32_bf16 v[24:27], v[104:107], v[48:51], v[24:27]
ds_read_b64_tr_b16 v[126:127], v135 offset:8704
s_add_u32 m0, s40, 40960
s_nop 0
buffer_load_dwordx4 v130, s[16:19], s38 offen lds
s_add_u32 s38, s38, 131072
v_mfma_f32_16x16x32_bf16 v[40:43], v[104:107], v[52:55], v[40:43]
buffer_load_dwordx4 v[80:83], v128, s[12:15], s37 offen
buffer_load_dwordx4 v[84:87], v129, s[12:15], s37 offen
s_add_u32 s37, s37, 262144
v_mfma_f32_16x16x32_bf16 v[28:31], v[108:111], v[48:51], v[28:31]
v_mfma_f32_16x16x32_bf16 v[44:47], v[108:111], v[52:55], v[44:47]
s_waitcnt vmcnt(9) lgkmcnt(0)
s_barrier
v_mfma_f32_16x16x32_bf16 v[16:19], v[112:115], v[56:59], v[16:19]
ds_read_b64_tr_b16 v[96:97], v132 offset:16384
ds_read_b64_tr_b16 v[98:99], v132 offset:16896
v_mfma_f32_16x16x32_bf16 v[32:35], v[112:115], v[60:63], v[32:35]
ds_read_b64_tr_b16 v[100:101], v133 offset:16384
ds_read_b64_tr_b16 v[102:103], v133 offset:16896
v_mfma_f32_16x16x32_bf16 v[20:23], v[116:119], v[56:59], v[20:23]
ds_read_b64_tr_b16 v[104:105], v134 offset:16384
ds_read_b64_tr_b16 v[106:107], v134 offset:16896
v_mfma_f32_16x16x32_bf16 v[36:39], v[116:119], v[60:63], v[36:39]
ds_read_b64_tr_b16 v[108:109], v135 offset:16384
v_mfma_f32_16x16x32_bf16 v[24:27], v[120:123], v[56:59], v[24:27]
ds_read_b64_tr_b16 v[110:111], v135 offset:16896
s_add_u32 m0, s40, 49152
s_nop 0
buffer_load_dwordx4 v130, s[16:19], s38 offen lds
s_add_u32 s38, s38, 131072
v_mfma_f32_16x16x32_bf16 v[40:43], v[120:123], v[60:63], v[40:43]
buffer_load_dwordx4 v[88:91], v128, s[12:15], s37 offen
buffer_load_dwordx4 v[92:95], v129, s[12:15], s37 offen
s_add_u32 s37, s37, 262144
v_mfma_f32_16x16x32_bf16 v[28:31], v[124:127], v[56:59], v[28:31]
v_mfma_f32_16x16x32_bf16 v[44:47], v[124:127], v[60:63], v[44:47]
s_waitcnt vmcnt(9) lgkmcnt(0)
s_barrier
v_mfma_f32_16x16x32_bf16 v[16:19], v[96:99], v[64:67], v[16:19]
ds_read_b64_tr_b16 v[112:113], v132 offset:24576
ds_read_b64_tr_b16 v[114:115], v132 offset:25088
v_mfma_f32_16x16x32_bf16 v[32:35], v[96:99], v[68:71], v[32:35]
ds_read_b64_tr_b16 v[116:117], v133 offset:24576
ds_read_b64_tr_b16 v[118:119], v133 offset:25088
v_mfma_f32_16x16x32_bf16 v[20:23], v[100:103], v[64:67], v[20:23]
ds_read_b64_tr_b16 v[120:121], v134 offset:24576
ds_read_b64_tr_b16 v[122:123], v134 offset:25088
v_mfma_f32_16x16x32_bf16 v[36:39], v[100:103], v[68:71], v[36:39]
ds_read_b64_tr_b16 v[124:125], v135 offset:24576
v_mfma_f32_16x16x32_bf16 v[24:27], v[104:107], v[64:67], v[24:27]
ds_read_b64_tr_b16 v[126:127], v135 offset:25088
s_add_u32 m0, s40, 57344
s_nop 0
buffer_load_dwordx4 v130, s[16:19], s38 offen lds
s_add_u32 s38, s38, 131072
v_mfma_f32_16x16x32_bf16 v[40:43], v[104:107], v[68:71], v[40:43]
buffer_load_dwordx4 v[48:51], v128, s[12:15], s37 offen
buffer_load_dwordx4 v[52:55], v129, s[12:15], s37 offen
s_add_u32 s37, s37, 262144
v_mfma_f32_16x16x32_bf16 v[28:31], v[108:111], v[64:67], v[28:31]
v_mfma_f32_16x16x32_bf16 v[44:47], v[108:111], v[68:71], v[44:47]
s_waitcnt vmcnt(9) lgkmcnt(0)
s_barrier
v_mfma_f32_16x16x32_bf16 v[16:19], v[112:115], v[72:75], v[16:19]
ds_read_b64_tr_b16 v[96:97], v132 offset:32768
ds_read_b64_tr_b16 v[98:99], v132 offset:33280
v_mfma_f32_16x16x32_bf16 v[32:35], v[112:115], v[76:79], v[32:35]
ds_read_b64_tr_b16 v[100:101], v133 offset:32768
ds_read_b64_tr_b16 v[102:103], v133 offset:33280
v_mfma_f32_16x16x32_bf16 v[20:23], v[116:119], v[72:75], v[20:23]
ds_read_b64_tr_b16 v[104:105], v134 offset:32768
ds_read_b64_tr_b16 v[106:107], v134 offset:33280
v_mfma_f32_16x16x32_bf16 v[36:39], v[116:119], v[76:79], v[36:39]
ds_read_b64_tr_b16 v[108:109], v135 offset:32768
v_mfma_f32_16x16x32_bf16 v[24:27], v[120:123], v[72:75], v[24:27]
ds_read_b64_tr_b16 v[110:111], v135 offset:33280
s_add_u32 m0, s40, 0
s_nop 0
buffer_load_dwordx4 v130, s[16:19], s38 offen lds
s_add_u32 s38, s38, 131072
v_mfma_f32_16x16x32_bf16 v[40:43], v[120:123], v[76:79], v[40:43]
buffer_load_dwordx4 v[56:59], v128, s[12:15], s37 offen
buffer_load_dwordx4 v[60:63], v129, s[12:15], s37 offen
s_add_u32 s37, s37, 262144
v_mfma_f32_16x16x32_bf16 v[28:31], v[124:127], v[72:75], v[28:31]
v_mfma_f32_16x16x32_bf16 v[44:47], v[124:127], v[76:79], v[44:47]
s_waitcnt vmcnt(9) lgkmcnt(0)
s_barrier
v_mfma_f32_16x16x32_bf16 v[16:19], v[96:99], v[80:83], v[16:19]
ds_read_b64_tr_b16 v[112:113], v132 offset:40960
ds_read_b64_tr_b16 v[114:115], v132 offset:41472
v_mfma_f32_16x16x32_bf16 v[32:35], v[96:99], v[84:87], v[32:35]
ds_read_b64_tr_b16 v[116:117], v133 offset:40960
ds_read_b64_tr_b16 v[118:119], v133 offset:41472
v_mfma_f32_16x16x32_bf16 v[20:23], v[100:103], v[80:83], v[20:23]
ds_read_b64_tr_b16 v[120:121], v134 offset:40960
ds_read_b64_tr_b16 v[122:123], v134 offset:41472
v_mfma_f32_16x16x32_bf16 v[36:39], v[100:103], v[84:87], v[36:39]
ds_read_b64_tr_b16 v[124:125], v135 offset:40960
v_mfma_f32_16x16x32_bf16 v[24:27], v[104:107], v[80:83], v[24:27]
ds_read_b64_tr_b16 v[126:127], v135 offset:41472
s_add_u32 m0, s40, 8192
s_nop 0
buffer_load_dwordx4 v130, s[16:19], s38 offen lds
s_add_u32 s38, s38, 131072
v_mfma_f32_16x16x32_bf16 v[40:43], v[104:107], v[84:87], v[40:43]
buffer_load_dwordx4 v[64:67], v128, s[12:15], s37 offen
buffer_load_dwordx4 v[68:71], v129, s[12:15], s37 offen
s_add_u32 s37, s37, 262144
v_mfma_f32_16x16x32_bf16 v[28:31], v[108:111], v[80:83], v[28:31]
v_mfma_f32_16x16x32_bf16 v[44:47], v[108:111], v[84:87], v[44:47]
s_waitcnt vmcnt(9) lgkmcnt(0)
s_barrier
v_mfma_f32_16x16x32_bf16 v[16:19], v[112:115], v[88:91], v[16:19]
ds_read_b64_tr_b16 v[96:97], v132 offset:49152
ds_read_b64_tr_b16 v[98:99], v132 offset:49664
v_mfma_f32_16x16x32_bf16 v[32:35], v[112:115], v[92:95], v[32:35]
ds_read_b64_tr_b16 v[100:101], v133 offset:49152
ds_read_b64_tr_b16 v[102:103], v133 offset:49664
v_mfma_f32_16x16x32_bf16 v[20:23], v[116:119], v[88:91], v[20:23]
ds_read_b64_tr_b16 v[104:105], v134 offset:49152
ds_read_b64_tr_b16 v[106:107], v134 offset:49664
v_mfma_f32_16x16x32_bf16 v[36:39], v[116:119], v[92:95], v[36:39]
ds_read_b64_tr_b16 v[108:109], v135 offset:49152
v_mfma_f32_16x16x32_bf16 v[24:27], v[120:123], v[88:91], v[24:27]
ds_read_b64_tr_b16 v[110:111], v135 offset:49664
s_add_u32 m0, s40, 16384
s_nop 0
buffer_load_dwordx4 v130, s[16:19], s38 offen lds
s_add_u32 s38, s38, 131072
v_mfma_f32_16x16x32_bf16 v[40:43], v[120:123], v[92:95], v[40:43]
buffer_load_dwordx4 v[72:75], v128, s[12:15], s37 offen
buffer_load_dwordx4 v[76:79], v129, s[12:15], s37 offen
s_add_u32 s37, s37, 262144
v_mfma_f32_16x16x32_bf16 v[28:31], v[124:127], v[88:91], v[28:31]
v_mfma_f32_16x16x32_bf16 v[44:47], v[124:127], v[92:95], v[44:47]
s_waitcnt vmcnt(9) lgkmcnt(0)
s_barrier
v_mfma_f32_16x16x32_bf16 v[16:19], v[96:99], v[48:51], v[16:19]
ds_read_b64_tr_b16 v[112:113], v132 offset:57344
ds_read_b64_tr_b16 v[114:115], v132 offset:57856
v_mfma_f32_16x16x32_bf16 v[32:35], v[96:99], v[52:55], v[32:35]
ds_read_b64_tr_b16 v[116:117], v133 offset:57344
ds_read_b64_tr_b16 v[118:119], v133 offset:57856
v_mfma_f32_16x16x32_bf16 v[20:23], v[100:103], v[48:51], v[20:23]
ds_read_b64_tr_b16 v[120:121], v134 offset:57344
ds_read_b64_tr_b16 v[122:123], v134 offset:57856
v_mfma_f32_16x16x32_bf16 v[36:39], v[100:103], v[52:55], v[36:39]
ds_read_b64_tr_b16 v[124:125], v135 offset:57344
v_mfma_f32_16x16x32_bf16 v[24:27], v[104:107], v[48:51], v[24:27]
ds_read_b64_tr_b16 v[126:127], v135 offset:57856
s_add_u32 m0, s40, 24576
s_nop 0
buffer_load_dwordx4 v130, s[16:19], s38 offen lds
s_add_u32 s38, s38, 131072
v_mfma_f32_16x16x32_bf16 v[40:43], v[104:107], v[52:55], v[40:43]
buffer_load_dwordx4 v[80:83], v128, s[12:15], s37 offen
buffer_load_dwordx4 v[84:87], v129, s[12:15], s37 offen
s_add_u32 s37, s37, 262144
v_mfma_f32_16x16x32_bf16 v[28:31], v[108:111], v[48:51], v[28:31]
v_mfma_f32_16x16x32_bf16 v[44:47], v[108:111], v[52:55], v[44:47]
s_waitcnt vmcnt(9) lgkmcnt(0)
s_barrier
v_mfma_f32_16x16x32_bf16 v[16:19], v[112:115], v[56:59], v[16:19]
ds_read_b64_tr_b16 v[96:97], v132 offset:0
ds_read_b64_tr_b16 v[98:99], v132 offset:512
v_mfma_f32_16x16x32_bf16 v[32:35], v[112:115], v[60:63], v[32:35]
ds_read_b64_tr_b16 v[100:101], v133 offset:0
ds_read_b64_tr_b16 v[102:103], v133 offset:512
v_mfma_f32_16x16x32_bf16 v[20:23], v[116:119], v[56:59], v[20:23]
ds_read_b64_tr_b16 v[104:105], v134 offset:0
ds_read_b64_tr_b16 v[106:107], v134 offset:512
v_mfma_f32_16x16x32_bf16 v[36:39], v[116:119], v[60:63], v[36:39]
ds_read_b64_tr_b16 v[108:109], v135 offset:0
v_mfma_f32_16x16x32_bf16 v[24:27], v[120:123], v[56:59], v[24:27]
ds_read_b64_tr_b16 v[110:111], v135 offset:512
s_add_u32 m0, s40, 32768
s_nop 0
buffer_load_dwordx4 v130, s[16:19], s38 offen lds
s_add_u32 s38, s38, 131072
v_mfma_f32_16x16x32_bf16 v[40:43], v[120:123], v[60:63], v[40:43]
buffer_load_dwordx4 v[88:91], v128, s[12:15], s37 offen
buffer_load_dwordx4 v[92:95], v129, s[12:15], s37 offen
s_add_u32 s37, s37, 262144
v_mfma_f32_16x16x32_bf16 v[28:31], v[124:127], v[56:59], v[28:31]
v_mfma_f32_16x16x32_bf16 v[44:47], v[124:127], v[60:63], v[44:47]
s_waitcnt vmcnt(9) lgkmcnt(0)
s_barrier
v_mfma_f32_16x16x32_bf16 v[16:19], v[96:99], v[64:67], v[16:19]
ds_read_b64_tr_b16 v[112:113], v132 offset:8192
ds_read_b64_tr_b16 v[114:115], v132 offset:8704
v_mfma_f32_16x16x32_bf16 v[32:35], v[96:99], v[68:71], v[32:35]
ds_read_b64_tr_b16 v[116:117], v133 offset:8192
ds_read_b64_tr_b16 v[118:119], v133 offset:8704
v_mfma_f32_16x16x32_bf16 v[20:23], v[100:103], v[64:67], v[20:23]
ds_read_b64_tr_b16 v[120:121], v134 offset:8192
ds_read_b64_tr_b16 v[122:123], v134 offset:8704
v_mfma_f32_16x16x32_bf16 v[36:39], v[100:103], v[68:71], v[36:39]
ds_read_b64_tr_b16 v[124:125], v135 offset:8192
v_mfma_f32_16x16x32_bf16 v[24:27], v[104:107], v[64:67], v[24:27]
ds_read_b64_tr_b16 v[126:127], v135 offset:8704
s_add_u32 m0, s40, 40960
s_nop 0
buffer_load_dwordx4 v130, s[16:19], s38 offen lds
s_add_u32 s38, s38, 131072
v_mfma_f32_16x16x32_bf16 v[40:43], v[104:107], v[68:71], v[40:43]
buffer_load_dwordx4 v[48:51], v128, s[12:15], s37 offen
buffer_load_dwordx4 v[52:55], v129, s[12:15], s37 offen
s_add_u32 s37, s37, 262144
v_mfma_f32_16x16x32_bf16 v[28:31], v[108:111], v[64:67], v[28:31]
v_mfma_f32_16x16x32_bf16 v[44:47], v[108:111], v[68:71], v[44:47]
s_waitcnt vmcnt(9) lgkmcnt(0)
s_barrier
v_mfma_f32_16x16x32_bf16 v[16:19], v[112:115], v[72:75], v[16:19]
ds_read_b64_tr_b16 v[96:97], v132 offset:16384
ds_read_b64_tr_b16 v[98:99], v132 offset:16896
v_mfma_f32_16x16x32_bf16 v[32:35], v[112:115], v[76:79], v[32:35]
ds_read_b64_tr_b16 v[100:101], v133 offset:16384
ds_read_b64_tr_b16 v[102:103], v133 offset:16896
v_mfma_f32_16x16x32_bf16 v[20:23], v[116:119], v[72:75], v[20:23]
ds_read_b64_tr_b16 v[104:105], v134 offset:16384
ds_read_b64_tr_b16 v[106:107], v134 offset:16896
v_mfma_f32_16x16x32_bf16 v[36:39], v[116:119], v[76:79], v[36:39]
ds_read_b64_tr_b16 v[108:109], v135 offset:16384
v_mfma_f32_16x16x32_bf16 v[24:27], v[120:123], v[72:75], v[24:27]
ds_read_b64_tr_b16 v[110:111], v135 offset:16896
s_add_u32 m0, s40, 49152
s_nop 0
buffer_load_dwordx4 v130, s[16:19], s38 offen lds
s_add_u32 s38, s38, 131072
v_mfma_f32_16x16x32_bf16 v[40:43], v[120:123], v[76:79], v[40:43]
buffer_load_dwordx4 v[56:59], v128, s[12:15], s37 offen
buffer_load_dwordx4 v[60:63], v129, s[12:15], s37 offen
s_add_u32 s37, s37, 262144
v_mfma_f32_16x16x32_bf16 v[28:31], v[124:127], v[72:75], v[28:31]
v_mfma_f32_16x16x32_bf16 v[44:47], v[124:127], v[76:79], v[44:47]
s_waitcnt vmcnt(9) lgkmcnt(0)
s_barrier
v_mfma_f32_16x16x32_bf16 v[16:19], v[96:99], v[80:83], v[16:19]
ds_read_b64_tr_b16 v[112:113], v132 offset:24576
ds_read_b64_tr_b16 v[114:115], v132 offset:25088
v_mfma_f32_16x16x32_bf16 v[32:35], v[96:99], v[84:87], v[32:35]
ds_read_b64_tr_b16 v[116:117], v133 offset:24576
ds_read_b64_tr_b16 v[118:119], v133 offset:25088
v_mfma_f32_16x16x32_bf16 v[20:23], v[100:103], v[80:83], v[20:23]
ds_read_b64_tr_b16 v[120:121], v134 offset:24576
ds_read_b64_tr_b16 v[122:123], v134 offset:25088
v_mfma_f32_16x16x32_bf16 v[36:39], v[100:103], v[84:87], v[36:39]
ds_read_b64_tr_b16 v[124:125], v135 offset:24576
v_mfma_f32_16x16x32_bf16 v[24:27], v[104:107], v[80:83], v[24:27]
ds_read_b64_tr_b16 v[126:127], v135 offset:25088
s_add_u32 m0, s40, 57344
s_nop 0
buffer_load_dwordx4 v130, s[16:19], s38 offen lds
s_add_u32 s38, s38, 131072
v_mfma_f32_16x16x32_bf16 v[40:43], v[104:107], v[84:87], v[40:43]
buffer_load_dwordx4 v[64:67], v128, s[12:15], s37 offen
buffer_load_dwordx4 v[68:71], v129, s[12:15], s37 offen
s_add_u32 s37, s37, 262144
v_mfma_f32_16x16x32_bf16 v[28:31], v[108:111], v[80:83], v[28:31]
v_mfma_f32_16x16x32_bf16 v[44:47], v[108:111], v[84:87], v[44:47]
s_waitcnt vmcnt(9) lgkmcnt(0)
s_barrier
v_mfma_f32_16x16x32_bf16 v[16:19], v[112:115], v[88:91], v[16:19]
ds_read_b64_tr_b16 v[96:97], v132 offset:32768
ds_read_b64_tr_b16 v[98:99], v132 offset:33280
v_mfma_f32_16x16x32_bf16 v[32:35], v[112:115], v[92:95], v[32:35]
ds_read_b64_tr_b16 v[100:101], v133 offset:32768
ds_read_b64_tr_b16 v[102:103], v133 offset:33280
v_mfma_f32_16x16x32_bf16 v[20:23], v[116:119], v[88:91], v[20:23]
ds_read_b64_tr_b16 v[104:105], v134 offset:32768
ds_read_b64_tr_b16 v[106:107], v134 offset:33280
v_mfma_f32_16x16x32_bf16 v[36:39], v[116:119], v[92:95], v[36:39]
ds_read_b64_tr_b16 v[108:109], v135 offset:32768
ds_read_b64_tr_b16 v[110:111], v135 offset:33280
buffer_load_dwordx4 v[72:75], v128, s[12:15], s37 offen
v_mfma_f32_16x16x32_bf16 v[24:27], v[120:123], v[88:91], v[24:27]
buffer_load_dwordx4 v[76:79], v129, s[12:15], s37 offen
s_add_u32 s37, s37, 262144
v_lshrrev_b32 v10, 3, v138
s_lshl_b32 s3, s32, 4
v_add_u32 v10, s3, v10
s_lshl_b32 s3, s35, 7
v_add_u32 v10, s3, v10
v_lshlrev_b32 v10, 11, v10
v_and_b32 v11, 7, v138
v_lshl_add_u32 v10, v11, 4, v10
s_lshl_b32 s3, s36, 7
v_add_u32 v10, s3, v10
s_lshl_b32 s3, s32, 11
s_add_u32 m0, s3, 65536
s_nop 0
buffer_load_dwordx4 v10, s[28:31], 0 offen lds
v_mfma_f32_16x16x32_bf16 v[40:43], v[120:123], v[92:95], v[40:43]
s_lshl_b32 s3, s32, 11
s_add_u32 m0, s3, 65536
v_add_u32 v10, 15360, v10
buffer_load_dwordx4 v10, s[28:31], 0 offen offset:1024 lds
v_and_b32 v11, 15, v138
v_lshlrev_b32 v11, 4, v11
v_lshrrev_b32 v12, 4, v138
v_lshlrev_b32 v12, 13, v12
v_add_u32 v11, v11, v12
s_lshl_b32 s3, s36, 8
s_add_u32 s3, s3, 8192
v_add_u32 v11, s3, v11
s_lshl_b32 s3, s32, 9
s_add_u32 m0, s3, 81920
s_mov_b32 exec_hi, 0
buffer_load_dwordx4 v11, s[24:27], 0 offen lds
s_mov_b32 exec_hi, -1
v_mfma_f32_16x16x32_bf16 v[28:31], v[124:127], v[88:91], v[28:31]
v_mfma_f32_16x16x32_bf16 v[44:47], v[124:127], v[92:95], v[44:47]
s_waitcnt vmcnt(11) lgkmcnt(0)
s_barrier
v_mfma_f32_16x16x32_bf16 v[16:19], v[96:99], v[48:51], v[16:19]
ds_read_b64_tr_b16 v[112:113], v132 offset:40960
v_mfma_f32_16x16x32_bf16 v[32:35], v[96:99], v[52:55], v[32:35]
ds_read_b64_tr_b16 v[114:115], v132 offset:41472
ds_read_b64_tr_b16 v[116:117], v133 offset:40960
v_mfma_f32_16x16x32_bf16 v[20:23], v[100:103], v[48:51], v[20:23]
ds_read_b64_tr_b16 v[118:119], v133 offset:41472
v_mfma_f32_16x16x32_bf16 v[36:39], v[100:103], v[52:55], v[36:39]
ds_read_b64_tr_b16 v[120:121], v134 offset:40960
v_mfma_f32_16x16x32_bf16 v[24:27], v[104:107], v[48:51], v[24:27]
ds_read_b64_tr_b16 v[122:123], v134 offset:41472
ds_read_b64_tr_b16 v[124:125], v135 offset:40960
v_mfma_f32_16x16x32_bf16 v[40:43], v[104:107], v[52:55], v[40:43]
ds_read_b64_tr_b16 v[126:127], v135 offset:41472
v_mfma_f32_16x16x32_bf16 v[28:31], v[108:111], v[48:51], v[28:31]
v_mfma_f32_16x16x32_bf16 v[44:47], v[108:111], v[52:55], v[44:47]
s_waitcnt vmcnt(8) lgkmcnt(0)
s_barrier
v_mfma_f32_16x16x32_bf16 v[16:19], v[112:115], v[56:59], v[16:19]
ds_read_b64_tr_b16 v[96:97], v132 offset:49152
v_mfma_f32_16x16x32_bf16 v[32:35], v[112:115], v[60:63], v[32:35]
ds_read_b64_tr_b16 v[98:99], v132 offset:49664
ds_read_b64_tr_b16 v[100:101], v133 offset:49152
v_mfma_f32_16x16x32_bf16 v[20:23], v[116:119], v[56:59], v[20:23]
ds_read_b64_tr_b16 v[102:103], v133 offset:49664
v_mfma_f32_16x16x32_bf16 v[36:39], v[116:119], v[60:63], v[36:39]
ds_read_b64_tr_b16 v[104:105], v134 offset:49152
v_mfma_f32_16x16x32_bf16 v[24:27], v[120:123], v[56:59], v[24:27]
ds_read_b64_tr_b16 v[106:107], v134 offset:49664
ds_read_b64_tr_b16 v[108:109], v135 offset:49152
v_mfma_f32_16x16x32_bf16 v[40:43], v[120:123], v[60:63], v[40:43]
ds_read_b64_tr_b16 v[110:111], v135 offset:49664
v_mfma_f32_16x16x32_bf16 v[28:31], v[124:127], v[56:59], v[28:31]
v_mfma_f32_16x16x32_bf16 v[44:47], v[124:127], v[60:63], v[44:47]
s_waitcnt vmcnt(5) lgkmcnt(0)
s_barrier
v_mfma_f32_16x16x32_bf16 v[16:19], v[96:99], v[64:67], v[16:19]
ds_read_b64_tr_b16 v[112:113], v132 offset:57344
v_mfma_f32_16x16x32_bf16 v[32:35], v[96:99], v[68:71], v[32:35]
ds_read_b64_tr_b16 v[114:115], v132 offset:57856
ds_read_b64_tr_b16 v[116:117], v133 offset:57344
v_mfma_f32_16x16x32_bf16 v[20:23], v[100:103], v[64:67], v[20:23]
ds_read_b64_tr_b16 v[118:119], v133 offset:57856
v_mfma_f32_16x16x32_bf16 v[36:39], v[100:103], v[68:71], v[36:39]
ds_read_b64_tr_b16 v[120:121], v134 offset:57344
v_mfma_f32_16x16x32_bf16 v[24:27], v[104:107], v[64:67], v[24:27]
ds_read_b64_tr_b16 v[122:123], v134 offset:57856
ds_read_b64_tr_b16 v[124:125], v135 offset:57344
v_mfma_f32_16x16x32_bf16 v[40:43], v[104:107], v[68:71], v[40:43]
ds_read_b64_tr_b16 v[126:127], v135 offset:57856
v_mfma_f32_16x16x32_bf16 v[28:31], v[108:111], v[64:67], v[28:31]
v_mfma_f32_16x16x32_bf16 v[44:47], v[108:111], v[68:71], v[44:47]
s_waitcnt vmcnt(3) lgkmcnt(0)
s_barrier
v_mfma_f32_16x16x32_bf16 v[16:19], v[112:115], v[72:75], v[16:19]
v_mfma_f32_16x16x32_bf16 v[32:35], v[112:115], v[76:79], v[32:35]
v_mfma_f32_16x16x32_bf16 v[20:23], v[116:119], v[72:75], v[20:23]
v_mfma_f32_16x16x32_bf16 v[36:39], v[116:119], v[76:79], v[36:39]
v_mfma_f32_16x16x32_bf16 v[24:27], v[120:123], v[72:75], v[24:27]
v_mfma_f32_16x16x32_bf16 v[40:43], v[120:123], v[76:79], v[40:43]
v_mfma_f32_16x16x32_bf16 v[28:31], v[124:127], v[72:75], v[28:31]
v_mfma_f32_16x16x32_bf16 v[44:47], v[124:127], v[76:79], v[44:47]
v_lshlrev_b32 v5, 4, v138
s_lshl_b32 s3, s34, 1
s_add_u32 s10, s3, s33
s_lshl_b32 s10, s10, 12
s_xor_b32 s11, s10, 4096
v_add_u32 v6, s11, v5
v_add_u32 v7, s10, v5
v_and_b32 v2, 15, v138
v_lshrrev_b32 v3, 4, v138
s_nop 1
s_cmp_eq_u32 s33, 0
s_cbranch_scc0 k4_kernel_e1
ds_write_b128 v6, v[32:35] offset:0
ds_write_b128 v6, v[36:39] offset:1024
ds_write_b128 v6, v[40:43] offset:2048
ds_write_b128 v6, v[44:47] offset:3072
s_branch k4_kernel_e2
k4_kernel_e1:
ds_write_b128 v6, v[16:19] offset:0
ds_write_b128 v6, v[20:23] offset:1024
ds_write_b128 v6, v[24:27] offset:2048
ds_write_b128 v6, v[28:31] offset:3072
k4_kernel_e2:
s_waitcnt vmcnt(0) lgkmcnt(0)
s_barrier
v_lshlrev_b32 v9, 4, v3
s_lshl_b32 s3, s32, 9
s_add_u32 s3, s3, 81920
v_add_u32 v9, s3, v9
ds_read_b128 v[96:99], v7 offset:0
ds_read_b128 v[100:103], v7 offset:1024
ds_read_b128 v[104:107], v7 offset:2048
ds_read_b128 v[108:111], v7 offset:3072
ds_read_b128 v[64:67], v9 offset:0
ds_read_b128 v[68:71], v9 offset:64
ds_read_b128 v[72:75], v9 offset:128
ds_read_b128 v[76:79], v9 offset:192
ds_read_b128 v[48:51], v9 offset:256
ds_read_b128 v[52:55], v9 offset:320
ds_read_b128 v[56:59], v9 offset:384
ds_read_b128 v[60:63], v9 offset:448
s_and_b32 s3, s55, 127
v_add_u32 v10, s3, v2
v_lshlrev_b32 v10, 7, v10
v_lshl_add_u32 v10, v3, 3, v10
v_add_u32 v10, 65536, v10
ds_read_b64 v[80:81], v10 offset:0
ds_read_b64 v[82:83], v10 offset:32
ds_read_b64 v[84:85], v10 offset:64
ds_read_b64 v[86:87], v10 offset:96
s_waitcnt lgkmcnt(0)
s_cmp_eq_u32 s33, 0
s_cbranch_scc0 k4_kernel_e3
v_add_f32 v96, v96, v16
v_add_f32 v97, v97, v17
v_add_f32 v98, v98, v18
v_add_f32 v99, v99, v19
v_add_f32 v100, v100, v20
v_add_f32 v101, v101, v21
v_add_f32 v102, v102, v22
v_add_f32 v103, v103, v23
v_add_f32 v104, v104, v24
v_add_f32 v105, v105, v25
v_add_f32 v106, v106, v26
v_add_f32 v107, v107, v27
v_add_f32 v108, v108, v28
v_add_f32 v109, v109, v29
v_add_f32 v110, v110, v30
v_add_f32 v111, v111, v31
s_branch k4_kernel_e4
k4_kernel_e3:
v_add_f32 v96, v96, v32
v_add_f32 v97, v97, v33
v_add_f32 v98, v98, v34
v_add_f32 v99, v99, v35
v_add_f32 v100, v100, v36
v_add_f32 v101, v101, v37
v_add_f32 v102, v102, v38
v_add_f32 v103, v103, v39
v_add_f32 v104, v104, v40
v_add_f32 v105, v105, v41
v_add_f32 v106, v106, v42
v_add_f32 v107, v107, v43
v_add_f32 v108, v108, v44
v_add_f32 v109, v109, v45
v_add_f32 v110, v110, v46
v_add_f32 v111, v111, v47
k4_kernel_e4:
v_mov_b32 v20, 0
v_mov_b32 v21, 0
v_lshlrev_b32 v4, 16, v80
v_and_b32 v5, 0xffff0000, v80
v_fma_f32 v96, v64, v96, v4
v_fma_f32 v97, v65, v97, v5
v_add_f32 v20, v20, v96
v_fmac_f32 v21, v96, v96
v_add_f32 v20, v20, v97
v_fmac_f32 v21, v97, v97
v_lshlrev_b32 v4, 16, v81
v_and_b32 v5, 0xffff0000, v81
v_fma_f32 v98, v66, v98, v4
v_fma_f32 v99, v67, v99, v5
v_add_f32 v20, v20, v98
v_fmac_f32 v21, v98, v98
v_add_f32 v20, v20, v99
v_fmac_f32 v21, v99, v99
v_lshlrev_b32 v4, 16, v82
v_and_b32 v5, 0xffff0000, v82
v_fma_f32 v100, v68, v100, v4
v_fma_f32 v101, v69, v101, v5
v_add_f32 v20, v20, v100
v_fmac_f32 v21, v100, v100
v_add_f32 v20, v20, v101
v_fmac_f32 v21, v101, v101
v_lshlrev_b32 v4, 16, v83
v_and_b32 v5, 0xffff0000, v83
v_fma_f32 v102, v70, v102, v4
v_fma_f32 v103, v71, v103, v5
v_add_f32 v20, v20, v102
v_fmac_f32 v21, v102, v102
v_add_f32 v20, v20, v103
v_fmac_f32 v21, v103, v103
v_lshlrev_b32 v4, 16, v84
v_and_b32 v5, 0xffff0000, v84
v_fma_f32 v104, v72, v104, v4
v_fma_f32 v105, v73, v105, v5
v_add_f32 v20, v20, v104
v_fmac_f32 v21, v104, v104
v_add_f32 v20, v20, v105
v_fmac_f32 v21, v105, v105
v_lshlrev_b32 v4, 16, v85
v_and_b32 v5, 0xffff0000, v85
v_fma_f32 v106, v74, v106, v4
v_fma_f32 v107, v75, v107, v5
v_add_f32 v20, v20, v106
v_fmac_f32 v21, v106, v106
v_add_f32 v20, v20, v107
v_fmac_f32 v21, v107, v107
v_lshlrev_b32 v4, 16, v86
v_and_b32 v5, 0xffff0000, v86
v_fma_f32 v108, v76, v108, v4
v_fma_f32 v109, v77, v109, v5
v_add_f32 v20, v20, v108
v_fmac_f32 v21, v108, v108
v_add_f32 v20, v20, v109
v_fmac_f32 v21, v109, v109
v_lshlrev_b32 v4, 16, v87
v_and_b32 v5, 0xffff0000, v87
v_fma_f32 v110, v78, v110, v4
v_fma_f32 v111, v79, v111, v5
v_add_f32 v20, v20, v110
v_fmac_f32 v21, v110, v110
v_add_f32 v20, v20, v111
v_fmac_f32 v21, v111, v111
v_lshlrev_b32 v5, 4, v138
s_lshr_b32 s3, s55, 4
s_lshl_b32 s3, s3, 4
s_add_u32 s3, s3, s36
s_lshl_b32 s3, s3, 11
s_add_u32 s3, s3, 16777216
v_cvt_pk_bf16_f32 v24, v96, v97
v_cvt_pk_bf16_f32 v25, v98, v99
v_cvt_pk_bf16_f32 v26, v100, v101
v_cvt_pk_bf16_f32 v27, v102, v103
buffer_store_dwordx4 v[24:27], v5, s[24:27], s3 offen offset:0 sc1
v_cvt_pk_bf16_f32 v28, v104, v105
v_cvt_pk_bf16_f32 v29, v106, v107
v_cvt_pk_bf16_f32 v30, v108, v109
v_cvt_pk_bf16_f32 v31, v110, v111
buffer_store_dwordx4 v[28:31], v5, s[24:27], s3 offen offset:1024 sc1
v_mul_f32 v96, v96, v48
v_mul_f32 v97, v97, v49
v_mul_f32 v98, v98, v50
v_mul_f32 v99, v99, v51
v_mul_f32 v100, v100, v52
v_mul_f32 v101, v101, v53
v_mul_f32 v102, v102, v54
v_mul_f32 v103, v103, v55
v_mul_f32 v104, v104, v56
v_mul_f32 v105, v105, v57
v_mul_f32 v106, v106, v58
v_mul_f32 v107, v107, v59
v_mul_f32 v108, v108, v60
v_mul_f32 v109, v109, v61
v_mul_f32 v110, v110, v62
v_mul_f32 v111, v111, v63
s_lshl_b32 s3, s55, 6
v_add_u32 v5, s3, v5
s_lshl_b32 s3, s36, 18
s_add_u32 s3, s3, 20971520
s_add_u32 s10, s3, 131072
v_cvt_pk_bf16_f32 v32, v96, v97
v_cvt_pk_bf16_f32 v33, v98, v99
v_cvt_pk_bf16_f32 v34, v100, v101
v_cvt_pk_bf16_f32 v35, v102, v103
buffer_store_dwordx4 v[32:35], v5, s[24:27], s3 offen sc1
v_cvt_pk_bf16_f32 v36, v104, v105
v_cvt_pk_bf16_f32 v37, v106, v107
v_cvt_pk_bf16_f32 v38, v108, v109
v_cvt_pk_bf16_f32 v39, v110, v111
buffer_store_dwordx4 v[36:39], v5, s[24:27], s10 offen sc1
v_mov_b32 v22, v20
v_mov_b32 v23, v21
s_nop 1
v_permlane16_swap_b32 v20, v22
v_permlane16_swap_b32 v21, v23
s_nop 1
v_add_f32 v20, v20, v22
v_add_f32 v21, v21, v23
v_mov_b32 v22, v20
v_mov_b32 v23, v21
s_nop 1
v_permlane32_swap_b32 v20, v22
v_permlane32_swap_b32 v21, v23
s_nop 1
v_add_f32 v20, v20, v22
v_add_f32 v21, v21, v23
v_cmp_eq_u32 vcc, 0, v3
v_add_u32 v4, s55, v2
v_lshlrev_b32 v4, 3, v4
v_cndmask_b32 v20, v21, v20, vcc
v_lshl_add_u32 v4, v3, 2, v4
v_cmp_gt_u32 vcc, 2, v3
s_mov_b32 s3, 262144
s_and_saveexec_b64 s[10:11], vcc
buffer_atomic_add_f32 v20, v4, s[24:27], s3 offen
s_mov_b64 exec, s[10:11]
k4_kernel_fin:
k4_kernel_end:
s_endpgm
.section .rodata,"a"
.p2align 6
.amdhsa_kernel k4_kernel
  .amdhsa_next_free_vgpr 160
  .amdhsa_next_free_sgpr 102
  .amdhsa_accum_offset 160
  .amdhsa_group_segment_fixed_size 0
  .amdhsa_kernarg_size 112
  .amdhsa_user_sgpr_count 2
  .amdhsa_user_sgpr_kernarg_segment_ptr 1
  .amdhsa_system_sgpr_workgroup_id_x 1
.end_amdhsa_kernel
.text
.globl k5_kernel
.p2align 8
.type k5_kernel,@function
k5_kernel:
s_cmp_ge_u32 s2, 256
s_cbranch_scc1 k5_kernel_end
s_load_dwordx4 s[4:7], s[0:1], 48
s_load_dwordx2 s[8:9], s[0:1], 104
v_lshrrev_b32 v1, 6, v0
v_and_b32 v236, 63, v0
v_readfirstlane_b32 s28, v1
s_and_b32 s3, s2, 7
s_lshl_b32 s32, s3, 2
s_lshr_b32 s3, s2, 3
s_and_b32 s3, s3, 3
s_add_u32 s32, s32, s3
s_lshr_b32 s31, s2, 5
s_and_b32 s29, s28, 3
s_lshr_b32 s30, s28, 2
v_lshlrev_b32 v222, 4, v236
s_lshl_b32 s3, s28, 11
v_add_u32 v222, s3, v222
s_lshl_b32 s3, s28, 6
v_add_u32 v5, s3, v236
s_movk_i32 s3, 4682
v_mul_lo_u32 v6, v5, s3
v_lshrrev_b32 v6, 16, v6
v_mul_u32_u24 v7, 14, v6
v_sub_u32 v7, v5, v7
s_movk_i32 s3, 7168
v_mul_lo_u32 v6, v6, s3
v_lshl_add_u32 v223, v7, 4, v6
s_cmp_eq_u32 s28, 7
s_cbranch_scc0 k5_kernel_notw7
v_mov_b32 v223, 0x40000000
k5_kernel_notw7:
s_lshl_b32 s33, s28, 11
s_lshl_b32 s34, s28, 10
s_add_u32 s36, s33, 0
s_add_u32 s40, s34, 16384
s_add_u32 s44, s34, 23552
s_cmp_eq_u32 s28, 7
s_cselect_b32 s40, 122880, s40
s_cselect_b32 s44, 123904, s44
s_add_u32 s37, s33, 30720
s_add_u32 s41, s34, 47104
s_add_u32 s45, s34, 54272
s_cmp_eq_u32 s28, 7
s_cselect_b32 s41, 122880, s41
s_cselect_b32 s45, 123904, s45
s_add_u32 s38, s33, 61440
s_add_u32 s42, s34, 77824
s_add_u32 s46, s34, 84992
s_cmp_eq_u32 s28, 7
s_cselect_b32 s42, 122880, s42
s_cselect_b32 s46, 123904, s46
s_add_u32 s39, s33, 92160
s_add_u32 s43, s34, 108544
s_add_u32 s47, s34, 115712
s_cmp_eq_u32 s28, 7
s_cselect_b32 s43, 122880, s43
s_cselect_b32 s47, 123904, s47
s_lshl_b32 s33, s31, 14
s_mov_b32 s34, 0
v_lshrrev_b32 v2, 3, v236
v_lshrrev_b32 v3, 1, v2
s_lshl_b32 s3, s30, 2
v_add_u32 v3, s3, v3
v_and_b32 v4, 1, v2
v_cmp_eq_u32 vcc, 6, v2
v_mov_b32 v8, 3
v_mov_b32 v9, s30
v_cndmask_b32 v3, v3, v8, vcc
v_cndmask_b32 v4, v4, v9, vcc
v_bfe_u32 v8, v236, 2, 1
v_lshl_add_u32 v4, v4, 1, v8
s_movk_i32 s3, 14336
v_mul_lo_u32 v4, v4, s3
v_lshl_add_u32 v4, v3, 6, v4
v_and_b32 v8, 3, v236
v_lshl_add_u32 v4, v8, 4, v4
v_cmp_gt_u32 vcc, 56, v236
v_mov_b32 v8, 0x7f000000
s_mul_i32 s49, s32, 448
v_cndmask_b32 v4, v8, v4, vcc
s_add_u32 s49, s49, 131072
s_mul_i32 s3, s32, 224
s_waitcnt lgkmcnt(0)
s_add_u32 s12, s8, 20971520
s_addc_u32 s13, s9, 0
s_and_b32 s13, s13, 0xffff
s_mov_b32 s14, 4194304
s_mov_b32 s15, 0x00020000
s_add_u32 s16, s4, s3
s_addc_u32 s17, s5, 0
s_and_b32 s17, s17, 0xffff
s_sub_u32 s18, 7340032, s3
s_mov_b32 s19, 0x00020000
s_add_u32 s20, s6, s3
s_addc_u32 s21, s7, 0
s_and_b32 s21, s21, 0xffff
s_mov_b32 s22, s18
s_mov_b32 s23, 0x00020000
s_mov_b32 m0, s36
s_nop 0
buffer_load_dwordx4 v222, s[12:15], s33 offen lds
buffer_load_dwordx4 v222, s[12:15], s33 offen offset:1024 lds
s_add_u32 s33, s33, 131072
s_mov_b32 m0, s40
s_nop 0
buffer_load_dwordx4 v223, s[16:19], s34 offen lds
s_mov_b32 m0, s44
s_nop 0
buffer_load_dwordx4 v223, s[20:23], s34 offen lds
s_add_u32 s34, s34, 229376
s_mov_b32 s24, s8
s_and_b32 s25, s9, 0xffff
s_mov_b32 s26, 67108864
s_mov_b32 s27, 0x00020000
s_lshl_b32 s3, s28, 10
s_add_u32 m0, s3, 124928
s_nop 0
buffer_load_dwordx4 v4, s[24:27], s49 offen lds
v_and_b32 v2, 15, v236
v_lshrrev_b32 v3, 4, v236
v_lshlrev_b32 v4, 3, v2
s_lshl_b32 s3, s31, 11
s_lshl_b32 s49, s29, 9
s_add_u32 s3, s3, s49
s_add_u32 s3, s3, 262144
buffer_load_dwordx2 v[128:129], v4, s[24:27], s3 offen offset:0
buffer_load_dwordx2 v[130:131], v4, s[24:27], s3 offen offset:128
buffer_load_dwordx2 v[132:133], v4, s[24:27], s3 offen offset:256
buffer_load_dwordx2 v[134:135], v4, s[24:27], s3 offen offset:384
s_mov_b32 m0, s37
s_nop 0
buffer_load_dwordx4 v222, s[12:15], s33 offen lds
buffer_load_dwordx4 v222, s[12:15], s33 offen offset:1024 lds
s_add_u32 s33, s33, 131072
s_mov_b32 m0, s41
s_nop 0
buffer_load_dwordx4 v223, s[16:19], s34 offen lds
s_mov_b32 m0, s45
s_nop 0
buffer_load_dwordx4 v223, s[20:23], s34 offen lds
s_add_u32 s34, s34, 229376
v_lshlrev_b32 v8, 4, v3
s_lshl_b32 s3, s28, 10
s_add_u32 s3, s3, 124928
v_add_u32 v237, s3, v8
v_lshlrev_b32 v216, 4, v236
s_lshl_b32 s3, s29, 12
v_add_u32 v216, s3, v216
v_add_u32 v217, 61440, v216
v_lshrrev_b32 v5, 2, v236
v_mul_u32_u24 v5, 224, v5
v_and_b32 v6, 3, v236
v_lshl_add_u32 v5, v6, 3, v5
v_add_u32 v5, 16384, v5
s_lshl_b32 s3, s30, 7
v_add_u32 v218, s3, v5
v_add_u32 v219, 61440, v218
s_mul_i32 s3, s30, 7168
s_add_u32 s3, s3, 96
v_add_u32 v220, s3, v5
v_add_u32 v221, 61440, v220
s_waitcnt vmcnt(4)
s_barrier
s_mov_b32 s3, 0x3a800000
s_mov_b32 s35, 0x3727c5ac
v_mul_f32 v128, s3, v128
v_mul_f32 v129, s3, v129
v_fma_f32 v129, -v128, v128, v129
v_max_f32 v129, 0, v129
v_add_f32 v129, s35, v129
v_rcp_f32 v224, v129
v_sqrt_f32 v232, v129
v_sub_f32 v228, 0, v128
v_mul_f32 v130, s3, v130
v_mul_f32 v131, s3, v131
v_fma_f32 v131, -v130, v130, v131
v_max_f32 v131, 0, v131
v_add_f32 v131, s35, v131
v_rcp_f32 v225, v131
v_sqrt_f32 v233, v131
v_sub_f32 v229, 0, v130
v_mul_f32 v132, s3, v132
v_mul_f32 v133, s3, v133
v_fma_f32 v133, -v132, v132, v133
v_max_f32 v133, 0, v133
v_add_f32 v133, s35, v133
v_rcp_f32 v226, v133
v_sqrt_f32 v234, v133
v_sub_f32 v230, 0, v132
v_mul_f32 v134, s3, v134
v_mul_f32 v135, s3, v135
v_fma_f32 v135, -v134, v134, v135
v_max_f32 v135, 0, v135
v_add_f32 v135, s35, v135
v_rcp_f32 v227, v135
v_sqrt_f32 v235, v135
v_sub_f32 v231, 0, v134
ds_read_b128 v[128:131], v216 offset:0
ds_read_b128 v[132:135], v216 offset:1024
ds_read_b128 v[136:139], v216 offset:2048
ds_read_b128 v[140:143], v216 offset:3072
ds_read_b64_tr_b16 v[144:145], v218 offset:0
ds_read_b64_tr_b16 v[146:147], v218 offset:3584
ds_read_b64_tr_b16 v[148:149], v218 offset:7168
ds_read_b64_tr_b16 v[150:151], v218 offset:10752
ds_read_b64_tr_b16 v[152:153], v218 offset:32
ds_read_b64_tr_b16 v[154:155], v218 offset:3616
ds_read_b64_tr_b16 v[156:157], v218 offset:7200
ds_read_b64_tr_b16 v[158:159], v218 offset:10784
ds_read_b64_tr_b16 v[160:161], v218 offset:64
ds_read_b64_tr_b16 v[162:163], v218 offset:3648
ds_read_b64_tr_b16 v[164:165], v218 offset:7232
ds_read_b64_tr_b16 v[166:167], v218 offset:10816
ds_read_b64_tr_b16 v[168:169], v220 offset:0
ds_read_b64_tr_b16 v[170:171], v220 offset:3584
s_waitcnt vmcnt(0) lgkmcnt(0)
s_barrier
ds_read_b128 v[240:243], v237 offset:0
ds_read_b128 v[244:247], v237 offset:64
ds_read_b128 v[248:251], v237 offset:128
ds_read_b128 v[252:255], v237 offset:192
v_mfma_f32_16x16x32_bf16 v[16:19], v[144:147], v[128:131], 0
ds_read_b128 v[172:175], v216 offset:30720
v_mfma_f32_16x16x32_bf16 v[20:23], v[144:147], v[132:135], 0
ds_read_b128 v[176:179], v216 offset:31744
s_mov_b32 m0, s38
s_nop 0
buffer_load_dwordx4 v222, s[12:15], s33 offen lds
v_mfma_f32_16x16x32_bf16 v[24:27], v[144:147], v[136:139], 0
ds_read_b128 v[180:183], v216 offset:32768
v_mfma_f32_16x16x32_bf16 v[28:31], v[144:147], v[140:143], 0
ds_read_b128 v[184:187], v216 offset:33792
v_mfma_f32_16x16x32_bf16 v[32:35], v[148:151], v[128:131], 0
ds_read_b64_tr_b16 v[188:189], v218 offset:30720
buffer_load_dwordx4 v222, s[12:15], s33 offen offset:1024 lds
s_add_u32 s33, s33, 131072
v_mfma_f32_16x16x32_bf16 v[36:39], v[148:151], v[132:135], 0
ds_read_b64_tr_b16 v[190:191], v218 offset:34304
v_mfma_f32_16x16x32_bf16 v[40:43], v[148:151], v[136:139], 0
ds_read_b64_tr_b16 v[192:193], v218 offset:37888
v_mfma_f32_16x16x32_bf16 v[44:47], v[148:151], v[140:143], 0
ds_read_b64_tr_b16 v[194:195], v218 offset:41472
s_mov_b32 m0, s42
s_nop 0
buffer_load_dwordx4 v223, s[16:19], s34 offen lds
v_mfma_f32_16x16x32_bf16 v[48:51], v[152:155], v[128:131], 0
ds_read_b64_tr_b16 v[196:197], v218 offset:30752
v_mfma_f32_16x16x32_bf16 v[52:55], v[152:155], v[132:135], 0
s_waitcnt lgkmcnt(9)
v_fmac_f32 v16, v232, v244
v_fmac_f32 v16, v228, v240
v_fmac_f32 v17, v232, v245
v_fmac_f32 v17, v228, v241
v_fmac_f32 v18, v232, v246
v_fmac_f32 v18, v228, v242
v_fmac_f32 v19, v232, v247
v_fmac_f32 v19, v228, v243
v_mfma_f32_16x16x32_bf16 v[56:59], v[152:155], v[136:139], 0
ds_read_b64_tr_b16 v[198:199], v218 offset:34336
s_mov_b32 m0, s46
s_nop 0
buffer_load_dwordx4 v223, s[20:23], s34 offen lds
s_add_u32 s34, s34, 229376
v_fmac_f32 v20, v233, v244
v_fmac_f32 v20, v229, v240
v_fmac_f32 v21, v233, v245
v_fmac_f32 v21, v229, v241
v_fmac_f32 v22, v233, v246
v_fmac_f32 v22, v229, v242
v_fmac_f32 v23, v233, v247
v_fmac_f32 v23, v229, v243
v_mfma_f32_16x16x32_bf16 v[60:63], v[152:155], v[140:143], 0
ds_read_b64_tr_b16 v[200:201], v218 offset:37920
v_fmac_f32 v24, v234, v244
v_fmac_f32 v24, v230, v240
v_fmac_f32 v25, v234, v245
v_fmac_f32 v25, v230, v241
v_fmac_f32 v26, v234, v246
v_fmac_f32 v26, v230, v242
v_fmac_f32 v27, v234, v247
v_fmac_f32 v27, v230, v243
v_mfma_f32_16x16x32_bf16 v[64:67], v[156:159], v[128:131], 0
ds_read_b64_tr_b16 v[202:203], v218 offset:41504
v_fmac_f32 v28, v235, v244
v_fmac_f32 v28, v231, v240
v_fmac_f32 v29, v235, v245
v_fmac_f32 v29, v231, v241
v_fmac_f32 v30, v235, v246
v_fmac_f32 v30, v231, v242
v_fmac_f32 v31, v235, v247
v_fmac_f32 v31, v231, v243
v_mfma_f32_16x16x32_bf16 v[68:71], v[156:159], v[132:135], 0
ds_read_b64_tr_b16 v[204:205], v218 offset:30784
s_mov_b32 m0, s39
s_nop 0
buffer_load_dwordx4 v222, s[12:15], s33 offen lds
v_fmac_f32 v32, v232, v252
v_fmac_f32 v32, v228, v248
v_fmac_f32 v33, v232, v253
v_fmac_f32 v33, v228, v249
v_fmac_f32 v34, v232, v254
v_fmac_f32 v34, v228, v250
v_fmac_f32 v35, v232, v255
v_fmac_f32 v35, v228, v251
v_mfma_f32_16x16x32_bf16 v[72:75], v[156:159], v[136:139], 0
ds_read_b64_tr_b16 v[206:207], v218 offset:34368
v_fmac_f32 v36, v233, v252
v_fmac_f32 v36, v229, v248
v_fmac_f32 v37, v233, v253
v_fmac_f32 v37, v229, v249
v_fmac_f32 v38, v233, v254
v_fmac_f32 v38, v229, v250
v_fmac_f32 v39, v233, v255
v_fmac_f32 v39, v229, v251
v_mfma_f32_16x16x32_bf16 v[76:79], v[156:159], v[140:143], 0
ds_read_b64_tr_b16 v[208:209], v218 offset:37952
v_fmac_f32 v40, v234, v252
v_fmac_f32 v40, v230, v248
v_fmac_f32 v41, v234, v253
v_fmac_f32 v41, v230, v249
v_fmac_f32 v42, v234, v254
v_fmac_f32 v42, v230, v250
v_fmac_f32 v43, v234, v255
v_fmac_f32 v43, v230, v251
v_mfma_f32_16x16x32_bf16 v[80:83], v[160:163], v[128:131], 0
ds_read_b64_tr_b16 v[210:211], v218 offset:41536
buffer_load_dwordx4 v222, s[12:15], s33 offen offset:1024 lds
s_add_u32 s33, s33, 131072
v_fmac_f32 v44, v235, v252
v_fmac_f32 v44, v231, v248
v_fmac_f32 v45, v235, v253
v_fmac_f32 v45, v231, v249
v_fmac_f32 v46, v235, v254
v_fmac_f32 v46, v231, v250
v_fmac_f32 v47, v235, v255
v_fmac_f32 v47, v231, v251
v_mfma_f32_16x16x32_bf16 v[84:87], v[160:163], v[132:135], 0
ds_read_b64_tr_b16 v[212:213], v220 offset:30720
v_mfma_f32_16x16x32_bf16 v[88:91], v[160:163], v[136:139], 0
ds_read_b64_tr_b16 v[214:215], v220 offset:34304
v_mfma_f32_16x16x32_bf16 v[92:95], v[160:163], v[140:143], 0
s_mov_b32 m0, s43
s_nop 0
buffer_load_dwordx4 v223, s[16:19], s34 offen lds
v_mfma_f32_16x16x32_bf16 v[96:99], v[164:167], v[128:131], 0
v_mfma_f32_16x16x32_bf16 v[100:103], v[164:167], v[132:135], 0
v_mfma_f32_16x16x32_bf16 v[104:107], v[164:167], v[136:139], 0
s_mov_b32 m0, s47
s_nop 0
buffer_load_dwordx4 v223, s[20:23], s34 offen lds
s_add_u32 s34, s34, 229376
v_mfma_f32_16x16x32_bf16 v[108:111], v[164:167], v[140:143], 0
v_mfma_f32_16x16x32_bf16 v[112:115], v[168:171], v[128:131], 0
v_mfma_f32_16x16x32_bf16 v[116:119], v[168:171], v[132:135], 0
v_mfma_f32_16x16x32_bf16 v[120:123], v[168:171], v[136:139], 0
v_mfma_f32_16x16x32_bf16 v[124:127], v[168:171], v[140:143], 0
s_waitcnt vmcnt(4) lgkmcnt(0)
s_barrier
ds_read_b128 v[240:243], v237 offset:256
ds_read_b128 v[244:247], v237 offset:320
ds_read_b128 v[248:251], v237 offset:384
ds_read_b128 v[252:255], v237 offset:448
v_mfma_f32_16x16x32_bf16 v[16:19], v[188:191], v[172:175], v[16:19]
ds_read_b128 v[128:131], v217 offset:0
v_mfma_f32_16x16x32_bf16 v[20:23], v[188:191], v[176:179], v[20:23]
ds_read_b128 v[132:135], v217 offset:1024
s_mov_b32 m0, s36
s_nop 0
buffer_load_dwordx4 v222, s[12:15], s33 offen lds
v_mfma_f32_16x16x32_bf16 v[24:27], v[188:191], v[180:183], v[24:27]
ds_read_b128 v[136:139], v217 offset:2048
v_mfma_f32_16x16x32_bf16 v[28:31], v[188:191], v[184:187], v[28:31]
ds_read_b128 v[140:143], v217 offset:3072
v_mfma_f32_16x16x32_bf16 v[32:35], v[192:195], v[172:175], v[32:35]
ds_read_b64_tr_b16 v[144:145], v219 offset:0
buffer_load_dwordx4 v222, s[12:15], s33 offen offset:1024 lds
s_add_u32 s33, s33, 131072
v_mfma_f32_16x16x32_bf16 v[36:39], v[192:195], v[176:179], v[36:39]
ds_read_b64_tr_b16 v[146:147], v219 offset:3584
v_mfma_f32_16x16x32_bf16 v[40:43], v[192:195], v[180:183], v[40:43]
ds_read_b64_tr_b16 v[148:149], v219 offset:7168
v_mfma_f32_16x16x32_bf16 v[44:47], v[192:195], v[184:187], v[44:47]
ds_read_b64_tr_b16 v[150:151], v219 offset:10752
s_mov_b32 m0, s40
s_nop 0
buffer_load_dwordx4 v223, s[16:19], s34 offen lds
v_mfma_f32_16x16x32_bf16 v[48:51], v[196:199], v[172:175], v[48:51]
ds_read_b64_tr_b16 v[152:153], v219 offset:32
v_mfma_f32_16x16x32_bf16 v[52:55], v[196:199], v[176:179], v[52:55]
v_mfma_f32_16x16x32_bf16 v[56:59], v[196:199], v[180:183], v[56:59]
ds_read_b64_tr_b16 v[154:155], v219 offset:3616
s_mov_b32 m0, s44
s_nop 0
buffer_load_dwordx4 v223, s[20:23], s34 offen lds
s_add_u32 s34, s34, 229376
v_mfma_f32_16x16x32_bf16 v[60:63], v[196:199], v[184:187], v[60:63]
ds_read_b64_tr_b16 v[156:157], v219 offset:7200
v_mfma_f32_16x16x32_bf16 v[64:67], v[200:203], v[172:175], v[64:67]
ds_read_b64_tr_b16 v[158:159], v219 offset:10784
v_mfma_f32_16x16x32_bf16 v[68:71], v[200:203], v[176:179], v[68:71]
ds_read_b64_tr_b16 v[160:161], v219 offset:64
s_mov_b32 m0, s37
s_nop 0
buffer_load_dwordx4 v222, s[12:15], s33 offen lds
v_mfma_f32_16x16x32_bf16 v[72:75], v[200:203], v[180:183], v[72:75]
ds_read_b64_tr_b16 v[162:163], v219 offset:3648
v_mfma_f32_16x16x32_bf16 v[76:79], v[200:203], v[184:187], v[76:79]
ds_read_b64_tr_b16 v[164:165], v219 offset:7232
v_mfma_f32_16x16x32_bf16 v[80:83], v[204:207], v[172:175], v[80:83]
ds_read_b64_tr_b16 v[166:167], v219 offset:10816
buffer_load_dwordx4 v222, s[12:15], s33 offen offset:1024 lds
s_add_u32 s33, s33, 131072
v_mfma_f32_16x16x32_bf16 v[84:87], v[204:207], v[176:179], v[84:87]
ds_read_b64_tr_b16 v[168:169], v221 offset:0
s_waitcnt lgkmcnt(15)
v_fmac_f32 v48, v232, v244
v_fmac_f32 v48, v228, v240
v_fmac_f32 v49, v232, v245
v_fmac_f32 v49, v228, v241
v_fmac_f32 v50, v232, v246
v_fmac_f32 v50, v228, v242
v_fmac_f32 v51, v232, v247
v_fmac_f32 v51, v228, v243
v_mfma_f32_16x16x32_bf16 v[88:91], v[204:207], v[180:183], v[88:91]
ds_read_b64_tr_b16 v[170:171], v221 offset:3584
v_fmac_f32 v52, v233, v244
v_fmac_f32 v52, v229, v240
v_fmac_f32 v53, v233, v245
v_fmac_f32 v53, v229, v241
v_fmac_f32 v54, v233, v246
v_fmac_f32 v54, v229, v242
v_fmac_f32 v55, v233, v247
v_fmac_f32 v55, v229, v243
v_mfma_f32_16x16x32_bf16 v[92:95], v[204:207], v[184:187], v[92:95]
s_mov_b32 m0, s41
s_nop 0
buffer_load_dwordx4 v223, s[16:19], s34 offen lds
v_fmac_f32 v56, v234, v244
v_fmac_f32 v56, v230, v240
v_fmac_f32 v57, v234, v245
v_fmac_f32 v57, v230, v241
v_fmac_f32 v58, v234, v246
v_fmac_f32 v58, v230, v242
v_fmac_f32 v59, v234, v247
v_fmac_f32 v59, v230, v243
v_mfma_f32_16x16x32_bf16 v[96:99], v[208:211], v[172:175], v[96:99]
v_fmac_f32 v60, v235, v244
v_fmac_f32 v60, v231, v240
v_fmac_f32 v61, v235, v245
v_fmac_f32 v61, v231, v241
v_fmac_f32 v62, v235, v246
v_fmac_f32 v62, v231, v242
v_fmac_f32 v63, v235, v247
v_fmac_f32 v63, v231, v243
v_mfma_f32_16x16x32_bf16 v[100:103], v[208:211], v[176:179], v[100:103]
v_fmac_f32 v64, v232, v252
v_fmac_f32 v64, v228, v248
v_fmac_f32 v65, v232, v253
v_fmac_f32 v65, v228, v249
v_fmac_f32 v66, v232, v254
v_fmac_f32 v66, v228, v250
v_fmac_f32 v67, v232, v255
v_fmac_f32 v67, v228, v251
v_mfma_f32_16x16x32_bf16 v[104:107], v[208:211], v[180:183], v[104:107]
s_mov_b32 m0, s45
s_nop 0
buffer_load_dwordx4 v223, s[20:23], s34 offen lds
s_add_u32 s34, s34, 229376
v_fmac_f32 v68, v233, v252
v_fmac_f32 v68, v229, v248
v_fmac_f32 v69, v233, v253
v_fmac_f32 v69, v229, v249
v_fmac_f32 v70, v233, v254
v_fmac_f32 v70, v229, v250
v_fmac_f32 v71, v233, v255
v_fmac_f32 v71, v229, v251
v_mfma_f32_16x16x32_bf16 v[108:111], v[208:211], v[184:187], v[108:111]
v_fmac_f32 v72, v234, v252
v_fmac_f32 v72, v230, v248
v_fmac_f32 v73, v234, v253
v_fmac_f32 v73, v230, v249
v_fmac_f32 v74, v234, v254
v_fmac_f32 v74, v230, v250
v_fmac_f32 v75, v234, v255
v_fmac_f32 v75, v230, v251
v_mfma_f32_16x16x32_bf16 v[112:115], v[212:215], v[172:175], v[112:115]
v_fmac_f32 v76, v235, v252
v_fmac_f32 v76, v231, v248
v_fmac_f32 v77, v235, v253
v_fmac_f32 v77, v231, v249
v_fmac_f32 v78, v235, v254
v_fmac_f32 v78, v231, v250
v_fmac_f32 v79, v235, v255
v_fmac_f32 v79, v231, v251
v_mfma_f32_16x16x32_bf16 v[116:119], v[212:215], v[176:179], v[116:119]
v_mfma_f32_16x16x32_bf16 v[120:123], v[212:215], v[180:183], v[120:123]
v_mfma_f32_16x16x32_bf16 v[124:127], v[212:215], v[184:187], v[124:127]
s_waitcnt vmcnt(8) lgkmcnt(0)
s_barrier
ds_read_b128 v[240:243], v237 offset:512
ds_read_b128 v[244:247], v237 offset:576
ds_read_b128 v[248:251], v237 offset:640
ds_read_b128 v[252:255], v237 offset:704
v_mfma_f32_16x16x32_bf16 v[16:19], v[144:147], v[128:131], v[16:19]
ds_read_b128 v[172:175], v217 offset:30720
v_mfma_f32_16x16x32_bf16 v[20:23], v[144:147], v[132:135], v[20:23]
ds_read_b128 v[176:179], v217 offset:31744
v_mfma_f32_16x16x32_bf16 v[24:27], v[144:147], v[136:139], v[24:27]
ds_read_b128 v[180:183], v217 offset:32768
v_mfma_f32_16x16x32_bf16 v[28:31], v[144:147], v[140:143], v[28:31]
ds_read_b128 v[184:187], v217 offset:33792
s_mov_b32 m0, s38
s_nop 0
buffer_load_dwordx4 v222, s[12:15], s33 offen lds
v_mfma_f32_16x16x32_bf16 v[32:35], v[148:151], v[128:131], v[32:35]
ds_read_b64_tr_b16 v[188:189], v219 offset:30720
v_mfma_f32_16x16x32_bf16 v[36:39], v[148:151], v[132:135], v[36:39]
ds_read_b64_tr_b16 v[190:191], v219 offset:34304
v_mfma_f32_16x16x32_bf16 v[40:43], v[148:151], v[136:139], v[40:43]
ds_read_b64_tr_b16 v[192:193], v219 offset:37888
v_mfma_f32_16x16x32_bf16 v[44:47], v[148:151], v[140:143], v[44:47]
ds_read_b64_tr_b16 v[194:195], v219 offset:41472
v_mfma_f32_16x16x32_bf16 v[48:51], v[152:155], v[128:131], v[48:51]
ds_read_b64_tr_b16 v[196:197], v219 offset:30752
v_mfma_f32_16x16x32_bf16 v[52:55], v[152:155], v[132:135], v[52:55]
buffer_load_dwordx4 v222, s[12:15], s33 offen offset:1024 lds
s_add_u32 s33, s33, 131072
v_mfma_f32_16x16x32_bf16 v[56:59], v[152:155], v[136:139], v[56:59]
ds_read_b64_tr_b16 v[198:199], v219 offset:34336
v_mfma_f32_16x16x32_bf16 v[60:63], v[152:155], v[140:143], v[60:63]
ds_read_b64_tr_b16 v[200:201], v219 offset:37920
s_waitcnt lgkmcnt(11)
v_fmac_f32 v92, v235, v244
v_fmac_f32 v92, v231, v240
v_fmac_f32 v93, v235, v245
v_fmac_f32 v93, v231, v241
v_fmac_f32 v94, v235, v246
v_fmac_f32 v94, v231, v242
v_fmac_f32 v95, v235, v247
v_fmac_f32 v95, v231, v243
v_mfma_f32_16x16x32_bf16 v[64:67], v[156:159], v[128:131], v[64:67]
ds_read_b64_tr_b16 v[202:203], v219 offset:41504
v_fmac_f32 v96, v232, v252
v_fmac_f32 v96, v228, v248
v_fmac_f32 v97, v232, v253
v_fmac_f32 v97, v228, v249
v_fmac_f32 v98, v232, v254
v_fmac_f32 v98, v228, v250
v_fmac_f32 v99, v232, v255
v_fmac_f32 v99, v228, v251
v_mfma_f32_16x16x32_bf16 v[68:71], v[156:159], v[132:135], v[68:71]
ds_read_b64_tr_b16 v[204:205], v219 offset:30784
v_fmac_f32 v100, v233, v252
v_fmac_f32 v100, v229, v248
v_fmac_f32 v101, v233, v253
v_fmac_f32 v101, v229, v249
v_fmac_f32 v102, v233, v254
v_fmac_f32 v102, v229, v250
v_fmac_f32 v103, v233, v255
v_fmac_f32 v103, v229, v251
v_mfma_f32_16x16x32_bf16 v[72:75], v[156:159], v[136:139], v[72:75]
ds_read_b64_tr_b16 v[206:207], v219 offset:34368
v_fmac_f32 v104, v234, v252
v_fmac_f32 v104, v230, v248
v_fmac_f32 v105, v234, v253
v_fmac_f32 v105, v230, v249
v_fmac_f32 v106, v234, v254
v_fmac_f32 v106, v230, v250
v_fmac_f32 v107, v234, v255
v_fmac_f32 v107, v230, v251
v_mfma_f32_16x16x32_bf16 v[76:79], v[156:159], v[140:143], v[76:79]
ds_read_b64_tr_b16 v[208:209], v219 offset:37952
s_mov_b32 m0, s42
s_nop 0
buffer_load_dwordx4 v223, s[16:19], s34 offen lds
v_fmac_f32 v108, v235, v252
v_fmac_f32 v108, v231, v248
v_fmac_f32 v109, v235, v253
v_fmac_f32 v109, v231, v249
v_fmac_f32 v110, v235, v254
v_fmac_f32 v110, v231, v250
v_fmac_f32 v111, v235, v255
v_fmac_f32 v111, v231, v251
v_mfma_f32_16x16x32_bf16 v[80:83], v[160:163], v[128:131], v[80:83]
ds_read_b64_tr_b16 v[210:211], v219 offset:41536
v_mfma_f32_16x16x32_bf16 v[84:87], v[160:163], v[132:135], v[84:87]
ds_read_b64_tr_b16 v[212:213], v221 offset:30720
v_mfma_f32_16x16x32_bf16 v[88:91], v[160:163], v[136:139], v[88:91]
ds_read_b64_tr_b16 v[214:215], v221 offset:34304
v_mfma_f32_16x16x32_bf16 v[92:95], v[160:163], v[140:143], v[92:95]
v_mfma_f32_16x16x32_bf16 v[96:99], v[164:167], v[128:131], v[96:99]
v_mfma_f32_16x16x32_bf16 v[100:103], v[164:167], v[132:135], v[100:103]
s_mov_b32 m0, s46
s_nop 0
buffer_load_dwordx4 v223, s[20:23], s34 offen lds
s_add_u32 s34, s34, 229376
v_mfma_f32_16x16x32_bf16 v[104:107], v[164:167], v[136:139], v[104:107]
v_mfma_f32_16x16x32_bf16 v[108:111], v[164:167], v[140:143], v[108:111]
v_mfma_f32_16x16x32_bf16 v[112:115], v[168:171], v[128:131], v[112:115]
v_mfma_f32_16x16x32_bf16 v[116:119], v[168:171], v[132:135], v[116:119]
v_fmac_f32 v80, v232, v244
v_fmac_f32 v80, v228, v240
v_fmac_f32 v81, v232, v245
v_fmac_f32 v81, v228, v241
v_fmac_f32 v82, v232, v246
v_fmac_f32 v82, v228, v242
v_fmac_f32 v83, v232, v247
v_fmac_f32 v83, v228, v243
v_mfma_f32_16x16x32_bf16 v[120:123], v[168:171], v[136:139], v[120:123]
v_fmac_f32 v84, v233, v244
v_fmac_f32 v84, v229, v240
v_fmac_f32 v85, v233, v245
v_fmac_f32 v85, v229, v241
v_fmac_f32 v86, v233, v246
v_fmac_f32 v86, v229, v242
v_fmac_f32 v87, v233, v247
v_fmac_f32 v87, v229, v243
v_mfma_f32_16x16x32_bf16 v[124:127], v[168:171], v[140:143], v[124:127]
v_fmac_f32 v88, v234, v244
v_fmac_f32 v88, v230, v240
v_fmac_f32 v89, v234, v245
v_fmac_f32 v89, v230, v241
v_fmac_f32 v90, v234, v246
v_fmac_f32 v90, v230, v242
v_fmac_f32 v91, v234, v247
v_fmac_f32 v91, v230, v243
s_waitcnt vmcnt(8) lgkmcnt(0)
s_barrier
ds_read_b128 v[240:243], v237 offset:768
ds_read_b128 v[244:247], v237 offset:832
v_mfma_f32_16x16x32_bf16 v[16:19], v[188:191], v[172:175], v[16:19]
ds_read_b128 v[128:131], v216 offset:0
v_mfma_f32_16x16x32_bf16 v[20:23], v[188:191], v[176:179], v[20:23]
ds_read_b128 v[132:135], v216 offset:1024
v_mfma_f32_16x16x32_bf16 v[24:27], v[188:191], v[180:183], v[24:27]
ds_read_b128 v[136:139], v216 offset:2048
v_mfma_f32_16x16x32_bf16 v[28:31], v[188:191], v[184:187], v[28:31]
ds_read_b128 v[140:143], v216 offset:3072
s_mov_b32 m0, s39
s_nop 0
buffer_load_dwordx4 v222, s[12:15], s33 offen lds
v_mfma_f32_16x16x32_bf16 v[32:35], v[192:195], v[172:175], v[32:35]
ds_read_b64_tr_b16 v[144:145], v218 offset:0
v_mfma_f32_16x16x32_bf16 v[36:39], v[192:195], v[176:179], v[36:39]
ds_read_b64_tr_b16 v[146:147], v218 offset:3584
v_mfma_f32_16x16x32_bf16 v[40:43], v[192:195], v[180:183], v[40:43]
ds_read_b64_tr_b16 v[148:149], v218 offset:7168
v_mfma_f32_16x16x32_bf16 v[44:47], v[192:195], v[184:187], v[44:47]
ds_read_b64_tr_b16 v[150:151], v218 offset:10752
v_mfma_f32_16x16x32_bf16 v[48:51], v[196:199], v[172:175], v[48:51]
ds_read_b64_tr_b16 v[152:153], v218 offset:32
v_mfma_f32_16x16x32_bf16 v[52:55], v[196:199], v[176:179], v[52:55]
buffer_load_dwordx4 v222, s[12:15], s33 offen offset:1024 lds
s_add_u32 s33, s33, 131072
v_mfma_f32_16x16x32_bf16 v[56:59], v[196:199], v[180:183], v[56:59]
ds_read_b64_tr_b16 v[154:155], v218 offset:3616
v_mfma_f32_16x16x32_bf16 v[60:63], v[196:199], v[184:187], v[60:63]
ds_read_b64_tr_b16 v[156:157], v218 offset:7200
v_mfma_f32_16x16x32_bf16 v[64:67], v[200:203], v[172:175], v[64:67]
ds_read_b64_tr_b16 v[158:159], v218 offset:10784
v_mfma_f32_16x16x32_bf16 v[68:71], v[200:203], v[176:179], v[68:71]
ds_read_b64_tr_b16 v[160:161], v218 offset:64
v_mfma_f32_16x16x32_bf16 v[72:75], v[200:203], v[180:183], v[72:75]
ds_read_b64_tr_b16 v[162:163], v218 offset:3648
v_mfma_f32_16x16x32_bf16 v[76:79], v[200:203], v[184:187], v[76:79]
ds_read_b64_tr_b16 v[164:165], v218 offset:7232
s_mov_b32 m0, s43
s_nop 0
buffer_load_dwordx4 v223, s[16:19], s34 offen lds
v_mfma_f32_16x16x32_bf16 v[80:83], v[204:207], v[172:175], v[80:83]
ds_read_b64_tr_b16 v[166:167], v218 offset:10816
s_waitcnt lgkmcnt(15)
v_fmac_f32 v112, v232, v244
v_fmac_f32 v112, v228, v240
v_fmac_f32 v113, v232, v245
v_fmac_f32 v113, v228, v241
v_fmac_f32 v114, v232, v246
v_fmac_f32 v114, v228, v242
v_fmac_f32 v115, v232, v247
v_fmac_f32 v115, v228, v243
v_mfma_f32_16x16x32_bf16 v[84:87], v[204:207], v[176:179], v[84:87]
ds_read_b64_tr_b16 v[168:169], v220 offset:0
v_fmac_f32 v116, v233, v244
v_fmac_f32 v116, v229, v240
v_fmac_f32 v117, v233, v245
v_fmac_f32 v117, v229, v241
v_fmac_f32 v118, v233, v246
v_fmac_f32 v118, v229, v242
v_fmac_f32 v119, v233, v247
v_fmac_f32 v119, v229, v243
v_mfma_f32_16x16x32_bf16 v[88:91], v[204:207], v[180:183], v[88:91]
ds_read_b64_tr_b16 v[170:171], v220 offset:3584
v_fmac_f32 v120, v234, v244
v_fmac_f32 v120, v230, v240
v_fmac_f32 v121, v234, v245
v_fmac_f32 v121, v230, v241
v_fmac_f32 v122, v234, v246
v_fmac_f32 v122, v230, v242
v_fmac_f32 v123, v234, v247
v_fmac_f32 v123, v230, v243
v_mfma_f32_16x16x32_bf16 v[92:95], v[204:207], v[184:187], v[92:95]
v_fmac_f32 v124, v235, v244
v_fmac_f32 v124, v231, v240
v_fmac_f32 v125, v235, v245
v_fmac_f32 v125, v231, v241
v_fmac_f32 v126, v235, v246
v_fmac_f32 v126, v231, v242
v_fmac_f32 v127, v235, v247
v_fmac_f32 v127, v231, v243
v_mfma_f32_16x16x32_bf16 v[96:99], v[208:211], v[172:175], v[96:99]
v_mfma_f32_16x16x32_bf16 v[100:103], v[208:211], v[176:179], v[100:103]
s_mov_b32 m0, s47
s_nop 0
buffer_load_dwordx4 v223, s[20:23], s34 offen lds
s_add_u32 s34, s34, 229376
v_mfma_f32_16x16x32_bf16 v[104:107], v[208:211], v[180:183], v[104:107]
v_mfma_f32_16x16x32_bf16 v[108:111], v[208:211], v[184:187], v[108:111]
v_mfma_f32_16x16x32_bf16 v[112:115], v[212:215], v[172:175], v[112:115]
v_mfma_f32_16x16x32_bf16 v[116:119], v[212:215], v[176:179], v[116:119]
v_mfma_f32_16x16x32_bf16 v[120:123], v[212:215], v[180:183], v[120:123]
v_mfma_f32_16x16x32_bf16 v[124:127], v[212:215], v[184:187], v[124:127]
s_mov_b32 s48, 7
k5_kernel_loop:
s_waitcnt vmcnt(8) lgkmcnt(0)
s_barrier
v_mfma_f32_16x16x32_bf16 v[16:19], v[144:147], v[128:131], v[16:19]
ds_read_b128 v[172:175], v216 offset:30720
v_mfma_f32_16x16x32_bf16 v[20:23], v[144:147], v[132:135], v[20:23]
ds_read_b128 v[176:179], v216 offset:31744
v_mfma_f32_16x16x32_bf16 v[24:27], v[144:147], v[136:139], v[24:27]
ds_read_b128 v[180:183], v216 offset:32768
v_mfma_f32_16x16x32_bf16 v[28:31], v[144:147], v[140:143], v[28:31]
ds_read_b128 v[184:187], v216 offset:33792
s_mov_b32 m0, s36
s_nop 0
buffer_load_dwordx4 v222, s[12:15], s33 offen lds
v_mfma_f32_16x16x32_bf16 v[32:35], v[148:151], v[128:131], v[32:35]
ds_read_b64_tr_b16 v[188:189], v218 offset:30720
v_mfma_f32_16x16x32_bf16 v[36:39], v[148:151], v[132:135], v[36:39]
ds_read_b64_tr_b16 v[190:191], v218 offset:34304
v_mfma_f32_16x16x32_bf16 v[40:43], v[148:151], v[136:139], v[40:43]
ds_read_b64_tr_b16 v[192:193], v218 offset:37888
v_mfma_f32_16x16x32_bf16 v[44:47], v[148:151], v[140:143], v[44:47]
ds_read_b64_tr_b16 v[194:195], v218 offset:41472
v_mfma_f32_16x16x32_bf16 v[48:51], v[152:155], v[128:131], v[48:51]
ds_read_b64_tr_b16 v[196:197], v218 offset:30752
v_mfma_f32_16x16x32_bf16 v[52:55], v[152:155], v[132:135], v[52:55]
buffer_load_dwordx4 v222, s[12:15], s33 offen offset:1024 lds
s_add_u32 s33, s33, 131072
v_mfma_f32_16x16x32_bf16 v[56:59], v[152:155], v[136:139], v[56:59]
ds_read_b64_tr_b16 v[198:199], v218 offset:34336
v_mfma_f32_16x16x32_bf16 v[60:63], v[152:155], v[140:143], v[60:63]
ds_read_b64_tr_b16 v[200:201], v218 offset:37920
v_mfma_f32_16x16x32_bf16 v[64:67], v[156:159], v[128:131], v[64:67]
ds_read_b64_tr_b16 v[202:203], v218 offset:41504
v_mfma_f32_16x16x32_bf16 v[68:71], v[156:159], v[132:135], v[68:71]
ds_read_b64_tr_b16 v[204:205], v218 offset:30784
v_mfma_f32_16x16x32_bf16 v[72:75], v[156:159], v[136:139], v[72:75]
ds_read_b64_tr_b16 v[206:207], v218 offset:34368
v_mfma_f32_16x16x32_bf16 v[76:79], v[156:159], v[140:143], v[76:79]
ds_read_b64_tr_b16 v[208:209], v218 offset:37952
s_mov_b32 m0, s40
s_nop 0
buffer_load_dwordx4 v223, s[16:19], s34 offen lds
v_mfma_f32_16x16x32_bf16 v[80:83], v[160:163], v[128:131], v[80:83]
ds_read_b64_tr_b16 v[210:211], v218 offset:41536
v_mfma_f32_16x16x32_bf16 v[84:87], v[160:163], v[132:135], v[84:87]
ds_read_b64_tr_b16 v[212:213], v220 offset:30720
v_mfma_f32_16x16x32_bf16 v[88:91], v[160:163], v[136:139], v[88:91]
ds_read_b64_tr_b16 v[214:215], v220 offset:34304
v_mfma_f32_16x16x32_bf16 v[92:95], v[160:163], v[140:143], v[92:95]
v_mfma_f32_16x16x32_bf16 v[96:99], v[164:167], v[128:131], v[96:99]
v_mfma_f32_16x16x32_bf16 v[100:103], v[164:167], v[132:135], v[100:103]
s_mov_b32 m0, s44
s_nop 0
buffer_load_dwordx4 v223, s[20:23], s34 offen lds
s_add_u32 s34, s34, 229376
v_mfma_f32_16x16x32_bf16 v[104:107], v[164:167], v[136:139], v[104:107]
v_mfma_f32_16x16x32_bf16 v[108:111], v[164:167], v[140:143], v[108:111]
v_mfma_f32_16x16x32_bf16 v[112:115], v[168:171], v[128:131], v[112:115]
v_mfma_f32_16x16x32_bf16 v[116:119], v[168:171], v[132:135], v[116:119]
v_mfma_f32_16x16x32_bf16 v[120:123], v[168:171], v[136:139], v[120:123]
v_mfma_f32_16x16x32_bf16 v[124:127], v[168:171], v[140:143], v[124:127]
s_waitcnt vmcnt(8) lgkmcnt(0)
s_barrier
v_mfma_f32_16x16x32_bf16 v[16:19], v[188:191], v[172:175], v[16:19]
ds_read_b128 v[128:131], v217 offset:0
v_mfma_f32_16x16x32_bf16 v[20:23], v[188:191], v[176:179], v[20:23]
ds_read_b128 v[132:135], v217 offset:1024
v_mfma_f32_16x16x32_bf16 v[24:27], v[188:191], v[180:183], v[24:27]
ds_read_b128 v[136:139], v217 offset:2048
v_mfma_f32_16x16x32_bf16 v[28:31], v[188:191], v[184:187], v[28:31]
ds_read_b128 v[140:143], v217 offset:3072
s_mov_b32 m0, s37
s_nop 0
buffer_load_dwordx4 v222, s[12:15], s33 offen lds
v_mfma_f32_16x16x32_bf16 v[32:35], v[192:195], v[172:175], v[32:35]
ds_read_b64_tr_b16 v[144:145], v219 offset:0
v_mfma_f32_16x16x32_bf16 v[36:39], v[192:195], v[176:179], v[36:39]
ds_read_b64_tr_b16 v[146:147], v219 offset:3584
v_mfma_f32_16x16x32_bf16 v[40:43], v[192:195], v[180:183], v[40:43]
ds_read_b64_tr_b16 v[148:149], v219 offset:7168
v_mfma_f32_16x16x32_bf16 v[44:47], v[192:195], v[184:187], v[44:47]
ds_read_b64_tr_b16 v[150:151], v219 offset:10752
v_mfma_f32_16x16x32_bf16 v[48:51], v[196:199], v[172:175], v[48:51]
ds_read_b64_tr_b16 v[152:153], v219 offset:32
v_mfma_f32_16x16x32_bf16 v[52:55], v[196:199], v[176:179], v[52:55]
buffer_load_dwordx4 v222, s[12:15], s33 offen offset:1024 lds
s_add_u32 s33, s33, 131072
v_mfma_f32_16x16x32_bf16 v[56:59], v[196:199], v[180:183], v[56:59]
ds_read_b64_tr_b16 v[154:155], v219 offset:3616
v_mfma_f32_16x16x32_bf16 v[60:63], v[196:199], v[184:187], v[60:63]
ds_read_b64_tr_b16 v[156:157], v219 offset:7200
v_mfma_f32_16x16x32_bf16 v[64:67], v[200:203], v[172:175], v[64:67]
ds_read_b64_tr_b16 v[158:159], v219 offset:10784
v_mfma_f32_16x16x32_bf16 v[68:71], v[200:203], v[176:179], v[68:71]
ds_read_b64_tr_b16 v[160:161], v219 offset:64
v_mfma_f32_16x16x32_bf16 v[72:75], v[200:203], v[180:183], v[72:75]
ds_read_b64_tr_b16 v[162:163], v219 offset:3648
v_mfma_f32_16x16x32_bf16 v[76:79], v[200:203], v[184:187], v[76:79]
ds_read_b64_tr_b16 v[164:165], v219 offset:7232
s_mov_b32 m0, s41
s_nop 0
buffer_load_dwordx4 v223, s[16:19], s34 offen lds
v_mfma_f32_16x16x32_bf16 v[80:83], v[204:207], v[172:175], v[80:83]
ds_read_b64_tr_b16 v[166:167], v219 offset:10816
v_mfma_f32_16x16x32_bf16 v[84:87], v[204:207], v[176:179], v[84:87]
ds_read_b64_tr_b16 v[168:169], v221 offset:0
v_mfma_f32_16x16x32_bf16 v[88:91], v[204:207], v[180:183], v[88:91]
ds_read_b64_tr_b16 v[170:171], v221 offset:3584
v_mfma_f32_16x16x32_bf16 v[92:95], v[204:207], v[184:187], v[92:95]
v_mfma_f32_16x16x32_bf16 v[96:99], v[208:211], v[172:175], v[96:99]
v_mfma_f32_16x16x32_bf16 v[100:103], v[208:211], v[176:179], v[100:103]
s_mov_b32 m0, s45
s_nop 0
buffer_load_dwordx4 v223, s[20:23], s34 offen lds
s_add_u32 s34, s34, 229376
v_mfma_f32_16x16x32_bf16 v[104:107], v[208:211], v[180:183], v[104:107]
v_mfma_f32_16x16x32_bf16 v[108:111], v[208:211], v[184:187], v[108:111]
v_mfma_f32_16x16x32_bf16 v[112:115], v[212:215], v[172:175], v[112:115]
v_mfma_f32_16x16x32_bf16 v[116:119], v[212:215], v[176:179], v[116:119]
v_mfma_f32_16x16x32_bf16 v[120:123], v[212:215], v[180:183], v[120:123]
v_mfma_f32_16x16x32_bf16 v[124:127], v[212:215], v[184:187], v[124:127]
s_waitcnt vmcnt(8) lgkmcnt(0)
s_barrier
v_mfma_f32_16x16x32_bf16 v[16:19], v[144:147], v[128:131], v[16:19]
ds_read_b128 v[172:175], v217 offset:30720
v_mfma_f32_16x16x32_bf16 v[20:23], v[144:147], v[132:135], v[20:23]
ds_read_b128 v[176:179], v217 offset:31744
v_mfma_f32_16x16x32_bf16 v[24:27], v[144:147], v[136:139], v[24:27]
ds_read_b128 v[180:183], v217 offset:32768
v_mfma_f32_16x16x32_bf16 v[28:31], v[144:147], v[140:143], v[28:31]
ds_read_b128 v[184:187], v217 offset:33792
s_mov_b32 m0, s38
s_nop 0
buffer_load_dwordx4 v222, s[12:15], s33 offen lds
v_mfma_f32_16x16x32_bf16 v[32:35], v[148:151], v[128:131], v[32:35]
ds_read_b64_tr_b16 v[188:189], v219 offset:30720
v_mfma_f32_16x16x32_bf16 v[36:39], v[148:151], v[132:135], v[36:39]
ds_read_b64_tr_b16 v[190:191], v219 offset:34304
v_mfma_f32_16x16x32_bf16 v[40:43], v[148:151], v[136:139], v[40:43]
ds_read_b64_tr_b16 v[192:193], v219 offset:37888
v_mfma_f32_16x16x32_bf16 v[44:47], v[148:151], v[140:143], v[44:47]
ds_read_b64_tr_b16 v[194:195], v219 offset:41472
v_mfma_f32_16x16x32_bf16 v[48:51], v[152:155], v[128:131], v[48:51]
ds_read_b64_tr_b16 v[196:197], v219 offset:30752
v_mfma_f32_16x16x32_bf16 v[52:55], v[152:155], v[132:135], v[52:55]
buffer_load_dwordx4 v222, s[12:15], s33 offen offset:1024 lds
s_add_u32 s33, s33, 131072
v_mfma_f32_16x16x32_bf16 v[56:59], v[152:155], v[136:139], v[56:59]
ds_read_b64_tr_b16 v[198:199], v219 offset:34336
v_mfma_f32_16x16x32_bf16 v[60:63], v[152:155], v[140:143], v[60:63]
ds_read_b64_tr_b16 v[200:201], v219 offset:37920
v_mfma_f32_16x16x32_bf16 v[64:67], v[156:159], v[128:131], v[64:67]
ds_read_b64_tr_b16 v[202:203], v219 offset:41504
v_mfma_f32_16x16x32_bf16 v[68:71], v[156:159], v[132:135], v[68:71]
ds_read_b64_tr_b16 v[204:205], v219 offset:30784
v_mfma_f32_16x16x32_bf16 v[72:75], v[156:159], v[136:139], v[72:75]
ds_read_b64_tr_b16 v[206:207], v219 offset:34368
v_mfma_f32_16x16x32_bf16 v[76:79], v[156:159], v[140:143], v[76:79]
ds_read_b64_tr_b16 v[208:209], v219 offset:37952
s_mov_b32 m0, s42
s_nop 0
buffer_load_dwordx4 v223, s[16:19], s34 offen lds
v_mfma_f32_16x16x32_bf16 v[80:83], v[160:163], v[128:131], v[80:83]
ds_read_b64_tr_b16 v[210:211], v219 offset:41536
v_mfma_f32_16x16x32_bf16 v[84:87], v[160:163], v[132:135], v[84:87]
ds_read_b64_tr_b16 v[212:213], v221 offset:30720
v_mfma_f32_16x16x32_bf16 v[88:91], v[160:163], v[136:139], v[88:91]
ds_read_b64_tr_b16 v[214:215], v221 offset:34304
v_mfma_f32_16x16x32_bf16 v[92:95], v[160:163], v[140:143], v[92:95]
v_mfma_f32_16x16x32_bf16 v[96:99], v[164:167], v[128:131], v[96:99]
v_mfma_f32_16x16x32_bf16 v[100:103], v[164:167], v[132:135], v[100:103]
s_mov_b32 m0, s46
s_nop 0
buffer_load_dwordx4 v223, s[20:23], s34 offen lds
s_add_u32 s34, s34, 229376
v_mfma_f32_16x16x32_bf16 v[104:107], v[164:167], v[136:139], v[104:107]
v_mfma_f32_16x16x32_bf16 v[108:111], v[164:167], v[140:143], v[108:111]
v_mfma_f32_16x16x32_bf16 v[112:115], v[168:171], v[128:131], v[112:115]
v_mfma_f32_16x16x32_bf16 v[116:119], v[168:171], v[132:135], v[116:119]
v_mfma_f32_16x16x32_bf16 v[120:123], v[168:171], v[136:139], v[120:123]
v_mfma_f32_16x16x32_bf16 v[124:127], v[168:171], v[140:143], v[124:127]
s_waitcnt vmcnt(8) lgkmcnt(0)
s_barrier
v_mfma_f32_16x16x32_bf16 v[16:19], v[188:191], v[172:175], v[16:19]
ds_read_b128 v[128:131], v216 offset:0
v_mfma_f32_16x16x32_bf16 v[20:23], v[188:191], v[176:179], v[20:23]
ds_read_b128 v[132:135], v216 offset:1024
v_mfma_f32_16x16x32_bf16 v[24:27], v[188:191], v[180:183], v[24:27]
ds_read_b128 v[136:139], v216 offset:2048
v_mfma_f32_16x16x32_bf16 v[28:31], v[188:191], v[184:187], v[28:31]
ds_read_b128 v[140:143], v216 offset:3072
s_mov_b32 m0, s39
s_nop 0
buffer_load_dwordx4 v222, s[12:15], s33 offen lds
v_mfma_f32_16x16x32_bf16 v[32:35], v[192:195], v[172:175], v[32:35]
ds_read_b64_tr_b16 v[144:145], v218 offset:0
v_mfma_f32_16x16x32_bf16 v[36:39], v[192:195], v[176:179], v[36:39]
ds_read_b64_tr_b16 v[146:147], v218 offset:3584
v_mfma_f32_16x16x32_bf16 v[40:43], v[192:195], v[180:183], v[40:43]
ds_read_b64_tr_b16 v[148:149], v218 offset:7168
v_mfma_f32_16x16x32_bf16 v[44:47], v[192:195], v[184:187], v[44:47]
ds_read_b64_tr_b16 v[150:151], v218 offset:10752
v_mfma_f32_16x16x32_bf16 v[48:51], v[196:199], v[172:175], v[48:51]
ds_read_b64_tr_b16 v[152:153], v218 offset:32
v_mfma_f32_16x16x32_bf16 v[52:55], v[196:199], v[176:179], v[52:55]
buffer_load_dwordx4 v222, s[12:15], s33 offen offset:1024 lds
s_add_u32 s33, s33, 131072
v_mfma_f32_16x16x32_bf16 v[56:59], v[196:199], v[180:183], v[56:59]
ds_read_b64_tr_b16 v[154:155], v218 offset:3616
v_mfma_f32_16x16x32_bf16 v[60:63], v[196:199], v[184:187], v[60:63]
ds_read_b64_tr_b16 v[156:157], v218 offset:7200
v_mfma_f32_16x16x32_bf16 v[64:67], v[200:203], v[172:175], v[64:67]
ds_read_b64_tr_b16 v[158:159], v218 offset:10784
v_mfma_f32_16x16x32_bf16 v[68:71], v[200:203], v[176:179], v[68:71]
ds_read_b64_tr_b16 v[160:161], v218 offset:64
v_mfma_f32_16x16x32_bf16 v[72:75], v[200:203], v[180:183], v[72:75]
ds_read_b64_tr_b16 v[162:163], v218 offset:3648
v_mfma_f32_16x16x32_bf16 v[76:79], v[200:203], v[184:187], v[76:79]
ds_read_b64_tr_b16 v[164:165], v218 offset:7232
s_mov_b32 m0, s43
s_nop 0
buffer_load_dwordx4 v223, s[16:19], s34 offen lds
v_mfma_f32_16x16x32_bf16 v[80:83], v[204:207], v[172:175], v[80:83]
ds_read_b64_tr_b16 v[166:167], v218 offset:10816
v_mfma_f32_16x16x32_bf16 v[84:87], v[204:207], v[176:179], v[84:87]
ds_read_b64_tr_b16 v[168:169], v220 offset:0
v_mfma_f32_16x16x32_bf16 v[88:91], v[204:207], v[180:183], v[88:91]
ds_read_b64_tr_b16 v[170:171], v220 offset:3584
v_mfma_f32_16x16x32_bf16 v[92:95], v[204:207], v[184:187], v[92:95]
v_mfma_f32_16x16x32_bf16 v[96:99], v[208:211], v[172:175], v[96:99]
v_mfma_f32_16x16x32_bf16 v[100:103], v[208:211], v[176:179], v[100:103]
s_mov_b32 m0, s47
s_nop 0
buffer_load_dwordx4 v223, s[20:23], s34 offen lds
s_add_u32 s34, s34, 229376
v_mfma_f32_16x16x32_bf16 v[104:107], v[208:211], v[180:183], v[104:107]
v_mfma_f32_16x16x32_bf16 v[108:111], v[208:211], v[184:187], v[108:111]
v_mfma_f32_16x16x32_bf16 v[112:115], v[212:215], v[172:175], v[112:115]
v_mfma_f32_16x16x32_bf16 v[116:119], v[212:215], v[176:179], v[116:119]
v_mfma_f32_16x16x32_bf16 v[120:123], v[212:215], v[180:183], v[120:123]
v_mfma_f32_16x16x32_bf16 v[124:127], v[212:215], v[184:187], v[124:127]
s_sub_u32 s48, s48, 1
s_cmp_lg_u32 s48, 0
s_cbranch_scc1 k5_kernel_loop
v_lshlrev_b32 v5, 4, v236
s_lshl_b32 s3, s29, 12
s_add_u32 s3, s3, 133120
v_add_u32 v5, s3, v5
v_lshlrev_b32 v6, 4, v236
s_lshl_b32 s3, s31, 14
s_lshl_b32 s54, s29, 12
s_add_u32 s3, s3, s54
v_add_u32 v6, s3, v6
s_lshr_b32 s55, s32, 1
s_mul_i32 s55, s55, 7
s_and_b32 s56, s32, 1
s_mul_i32 s57, s56, 3
s_add_u32 s57, s57, s55
s_nop 3
s_cmp_eq_u32 s30, 1
s_cbranch_scc0 k5_kernel_x1
ds_write_b128 v5, v[112:115] offset:0
ds_write_b128 v5, v[116:119] offset:1024
ds_write_b128 v5, v[120:123] offset:2048
ds_write_b128 v5, v[124:127] offset:3072
k5_kernel_x1:
v_mul_f32 v32, v224, v32
v_max_f32 v16, 0, v16
v_mul_f32 v16, v16, v32
v_mul_f32 v33, v224, v33
v_max_f32 v17, 0, v17
v_mul_f32 v17, v17, v33
v_mul_f32 v34, v224, v34
v_max_f32 v18, 0, v18
v_mul_f32 v18, v18, v34
v_mul_f32 v35, v224, v35
v_max_f32 v19, 0, v19
v_mul_f32 v19, v19, v35
v_mul_f32 v36, v225, v36
v_max_f32 v20, 0, v20
v_mul_f32 v20, v20, v36
v_mul_f32 v37, v225, v37
v_max_f32 v21, 0, v21
v_mul_f32 v21, v21, v37
v_mul_f32 v38, v225, v38
v_max_f32 v22, 0, v22
v_mul_f32 v22, v22, v38
v_mul_f32 v39, v225, v39
v_max_f32 v23, 0, v23
v_mul_f32 v23, v23, v39
v_mul_f32 v40, v226, v40
v_max_f32 v24, 0, v24
v_mul_f32 v24, v24, v40
v_mul_f32 v41, v226, v41
v_max_f32 v25, 0, v25
v_mul_f32 v25, v25, v41
v_mul_f32 v42, v226, v42
v_max_f32 v26, 0, v26
v_mul_f32 v26, v26, v42
v_mul_f32 v43, v226, v43
v_max_f32 v27, 0, v27
v_mul_f32 v27, v27, v43
v_mul_f32 v44, v227, v44
v_max_f32 v28, 0, v28
v_mul_f32 v28, v28, v44
v_mul_f32 v45, v227, v45
v_max_f32 v29, 0, v29
v_mul_f32 v29, v29, v45
v_mul_f32 v46, v227, v46
v_max_f32 v30, 0, v30
v_mul_f32 v30, v30, v46
v_mul_f32 v47, v227, v47
v_max_f32 v31, 0, v31
v_mul_f32 v31, v31, v47
v_mul_f32 v64, v224, v64
v_max_f32 v48, 0, v48
v_mul_f32 v48, v48, v64
v_mul_f32 v65, v224, v65
v_max_f32 v49, 0, v49
v_mul_f32 v49, v49, v65
v_mul_f32 v66, v224, v66
v_max_f32 v50, 0, v50
v_mul_f32 v50, v50, v66
v_mul_f32 v67, v224, v67
v_max_f32 v51, 0, v51
v_mul_f32 v51, v51, v67
v_mul_f32 v68, v225, v68
v_max_f32 v52, 0, v52
v_mul_f32 v52, v52, v68
v_mul_f32 v69, v225, v69
v_max_f32 v53, 0, v53
v_mul_f32 v53, v53, v69
v_mul_f32 v70, v225, v70
v_max_f32 v54, 0, v54
v_mul_f32 v54, v54, v70
v_mul_f32 v71, v225, v71
v_max_f32 v55, 0, v55
v_mul_f32 v55, v55, v71
v_mul_f32 v72, v226, v72
v_max_f32 v56, 0, v56
v_mul_f32 v56, v56, v72
v_mul_f32 v73, v226, v73
v_max_f32 v57, 0, v57
v_mul_f32 v57, v57, v73
v_mul_f32 v74, v226, v74
v_max_f32 v58, 0, v58
v_mul_f32 v58, v58, v74
v_mul_f32 v75, v226, v75
v_max_f32 v59, 0, v59
v_mul_f32 v59, v59, v75
v_mul_f32 v76, v227, v76
v_max_f32 v60, 0, v60
v_mul_f32 v60, v60, v76
v_mul_f32 v77, v227, v77
v_max_f32 v61, 0, v61
v_mul_f32 v61, v61, v77
v_mul_f32 v78, v227, v78
v_max_f32 v62, 0, v62
v_mul_f32 v62, v62, v78
v_mul_f32 v79, v227, v79
v_max_f32 v63, 0, v63
v_mul_f32 v63, v63, v79
s_lshl_b32 s3, s30, 1
s_add_u32 s3, s3, s57
s_lshl_b32 s3, s3, 17
s_add_u32 s3, s3, 25165824
v_cvt_pk_bf16_f32 v8, v16, v17
v_cvt_pk_bf16_f32 v9, v18, v19
v_cvt_pk_bf16_f32 v10, v48, v49
v_cvt_pk_bf16_f32 v11, v50, v51
buffer_store_dwordx4 v[8:11], v6, s[24:27], s3 offen offset:0 sc1
v_cvt_pk_bf16_f32 v12, v20, v21
v_cvt_pk_bf16_f32 v13, v22, v23
v_cvt_pk_bf16_f32 v14, v52, v53
v_cvt_pk_bf16_f32 v15, v54, v55
buffer_store_dwordx4 v[12:15], v6, s[24:27], s3 offen offset:1024 sc1
v_cvt_pk_bf16_f32 v8, v24, v25
v_cvt_pk_bf16_f32 v9, v26, v27
v_cvt_pk_bf16_f32 v10, v56, v57
v_cvt_pk_bf16_f32 v11, v58, v59
buffer_store_dwordx4 v[8:11], v6, s[24:27], s3 offen offset:2048 sc1
v_cvt_pk_bf16_f32 v12, v28, v29
v_cvt_pk_bf16_f32 v13, v30, v31
v_cvt_pk_bf16_f32 v14, v60, v61
v_cvt_pk_bf16_f32 v15, v62, v63
buffer_store_dwordx4 v[12:15], v6, s[24:27], s3 offen offset:3072 sc1
v_mul_f32 v96, v224, v96
v_max_f32 v80, 0, v80
v_mul_f32 v80, v80, v96
v_mul_f32 v97, v224, v97
v_max_f32 v81, 0, v81
v_mul_f32 v81, v81, v97
v_mul_f32 v98, v224, v98
v_max_f32 v82, 0, v82
v_mul_f32 v82, v82, v98
v_mul_f32 v99, v224, v99
v_max_f32 v83, 0, v83
v_mul_f32 v83, v83, v99
v_mul_f32 v100, v225, v100
v_max_f32 v84, 0, v84
v_mul_f32 v84, v84, v100
v_mul_f32 v101, v225, v101
v_max_f32 v85, 0, v85
v_mul_f32 v85, v85, v101
v_mul_f32 v102, v225, v102
v_max_f32 v86, 0, v86
v_mul_f32 v86, v86, v102
v_mul_f32 v103, v225, v103
v_max_f32 v87, 0, v87
v_mul_f32 v87, v87, v103
v_mul_f32 v104, v226, v104
v_max_f32 v88, 0, v88
v_mul_f32 v88, v88, v104
v_mul_f32 v105, v226, v105
v_max_f32 v89, 0, v89
v_mul_f32 v89, v89, v105
v_mul_f32 v106, v226, v106
v_max_f32 v90, 0, v90
v_mul_f32 v90, v90, v106
v_mul_f32 v107, v226, v107
v_max_f32 v91, 0, v91
v_mul_f32 v91, v91, v107
v_mul_f32 v108, v227, v108
v_max_f32 v92, 0, v92
v_mul_f32 v92, v92, v108
v_mul_f32 v109, v227, v109
v_max_f32 v93, 0, v93
v_mul_f32 v93, v93, v109
v_mul_f32 v110, v227, v110
v_max_f32 v94, 0, v94
v_mul_f32 v94, v94, v110
v_mul_f32 v111, v227, v111
v_max_f32 v95, 0, v95
v_mul_f32 v95, v95, v111
s_waitcnt lgkmcnt(0)
s_barrier
s_cmp_eq_u32 s30, 0
s_cbranch_scc0 k5_kernel_single
ds_read_b128 v[192:195], v5 offset:0
ds_read_b128 v[196:199], v5 offset:1024
ds_read_b128 v[200:203], v5 offset:2048
ds_read_b128 v[204:207], v5 offset:3072
s_add_u32 s3, s57, 1
s_lshl_b32 s3, s3, 17
s_add_u32 s3, s3, 25165824
s_waitcnt lgkmcnt(0)
v_mul_f32 v192, v224, v192
v_max_f32 v112, 0, v112
v_mul_f32 v112, v112, v192
v_mul_f32 v193, v224, v193
v_max_f32 v113, 0, v113
v_mul_f32 v113, v113, v193
v_mul_f32 v194, v224, v194
v_max_f32 v114, 0, v114
v_mul_f32 v114, v114, v194
v_mul_f32 v195, v224, v195
v_max_f32 v115, 0, v115
v_mul_f32 v115, v115, v195
v_mul_f32 v196, v225, v196
v_max_f32 v116, 0, v116
v_mul_f32 v116, v116, v196
v_mul_f32 v197, v225, v197
v_max_f32 v117, 0, v117
v_mul_f32 v117, v117, v197
v_mul_f32 v198, v225, v198
v_max_f32 v118, 0, v118
v_mul_f32 v118, v118, v198
v_mul_f32 v199, v225, v199
v_max_f32 v119, 0, v119
v_mul_f32 v119, v119, v199
v_mul_f32 v200, v226, v200
v_max_f32 v120, 0, v120
v_mul_f32 v120, v120, v200
v_mul_f32 v201, v226, v201
v_max_f32 v121, 0, v121
v_mul_f32 v121, v121, v201
v_mul_f32 v202, v226, v202
v_max_f32 v122, 0, v122
v_mul_f32 v122, v122, v202
v_mul_f32 v203, v226, v203
v_max_f32 v123, 0, v123
v_mul_f32 v123, v123, v203
v_mul_f32 v204, v227, v204
v_max_f32 v124, 0, v124
v_mul_f32 v124, v124, v204
v_mul_f32 v205, v227, v205
v_max_f32 v125, 0, v125
v_mul_f32 v125, v125, v205
v_mul_f32 v206, v227, v206
v_max_f32 v126, 0, v126
v_mul_f32 v126, v126, v206
v_mul_f32 v207, v227, v207
v_max_f32 v127, 0, v127
v_mul_f32 v127, v127, v207
v_cvt_pk_bf16_f32 v8, v80, v81
v_cvt_pk_bf16_f32 v9, v82, v83
v_cvt_pk_bf16_f32 v10, v112, v113
v_cvt_pk_bf16_f32 v11, v114, v115
buffer_store_dwordx4 v[8:11], v6, s[24:27], s3 offen offset:0 sc1
v_cvt_pk_bf16_f32 v12, v84, v85
v_cvt_pk_bf16_f32 v13, v86, v87
v_cvt_pk_bf16_f32 v14, v116, v117
v_cvt_pk_bf16_f32 v15, v118, v119
buffer_store_dwordx4 v[12:15], v6, s[24:27], s3 offen offset:1024 sc1
v_cvt_pk_bf16_f32 v8, v88, v89
v_cvt_pk_bf16_f32 v9, v90, v91
v_cvt_pk_bf16_f32 v10, v120, v121
v_cvt_pk_bf16_f32 v11, v122, v123
buffer_store_dwordx4 v[8:11], v6, s[24:27], s3 offen offset:2048 sc1
v_cvt_pk_bf16_f32 v12, v92, v93
v_cvt_pk_bf16_f32 v13, v94, v95
v_cvt_pk_bf16_f32 v14, v124, v125
v_cvt_pk_bf16_f32 v15, v126, v127
buffer_store_dwordx4 v[12:15], v6, s[24:27], s3 offen offset:3072 sc1
s_branch k5_kernel_fin
k5_kernel_single:
s_add_u32 s3, s55, 6
s_lshl_b32 s3, s3, 17
s_lshl_b32 s56, s56, 3
s_add_u32 s3, s3, s56
s_add_u32 s3, s3, 25165824
v_cvt_pk_bf16_f32 v8, v80, v81
v_cvt_pk_bf16_f32 v9, v82, v83
buffer_store_dwordx2 v[8:9], v6, s[24:27], s3 offen offset:0 sc1
v_cvt_pk_bf16_f32 v10, v84, v85
v_cvt_pk_bf16_f32 v11, v86, v87
buffer_store_dwordx2 v[10:11], v6, s[24:27], s3 offen offset:1024 sc1
v_cvt_pk_bf16_f32 v8, v88, v89
v_cvt_pk_bf16_f32 v9, v90, v91
buffer_store_dwordx2 v[8:9], v6, s[24:27], s3 offen offset:2048 sc1
v_cvt_pk_bf16_f32 v10, v92, v93
v_cvt_pk_bf16_f32 v11, v94, v95
buffer_store_dwordx2 v[10:11], v6, s[24:27], s3 offen offset:3072 sc1
k5_kernel_fin:
k5_kernel_end:
s_endpgm
.section .rodata,"a"
.p2align 6
.amdhsa_kernel k5_kernel
  .amdhsa_next_free_vgpr 256
  .amdhsa_next_free_sgpr 102
  .amdhsa_accum_offset 256
  .amdhsa_group_segment_fixed_size 0
  .amdhsa_kernarg_size 112
  .amdhsa_user_sgpr_count 2
  .amdhsa_user_sgpr_kernarg_segment_ptr 1
  .amdhsa_system_sgpr_workgroup_id_x 1
.end_amdhsa_kernel
.text
.globl k6_kernel
.p2align 8
.type k6_kernel,@function
k6_kernel:
s_cmp_ge_u32 s2, 256
s_cbranch_scc1 k6_kernel_end
s_load_dwordx2 s[4:5], s[0:1], 64
s_load_dwordx2 s[8:9], s[0:1], 104
s_load_dwordx2 s[44:45], s[0:1], 88
v_lshrrev_b32 v1, 6, v0
v_and_b32 v186, 63, v0
v_readfirstlane_b32 s32, v1
s_and_b32 s3, s2, 7
s_lshr_b32 s10, s2, 3
s_lshr_b32 s35, s3, 1
s_lshl_b32 s35, s35, 2
s_and_b32 s11, s10, 3
s_add_u32 s35, s35, s11
s_and_b32 s36, s3, 1
s_lshl_b32 s36, s36, 3
s_lshr_b32 s11, s10, 2
s_add_u32 s36, s36, s11
s_lshr_b32 s33, s32, 2
s_and_b32 s34, s32, 3
s_mov_b32 s41, 0
v_lshlrev_b32 v176, 4, v186
s_lshl_b32 s3, s34, 11
s_lshl_b32 s10, s35, 13
s_add_u32 s3, s3, s10
s_lshl_b32 s10, s33, 17
s_add_u32 s3, s3, s10
v_add_u32 v176, s3, v176
s_lshl_b32 s10, s41, 10
v_add_u32 v177, 1024, v176
v_subrev_u32 v177, s10, v177
v_add_u32 v176, s10, v176
v_lshrrev_b32 v2, 3, v186
s_lshl_b32 s3, s32, 3
v_add_u32 v3, s3, v2
v_bfe_u32 v4, v3, 1, 2
v_bfe_u32 v5, v186, 1, 2
v_xor_b32 v5, v5, v4
v_and_b32 v6, 1, v186
v_lshl_or_b32 v5, v5, 1, v6
v_lshlrev_b32 v5, 4, v5
s_and_b32 s3, s32, 1
s_lshl_b32 s3, s3, 3
v_add_u32 v6, s3, v2
v_lshl_add_u32 v178, v6, 11, v5
s_lshl_b32 s40, s32, 10
s_waitcnt lgkmcnt(0)
s_add_u32 s12, s8, 25165824
s_addc_u32 s13, s9, 0
s_and_b32 s13, s13, 0xffff
s_mov_b32 s14, 14680064
s_mov_b32 s15, 0x00020000
s_lshl_b32 s3, s36, 7
s_add_u32 s16, s4, s3
s_addc_u32 s17, s5, 0
s_and_b32 s17, s17, 0xffff
s_sub_u32 s18, 7340032, s3
s_mov_b32 s19, 0x00020000
s_mov_b32 s24, s8
s_and_b32 s25, s9, 0xffff
s_mov_b32 s26, 67108864
s_mov_b32 s27, 0x00020000
s_mov_b32 s28, s44
s_and_b32 s29, s45, 0xffff
s_mov_b32 s30, 4194304
s_mov_b32 s31, 0x00020000
v_lshlrev_b32 v178, 4, v186
s_lshl_b32 s3, s32, 10
v_add_u32 v178, s3, v178
s_add_u32 s16, s8, 40894464
s_addc_u32 s17, s9, 0
s_and_b32 s17, s17, 0xffff
s_mov_b32 s18, 7340032
s_mul_i32 s47, s36, 458752
s_mov_b32 s37, 0
s_mov_b32 s39, 0
s_mov_b32 s50, 0
s_lshr_b32 s51, s32, 2
s_bfe_u32 s52, s32, 0x10001
v_and_b32 v2, 15, v186
v_lshrrev_b32 v3, 4, v186
s_add_u32 m0, s40, 0
s_nop 0
buffer_load_dwordx4 v178, s[16:19], s47 offen lds
s_add_u32 s47, s47, 8192
s_add_u32 m0, s40, 8192
s_nop 0
buffer_load_dwordx4 v178, s[16:19], s47 offen lds
s_add_u32 s47, s47, 8192
buffer_load_dwordx4 v[64:67], v176, s[12:15], s37 offen
buffer_load_dwordx4 v[68:71], v177, s[12:15], s37 offen
s_add_u32 s37, s37, 262144
s_add_u32 m0, s40, 16384
s_nop 0
buffer_load_dwordx4 v178, s[16:19], s47 offen lds
s_add_u32 s47, s47, 8192
buffer_load_dwordx4 v[72:75], v176, s[12:15], s37 offen
buffer_load_dwordx4 v[76:79], v177, s[12:15], s37 offen
s_add_u32 s37, s37, 262144
s_add_u32 m0, s40, 24576
s_nop 0
buffer_load_dwordx4 v178, s[16:19], s47 offen lds
s_add_u32 s47, s47, 8192
buffer_load_dwordx4 v[80:83], v176, s[12:15], s37 offen
buffer_load_dwordx4 v[84:87], v177, s[12:15], s37 offen
s_add_u32 s37, s37, 262144
s_add_u32 m0, s40, 32768
s_nop 0
buffer_load_dwordx4 v178, s[16:19], s47 offen lds
s_add_u32 s47, s47, 8192
buffer_load_dwordx4 v[88:91], v176, s[12:15], s37 offen
buffer_load_dwordx4 v[92:95], v177, s[12:15], s37 offen
s_add_u32 s37, s37, 262144
s_xor_b32 s55, s33, s41
s_lshl_b32 s55, s55, 4
s_lshl_b32 s3, s34, 5
s_add_u32 s55, s55, s3
s_lshl_b32 s3, s35, 7
s_add_u32 s55, s55, s3
v_bfe_u32 v4, v186, 2, 2
v_lshl_add_u32 v5, v3, 2, v4
v_bfe_u32 v6, v5, 1, 2
s_lshl_b32 s3, s33, 5
v_add_u32 v5, s3, v5
v_and_b32 v7, 3, v186
v_lshlrev_b32 v7, 3, v7
v_lshl_add_u32 v7, v5, 7, v7
v_xor_b32 v8, 0, v6
v_lshl_add_u32 v180, v8, 5, v7
v_xor_b32 v8, 1, v6
v_lshl_add_u32 v181, v8, 5, v7
v_xor_b32 v8, 2, v6
v_lshl_add_u32 v182, v8, 5, v7
v_xor_b32 v8, 3, v6
v_lshl_add_u32 v183, v8, 5, v7
v_mov_b32 v16, 0
v_mov_b32 v17, 0
v_mov_b32 v18, 0
v_mov_b32 v19, 0
v_mov_b32 v20, 0
v_mov_b32 v21, 0
v_mov_b32 v22, 0
v_mov_b32 v23, 0
v_mov_b32 v24, 0
v_mov_b32 v25, 0
v_mov_b32 v26, 0
v_mov_b32 v27, 0
v_mov_b32 v28, 0
v_mov_b32 v29, 0
v_mov_b32 v30, 0
v_mov_b32 v31, 0
v_mov_b32 v32, 0
v_mov_b32 v33, 0
v_mov_b32 v34, 0
v_mov_b32 v35, 0
v_mov_b32 v36, 0
v_mov_b32 v37, 0
v_mov_b32 v38, 0
v_mov_b32 v39, 0
v_mov_b32 v40, 0
v_mov_b32 v41, 0
v_mov_b32 v42, 0
v_mov_b32 v43, 0
v_mov_b32 v44, 0
v_mov_b32 v45, 0
v_mov_b32 v46, 0
v_mov_b32 v47, 0
s_waitcnt vmcnt(12)
s_barrier
ds_read_b64_tr_b16 v[128:129], v180 offset:0
ds_read_b64_tr_b16 v[130:131], v180 offset:2048
ds_read_b64_tr_b16 v[132:133], v181 offset:0
ds_read_b64_tr_b16 v[134:135], v181 offset:2048
ds_read_b64_tr_b16 v[136:137], v182 offset:0
ds_read_b64_tr_b16 v[138:139], v182 offset:2048
ds_read_b64_tr_b16 v[140:141], v183 offset:0
ds_read_b64_tr_b16 v[142:143], v183 offset:2048
s_mov_b32 s48, 6
k6_kernel_loop:
s_waitcnt vmcnt(9) lgkmcnt(0)
s_barrier
v_mfma_f32_16x16x32_bf16 v[16:19], v[128:131], v[64:67], v[16:19]
ds_read_b64_tr_b16 v[144:145], v180 offset:8192
ds_read_b64_tr_b16 v[146:147], v180 offset:10240
v_mfma_f32_16x16x32_bf16 v[32:35], v[128:131], v[68:71], v[32:35]
ds_read_b64_tr_b16 v[148:149], v181 offset:8192
ds_read_b64_tr_b16 v[150:151], v181 offset:10240
v_mfma_f32_16x16x32_bf16 v[20:23], v[132:135], v[64:67], v[20:23]
ds_read_b64_tr_b16 v[152:153], v182 offset:8192
ds_read_b64_tr_b16 v[154:155], v182 offset:10240
v_mfma_f32_16x16x32_bf16 v[36:39], v[132:135], v[68:71], v[36:39]
ds_read_b64_tr_b16 v[156:157], v183 offset:8192
v_mfma_f32_16x16x32_bf16 v[24:27], v[136:139], v[64:67], v[24:27]
ds_read_b64_tr_b16 v[158:159], v183 offset:10240
s_add_u32 m0, s40, 40960
s_nop 0
buffer_load_dwordx4 v178, s[16:19], s47 offen lds
s_add_u32 s47, s47, 8192
v_mfma_f32_16x16x32_bf16 v[40:43], v[136:139], v[68:71], v[40:43]
buffer_load_dwordx4 v[96:99], v176, s[12:15], s37 offen
buffer_load_dwordx4 v[100:103], v177, s[12:15], s37 offen
s_add_u32 s37, s37, 262144
v_mfma_f32_16x16x32_bf16 v[28:31], v[140:143], v[64:67], v[28:31]
v_mfma_f32_16x16x32_bf16 v[44:47], v[140:143], v[68:71], v[44:47]
s_waitcnt vmcnt(9) lgkmcnt(0)
s_barrier
v_mfma_f32_16x16x32_bf16 v[16:19], v[144:147], v[72:75], v[16:19]
ds_read_b64_tr_b16 v[128:129], v180 offset:16384
ds_read_b64_tr_b16 v[130:131], v180 offset:18432
v_mfma_f32_16x16x32_bf16 v[32:35], v[144:147], v[76:79], v[32:35]
ds_read_b64_tr_b16 v[132:133], v181 offset:16384
ds_read_b64_tr_b16 v[134:135], v181 offset:18432
v_mfma_f32_16x16x32_bf16 v[20:23], v[148:151], v[72:75], v[20:23]
ds_read_b64_tr_b16 v[136:137], v182 offset:16384
ds_read_b64_tr_b16 v[138:139], v182 offset:18432
v_mfma_f32_16x16x32_bf16 v[36:39], v[148:151], v[76:79], v[36:39]
ds_read_b64_tr_b16 v[140:141], v183 offset:16384
v_mfma_f32_16x16x32_bf16 v[24:27], v[152:155], v[72:75], v[24:27]
ds_read_b64_tr_b16 v[142:143], v183 offset:18432
s_add_u32 m0, s40, 49152
s_nop 0
buffer_load_dwordx4 v178, s[16:19], s47 offen lds
s_add_u32 s47, s47, 8192
v_mfma_f32_16x16x32_bf16 v[40:43], v[152:155], v[76:79], v[40:43]
buffer_load_dwordx4 v[104:107], v176, s[12:15], s37 offen
buffer_load_dwordx4 v[108:111], v177, s[12:15], s37 offen
s_add_u32 s37, s37, 262144
v_mfma_f32_16x16x32_bf16 v[28:31], v[156:159], v[72:75], v[28:31]
v_mfma_f32_16x16x32_bf16 v[44:47], v[156:159], v[76:79], v[44:47]
s_waitcnt vmcnt(9) lgkmcnt(0)
s_barrier
v_mfma_f32_16x16x32_bf16 v[16:19], v[128:131], v[80:83], v[16:19]
ds_read_b64_tr_b16 v[144:145], v180 offset:24576
ds_read_b64_tr_b16 v[146:147], v180 offset:26624
v_mfma_f32_16x16x32_bf16 v[32:35], v[128:131], v[84:87], v[32:35]
ds_read_b64_tr_b16 v[148:149], v181 offset:24576
ds_read_b64_tr_b16 v[150:151], v181 offset:26624
v_mfma_f32_16x16x32_bf16 v[20:23], v[132:135], v[80:83], v[20:23]
ds_read_b64_tr_b16 v[152:153], v182 offset:24576
ds_read_b64_tr_b16 v[154:155], v182 offset:26624
v_mfma_f32_16x16x32_bf16 v[36:39], v[132:135], v[84:87], v[36:39]
ds_read_b64_tr_b16 v[156:157], v183 offset:24576
v_mfma_f32_16x16x32_bf16 v[24:27], v[136:139], v[80:83], v[24:27]
ds_read_b64_tr_b16 v[158:159], v183 offset:26624
s_add_u32 m0, s40, 57344
s_nop 0
buffer_load_dwordx4 v178, s[16:19], s47 offen lds
s_add_u32 s47, s47, 8192
v_mfma_f32_16x16x32_bf16 v[40:43], v[136:139], v[84:87], v[40:43]
buffer_load_dwordx4 v[112:115], v176, s[12:15], s37 offen
buffer_load_dwordx4 v[116:119], v177, s[12:15], s37 offen
s_add_u32 s37, s37, 262144
v_mfma_f32_16x16x32_bf16 v[28:31], v[140:143], v[80:83], v[28:31]
v_mfma_f32_16x16x32_bf16 v[44:47], v[140:143], v[84:87], v[44:47]
s_waitcnt vmcnt(9) lgkmcnt(0)
s_barrier
v_mfma_f32_16x16x32_bf16 v[16:19], v[144:147], v[88:91], v[16:19]
ds_read_b64_tr_b16 v[128:129], v180 offset:32768
ds_read_b64_tr_b16 v[130:131], v180 offset:34816
v_mfma_f32_16x16x32_bf16 v[32:35], v[144:147], v[92:95], v[32:35]
ds_read_b64_tr_b16 v[132:133], v181 offset:32768
ds_read_b64_tr_b16 v[134:135], v181 offset:34816
v_mfma_f32_16x16x32_bf16 v[20:23], v[148:151], v[88:91], v[20:23]
ds_read_b64_tr_b16 v[136:137], v182 offset:32768
ds_read_b64_tr_b16 v[138:139], v182 offset:34816
v_mfma_f32_16x16x32_bf16 v[36:39], v[148:151], v[92:95], v[36:39]
ds_read_b64_tr_b16 v[140:141], v183 offset:32768
v_mfma_f32_16x16x32_bf16 v[24:27], v[152:155], v[88:91], v[24:27]
ds_read_b64_tr_b16 v[142:143], v183 offset:34816
s_add_u32 m0, s40, 0
s_nop 0
buffer_load_dwordx4 v178, s[16:19], s47 offen lds
s_add_u32 s47, s47, 8192
v_mfma_f32_16x16x32_bf16 v[40:43], v[152:155], v[92:95], v[40:43]
buffer_load_dwordx4 v[120:123], v176, s[12:15], s37 offen
buffer_load_dwordx4 v[124:127], v177, s[12:15], s37 offen
s_add_u32 s37, s37, 262144
v_mfma_f32_16x16x32_bf16 v[28:31], v[156:159], v[88:91], v[28:31]
v_mfma_f32_16x16x32_bf16 v[44:47], v[156:159], v[92:95], v[44:47]
s_waitcnt vmcnt(9) lgkmcnt(0)
s_barrier
v_mfma_f32_16x16x32_bf16 v[16:19], v[128:131], v[96:99], v[16:19]
ds_read_b64_tr_b16 v[144:145], v180 offset:40960
ds_read_b64_tr_b16 v[146:147], v180 offset:43008
v_mfma_f32_16x16x32_bf16 v[32:35], v[128:131], v[100:103], v[32:35]
ds_read_b64_tr_b16 v[148:149], v181 offset:40960
ds_read_b64_tr_b16 v[150:151], v181 offset:43008
v_mfma_f32_16x16x32_bf16 v[20:23], v[132:135], v[96:99], v[20:23]
ds_read_b64_tr_b16 v[152:153], v182 offset:40960
ds_read_b64_tr_b16 v[154:155], v182 offset:43008
v_mfma_f32_16x16x32_bf16 v[36:39], v[132:135], v[100:103], v[36:39]
ds_read_b64_tr_b16 v[156:157], v183 offset:40960
v_mfma_f32_16x16x32_bf16 v[24:27], v[136:139], v[96:99], v[24:27]
ds_read_b64_tr_b16 v[158:159], v183 offset:43008
s_add_u32 m0, s40, 8192
s_nop 0
buffer_load_dwordx4 v178, s[16:19], s47 offen lds
s_add_u32 s47, s47, 8192
v_mfma_f32_16x16x32_bf16 v[40:43], v[136:139], v[100:103], v[40:43]
buffer_load_dwordx4 v[64:67], v176, s[12:15], s37 offen
buffer_load_dwordx4 v[68:71], v177, s[12:15], s37 offen
s_add_u32 s37, s37, 262144
v_mfma_f32_16x16x32_bf16 v[28:31], v[140:143], v[96:99], v[28:31]
v_mfma_f32_16x16x32_bf16 v[44:47], v[140:143], v[100:103], v[44:47]
s_waitcnt vmcnt(9) lgkmcnt(0)
s_barrier
v_mfma_f32_16x16x32_bf16 v[16:19], v[144:147], v[104:107], v[16:19]
ds_read_b64_tr_b16 v[128:129], v180 offset:49152
ds_read_b64_tr_b16 v[130:131], v180 offset:51200
v_mfma_f32_16x16x32_bf16 v[32:35], v[144:147], v[108:111], v[32:35]
ds_read_b64_tr_b16 v[132:133], v181 offset:49152
ds_read_b64_tr_b16 v[134:135], v181 offset:51200
v_mfma_f32_16x16x32_bf16 v[20:23], v[148:151], v[104:107], v[20:23]
ds_read_b64_tr_b16 v[136:137], v182 offset:49152
ds_read_b64_tr_b16 v[138:139], v182 offset:51200
v_mfma_f32_16x16x32_bf16 v[36:39], v[148:151], v[108:111], v[36:39]
ds_read_b64_tr_b16 v[140:141], v183 offset:49152
v_mfma_f32_16x16x32_bf16 v[24:27], v[152:155], v[104:107], v[24:27]
ds_read_b64_tr_b16 v[142:143], v183 offset:51200
s_add_u32 m0, s40, 16384
s_nop 0
buffer_load_dwordx4 v178, s[16:19], s47 offen lds
s_add_u32 s47, s47, 8192
v_mfma_f32_16x16x32_bf16 v[40:43], v[152:155], v[108:111], v[40:43]
buffer_load_dwordx4 v[72:75], v176, s[12:15], s37 offen
buffer_load_dwordx4 v[76:79], v177, s[12:15], s37 offen
s_add_u32 s37, s37, 262144
v_mfma_f32_16x16x32_bf16 v[28:31], v[156:159], v[104:107], v[28:31]
v_mfma_f32_16x16x32_bf16 v[44:47], v[156:159], v[108:111], v[44:47]
s_waitcnt vmcnt(9) lgkmcnt(0)
s_barrier
v_mfma_f32_16x16x32_bf16 v[16:19], v[128:131], v[112:115], v[16:19]
ds_read_b64_tr_b16 v[144:145], v180 offset:57344
ds_read_b64_tr_b16 v[146:147], v180 offset:59392
v_mfma_f32_16x16x32_bf16 v[32:35], v[128:131], v[116:119], v[32:35]
ds_read_b64_tr_b16 v[148:149], v181 offset:57344
ds_read_b64_tr_b16 v[150:151], v181 offset:59392
v_mfma_f32_16x16x32_bf16 v[20:23], v[132:135], v[112:115], v[20:23]
ds_read_b64_tr_b16 v[152:153], v182 offset:57344
ds_read_b64_tr_b16 v[154:155], v182 offset:59392
v_mfma_f32_16x16x32_bf16 v[36:39], v[132:135], v[116:119], v[36:39]
ds_read_b64_tr_b16 v[156:157], v183 offset:57344
v_mfma_f32_16x16x32_bf16 v[24:27], v[136:139], v[112:115], v[24:27]
ds_read_b64_tr_b16 v[158:159], v183 offset:59392
s_add_u32 m0, s40, 24576
s_nop 0
buffer_load_dwordx4 v178, s[16:19], s47 offen lds
s_add_u32 s47, s47, 8192
v_mfma_f32_16x16x32_bf16 v[40:43], v[136:139], v[116:119], v[40:43]
buffer_load_dwordx4 v[80:83], v176, s[12:15], s37 offen
buffer_load_dwordx4 v[84:87], v177, s[12:15], s37 offen
s_add_u32 s37, s37, 262144
v_mfma_f32_16x16x32_bf16 v[28:31], v[140:143], v[112:115], v[28:31]
v_mfma_f32_16x16x32_bf16 v[44:47], v[140:143], v[116:119], v[44:47]
s_waitcnt vmcnt(9) lgkmcnt(0)
s_barrier
v_mfma_f32_16x16x32_bf16 v[16:19], v[144:147], v[120:123], v[16:19]
ds_read_b64_tr_b16 v[128:129], v180 offset:0
ds_read_b64_tr_b16 v[130:131], v180 offset:2048
v_mfma_f32_16x16x32_bf16 v[32:35], v[144:147], v[124:127], v[32:35]
ds_read_b64_tr_b16 v[132:133], v181 offset:0
ds_read_b64_tr_b16 v[134:135], v181 offset:2048
v_mfma_f32_16x16x32_bf16 v[20:23], v[148:151], v[120:123], v[20:23]
ds_read_b64_tr_b16 v[136:137], v182 offset:0
ds_read_b64_tr_b16 v[138:139], v182 offset:2048
v_mfma_f32_16x16x32_bf16 v[36:39], v[148:151], v[124:127], v[36:39]
ds_read_b64_tr_b16 v[140:141], v183 offset:0
v_mfma_f32_16x16x32_bf16 v[24:27], v[152:155], v[120:123], v[24:27]
ds_read_b64_tr_b16 v[142:143], v183 offset:2048
s_add_u32 m0, s40, 32768
s_nop 0
buffer_load_dwordx4 v178, s[16:19], s47 offen lds
s_add_u32 s47, s47, 8192
v_mfma_f32_16x16x32_bf16 v[40:43], v[152:155], v[124:127], v[40:43]
buffer_load_dwordx4 v[88:91], v176, s[12:15], s37 offen
buffer_load_dwordx4 v[92:95], v177, s[12:15], s37 offen
s_add_u32 s37, s37, 262144
v_mfma_f32_16x16x32_bf16 v[28:31], v[156:159], v[120:123], v[28:31]
v_mfma_f32_16x16x32_bf16 v[44:47], v[156:159], v[124:127], v[44:47]
s_sub_u32 s48, s48, 1
s_cmp_lg_u32 s48, 0
s_cbranch_scc1 k6_kernel_loop
s_waitcnt vmcnt(9) lgkmcnt(0)
s_barrier
v_mfma_f32_16x16x32_bf16 v[16:19], v[128:131], v[64:67], v[16:19]
ds_read_b64_tr_b16 v[144:145], v180 offset:8192
ds_read_b64_tr_b16 v[146:147], v180 offset:10240
v_mfma_f32_16x16x32_bf16 v[32:35], v[128:131], v[68:71], v[32:35]
ds_read_b64_tr_b16 v[148:149], v181 offset:8192
ds_read_b64_tr_b16 v[150:151], v181 offset:10240
v_mfma_f32_16x16x32_bf16 v[20:23], v[132:135], v[64:67], v[20:23]
ds_read_b64_tr_b16 v[152:153], v182 offset:8192
ds_read_b64_tr_b16 v[154:155], v182 offset:10240
v_mfma_f32_16x16x32_bf16 v[36:39], v[132:135], v[68:71], v[36:39]
ds_read_b64_tr_b16 v[156:157], v183 offset:8192
v_mfma_f32_16x16x32_bf16 v[24:27], v[136:139], v[64:67], v[24:27]
ds_read_b64_tr_b16 v[158:159], v183 offset:10240
s_add_u32 m0, s40, 40960
s_nop 0
buffer_load_dwordx4 v178, s[16:19], s47 offen lds
s_add_u32 s47, s47, 8192
v_mfma_f32_16x16x32_bf16 v[40:43], v[136:139], v[68:71], v[40:43]
buffer_load_dwordx4 v[96:99], v176, s[12:15], s37 offen
buffer_load_dwordx4 v[100:103], v177, s[12:15], s37 offen
s_add_u32 s37, s37, 262144
v_mfma_f32_16x16x32_bf16 v[28:31], v[140:143], v[64:67], v[28:31]
v_mfma_f32_16x16x32_bf16 v[44:47], v[140:143], v[68:71], v[44:47]
s_waitcnt vmcnt(9) lgkmcnt(0)
s_barrier
v_mfma_f32_16x16x32_bf16 v[16:19], v[144:147], v[72:75], v[16:19]
ds_read_b64_tr_b16 v[128:129], v180 offset:16384
ds_read_b64_tr_b16 v[130:131], v180 offset:18432
v_mfma_f32_16x16x32_bf16 v[32:35], v[144:147], v[76:79], v[32:35]
ds_read_b64_tr_b16 v[132:133], v181 offset:16384
ds_read_b64_tr_b16 v[134:135], v181 offset:18432
ds_read_b64_tr_b16 v[136:137], v182 offset:16384
v_mfma_f32_16x16x32_bf16 v[20:23], v[148:151], v[72:75], v[20:23]
ds_read_b64_tr_b16 v[138:139], v182 offset:18432
ds_read_b64_tr_b16 v[140:141], v183 offset:16384
v_mfma_f32_16x16x32_bf16 v[36:39], v[148:151], v[76:79], v[36:39]
ds_read_b64_tr_b16 v[142:143], v183 offset:18432
s_add_u32 m0, s40, 49152
s_nop 0
buffer_load_dwordx4 v178, s[16:19], s47 offen lds
s_add_u32 s47, s47, 8192
v_mfma_f32_16x16x32_bf16 v[24:27], v[152:155], v[72:75], v[24:27]
buffer_load_dwordx4 v[104:107], v176, s[12:15], s37 offen
buffer_load_dwordx4 v[108:111], v177, s[12:15], s37 offen
s_add_u32 s37, s37, 262144
s_lshr_b32 s3, s55, 4
s_lshl_b32 s3, s3, 4
s_add_u32 s3, s3, s36
s_lshl_b32 s3, s3, 11
s_add_u32 s49, s3, 16777216
v_lshlrev_b32 v10, 4, v186
buffer_load_dwordx4 v[188:191], v10, s[24:27], s49 offen
v_mfma_f32_16x16x32_bf16 v[40:43], v[152:155], v[76:79], v[40:43]
buffer_load_dwordx4 v[192:195], v10, s[24:27], s49 offen offset:1024
v_lshlrev_b32 v11, 4, v186
s_lshl_b32 s3, s36, 8
s_add_u32 s3, s3, 20480
v_add_u32 v11, s3, v11
s_lshl_b32 s3, s32, 9
s_add_u32 m0, s3, 65536
s_mov_b64 exec, 0xffff
buffer_load_dwordx4 v11, s[24:27], 0 offen lds
s_mov_b64 exec, -1
v_mfma_f32_16x16x32_bf16 v[28:31], v[156:159], v[72:75], v[28:31]
v_mfma_f32_16x16x32_bf16 v[44:47], v[156:159], v[76:79], v[44:47]
s_waitcnt vmcnt(12) lgkmcnt(0)
s_barrier
v_mfma_f32_16x16x32_bf16 v[16:19], v[128:131], v[80:83], v[16:19]
ds_read_b64_tr_b16 v[144:145], v180 offset:24576
ds_read_b64_tr_b16 v[146:147], v180 offset:26624
v_mfma_f32_16x16x32_bf16 v[32:35], v[128:131], v[84:87], v[32:35]
ds_read_b64_tr_b16 v[148:149], v181 offset:24576
ds_read_b64_tr_b16 v[150:151], v181 offset:26624
v_mfma_f32_16x16x32_bf16 v[20:23], v[132:135], v[80:83], v[20:23]
ds_read_b64_tr_b16 v[152:153], v182 offset:24576
ds_read_b64_tr_b16 v[154:155], v182 offset:26624
v_mfma_f32_16x16x32_bf16 v[36:39], v[132:135], v[84:87], v[36:39]
ds_read_b64_tr_b16 v[156:157], v183 offset:24576
v_mfma_f32_16x16x32_bf16 v[24:27], v[136:139], v[80:83], v[24:27]
ds_read_b64_tr_b16 v[158:159], v183 offset:26624
s_add_u32 m0, s40, 57344
s_nop 0
buffer_load_dwordx4 v178, s[16:19], s47 offen lds
s_add_u32 s47, s47, 8192
v_mfma_f32_16x16x32_bf16 v[40:43], v[136:139], v[84:87], v[40:43]
buffer_load_dwordx4 v[112:115], v176, s[12:15], s37 offen
buffer_load_dwordx4 v[116:119], v177, s[12:15], s37 offen
s_add_u32 s37, s37, 262144
v_mfma_f32_16x16x32_bf16 v[28:31], v[140:143], v[80:83], v[28:31]
v_mfma_f32_16x16x32_bf16 v[44:47], v[140:143], v[84:87], v[44:47]
s_waitcnt vmcnt(12) lgkmcnt(0)
s_barrier
v_mfma_f32_16x16x32_bf16 v[16:19], v[144:147], v[88:91], v[16:19]
ds_read_b64_tr_b16 v[128:129], v180 offset:32768
ds_read_b64_tr_b16 v[130:131], v180 offset:34816
v_mfma_f32_16x16x32_bf16 v[32:35], v[144:147], v[92:95], v[32:35]
ds_read_b64_tr_b16 v[132:133], v181 offset:32768
v_mfma_f32_16x16x32_bf16 v[20:23], v[148:151], v[88:91], v[20:23]
ds_read_b64_tr_b16 v[134:135], v181 offset:34816
ds_read_b64_tr_b16 v[136:137], v182 offset:32768
v_mfma_f32_16x16x32_bf16 v[36:39], v[148:151], v[92:95], v[36:39]
ds_read_b64_tr_b16 v[138:139], v182 offset:34816
ds_read_b64_tr_b16 v[140:141], v183 offset:32768
v_mfma_f32_16x16x32_bf16 v[24:27], v[152:155], v[88:91], v[24:27]
ds_read_b64_tr_b16 v[142:143], v183 offset:34816
v_mfma_f32_16x16x32_bf16 v[40:43], v[152:155], v[92:95], v[40:43]
buffer_load_dwordx4 v[120:123], v176, s[12:15], s37 offen
buffer_load_dwordx4 v[124:127], v177, s[12:15], s37 offen
s_add_u32 s37, s37, 262144
v_mfma_f32_16x16x32_bf16 v[28:31], v[156:159], v[88:91], v[28:31]
v_mfma_f32_16x16x32_bf16 v[44:47], v[156:159], v[92:95], v[44:47]
s_waitcnt vmcnt(11) lgkmcnt(0)
s_barrier
v_mfma_f32_16x16x32_bf16 v[16:19], v[128:131], v[96:99], v[16:19]
ds_read_b64_tr_b16 v[144:145], v180 offset:40960
v_mfma_f32_16x16x32_bf16 v[32:35], v[128:131], v[100:103], v[32:35]
ds_read_b64_tr_b16 v[146:147], v180 offset:43008
ds_read_b64_tr_b16 v[148:149], v181 offset:40960
v_mfma_f32_16x16x32_bf16 v[20:23], v[132:135], v[96:99], v[20:23]
ds_read_b64_tr_b16 v[150:151], v181 offset:43008
v_mfma_f32_16x16x32_bf16 v[36:39], v[132:135], v[100:103], v[36:39]
ds_read_b64_tr_b16 v[152:153], v182 offset:40960
v_mfma_f32_16x16x32_bf16 v[24:27], v[136:139], v[96:99], v[24:27]
ds_read_b64_tr_b16 v[154:155], v182 offset:43008
ds_read_b64_tr_b16 v[156:157], v183 offset:40960
v_mfma_f32_16x16x32_bf16 v[40:43], v[136:139], v[100:103], v[40:43]
ds_read_b64_tr_b16 v[158:159], v183 offset:43008
v_mfma_f32_16x16x32_bf16 v[28:31], v[140:143], v[96:99], v[28:31]
v_mfma_f32_16x16x32_bf16 v[44:47], v[140:143], v[100:103], v[44:47]
s_waitcnt vmcnt(8) lgkmcnt(0)
s_barrier
v_mfma_f32_16x16x32_bf16 v[16:19], v[144:147], v[104:107], v[16:19]
ds_read_b64_tr_b16 v[128:129], v180 offset:49152
v_mfma_f32_16x16x32_bf16 v[32:35], v[144:147], v[108:111], v[32:35]
ds_read_b64_tr_b16 v[130:131], v180 offset:51200
ds_read_b64_tr_b16 v[132:133], v181 offset:49152
v_mfma_f32_16x16x32_bf16 v[20:23], v[148:151], v[104:107], v[20:23]
ds_read_b64_tr_b16 v[134:135], v181 offset:51200
v_mfma_f32_16x16x32_bf16 v[36:39], v[148:151], v[108:111], v[36:39]
ds_read_b64_tr_b16 v[136:137], v182 offset:49152
v_mfma_f32_16x16x32_bf16 v[24:27], v[152:155], v[104:107], v[24:27]
ds_read_b64_tr_b16 v[138:139], v182 offset:51200
ds_read_b64_tr_b16 v[140:141], v183 offset:49152
v_mfma_f32_16x16x32_bf16 v[40:43], v[152:155], v[108:111], v[40:43]
ds_read_b64_tr_b16 v[142:143], v183 offset:51200
v_mfma_f32_16x16x32_bf16 v[28:31], v[156:159], v[104:107], v[28:31]
v_mfma_f32_16x16x32_bf16 v[44:47], v[156:159], v[108:111], v[44:47]
s_waitcnt vmcnt(2) lgkmcnt(0)
s_barrier
v_mfma_f32_16x16x32_bf16 v[16:19], v[128:131], v[112:115], v[16:19]
ds_read_b64_tr_b16 v[144:145], v180 offset:57344
v_mfma_f32_16x16x32_bf16 v[32:35], v[128:131], v[116:119], v[32:35]
ds_read_b64_tr_b16 v[146:147], v180 offset:59392
ds_read_b64_tr_b16 v[148:149], v181 offset:57344
v_mfma_f32_16x16x32_bf16 v[20:23], v[132:135], v[112:115], v[20:23]
ds_read_b64_tr_b16 v[150:151], v181 offset:59392
v_mfma_f32_16x16x32_bf16 v[36:39], v[132:135], v[116:119], v[36:39]
ds_read_b64_tr_b16 v[152:153], v182 offset:57344
v_mfma_f32_16x16x32_bf16 v[24:27], v[136:139], v[112:115], v[24:27]
ds_read_b64_tr_b16 v[154:155], v182 offset:59392
ds_read_b64_tr_b16 v[156:157], v183 offset:57344
v_mfma_f32_16x16x32_bf16 v[40:43], v[136:139], v[116:119], v[40:43]
ds_read_b64_tr_b16 v[158:159], v183 offset:59392
v_mfma_f32_16x16x32_bf16 v[28:31], v[140:143], v[112:115], v[28:31]
v_mfma_f32_16x16x32_bf16 v[44:47], v[140:143], v[116:119], v[44:47]
s_waitcnt vmcnt(0) lgkmcnt(0)
s_barrier
v_mfma_f32_16x16x32_bf16 v[16:19], v[144:147], v[120:123], v[16:19]
v_mfma_f32_16x16x32_bf16 v[32:35], v[144:147], v[124:127], v[32:35]
v_mfma_f32_16x16x32_bf16 v[20:23], v[148:151], v[120:123], v[20:23]
v_mfma_f32_16x16x32_bf16 v[36:39], v[148:151], v[124:127], v[36:39]
v_mfma_f32_16x16x32_bf16 v[24:27], v[152:155], v[120:123], v[24:27]
v_mfma_f32_16x16x32_bf16 v[40:43], v[152:155], v[124:127], v[40:43]
v_mfma_f32_16x16x32_bf16 v[28:31], v[156:159], v[120:123], v[28:31]
v_mfma_f32_16x16x32_bf16 v[44:47], v[156:159], v[124:127], v[44:47]
v_lshlrev_b32 v5, 4, v186
s_lshl_b32 s3, s34, 1
s_add_u32 s10, s3, s33
s_lshl_b32 s10, s10, 12
s_xor_b32 s11, s10, 4096
v_add_u32 v6, s11, v5
v_add_u32 v7, s10, v5
v_and_b32 v2, 15, v186
v_lshrrev_b32 v3, 4, v186
s_nop 1
s_cmp_eq_u32 s33, 0
s_cbranch_scc0 k6_kernel_e1
ds_write_b128 v6, v[32:35] offset:0
ds_write_b128 v6, v[36:39] offset:1024
ds_write_b128 v6, v[40:43] offset:2048
ds_write_b128 v6, v[44:47] offset:3072
s_branch k6_kernel_e2
k6_kernel_e1:
ds_write_b128 v6, v[16:19] offset:0
ds_write_b128 v6, v[20:23] offset:1024
ds_write_b128 v6, v[24:27] offset:2048
ds_write_b128 v6, v[28:31] offset:3072
k6_kernel_e2:
s_waitcnt vmcnt(0) lgkmcnt(0)
s_barrier
v_lshlrev_b32 v9, 4, v3
s_lshl_b32 s3, s32, 9
s_add_u32 s3, s3, 65536
v_add_u32 v9, s3, v9
ds_read_b128 v[128:131], v7 offset:0
ds_read_b128 v[132:135], v7 offset:1024
ds_read_b128 v[136:139], v7 offset:2048
ds_read_b128 v[140:143], v7 offset:3072
ds_read_b128 v[196:199], v9 offset:0
ds_read_b128 v[200:203], v9 offset:64
ds_read_b128 v[204:207], v9 offset:128
ds_read_b128 v[208:211], v9 offset:192
s_waitcnt lgkmcnt(0)
s_cmp_eq_u32 s33, 0
s_cbranch_scc0 k6_kernel_e3
v_add_f32 v128, v128, v16
v_add_f32 v129, v129, v17
v_add_f32 v130, v130, v18
v_add_f32 v131, v131, v19
v_add_f32 v132, v132, v20
v_add_f32 v133, v133, v21
v_add_f32 v134, v134, v22
v_add_f32 v135, v135, v23
v_add_f32 v136, v136, v24
v_add_f32 v137, v137, v25
v_add_f32 v138, v138, v26
v_add_f32 v139, v139, v27
v_add_f32 v140, v140, v28
v_add_f32 v141, v141, v29
v_add_f32 v142, v142, v30
v_add_f32 v143, v143, v31
s_branch k6_kernel_e4
k6_kernel_e3:
v_add_f32 v128, v128, v32
v_add_f32 v129, v129, v33
v_add_f32 v130, v130, v34
v_add_f32 v131, v131, v35
v_add_f32 v132, v132, v36
v_add_f32 v133, v133, v37
v_add_f32 v134, v134, v38
v_add_f32 v135, v135, v39
v_add_f32 v136, v136, v40
v_add_f32 v137, v137, v41
v_add_f32 v138, v138, v42
v_add_f32 v139, v139, v43
v_add_f32 v140, v140, v44
v_add_f32 v141, v141, v45
v_add_f32 v142, v142, v46
v_add_f32 v143, v143, v47
k6_kernel_e4:
v_lshlrev_b32 v4, 16, v188
v_and_b32 v5, 0xffff0000, v188
v_fma_f32 v128, v196, v128, v4
v_fma_f32 v129, v197, v129, v5
v_lshlrev_b32 v4, 16, v189
v_and_b32 v5, 0xffff0000, v189
v_fma_f32 v130, v198, v130, v4
v_fma_f32 v131, v199, v131, v5
v_lshlrev_b32 v4, 16, v190
v_and_b32 v5, 0xffff0000, v190
v_fma_f32 v132, v200, v132, v4
v_fma_f32 v133, v201, v133, v5
v_lshlrev_b32 v4, 16, v191
v_and_b32 v5, 0xffff0000, v191
v_fma_f32 v134, v202, v134, v4
v_fma_f32 v135, v203, v135, v5
v_lshlrev_b32 v4, 16, v192
v_and_b32 v5, 0xffff0000, v192
v_fma_f32 v136, v204, v136, v4
v_fma_f32 v137, v205, v137, v5
v_lshlrev_b32 v4, 16, v193
v_and_b32 v5, 0xffff0000, v193
v_fma_f32 v138, v206, v138, v4
v_fma_f32 v139, v207, v139, v5
v_lshlrev_b32 v4, 16, v194
v_and_b32 v5, 0xffff0000, v194
v_fma_f32 v140, v208, v140, v4
v_fma_f32 v141, v209, v141, v5
v_lshlrev_b32 v4, 16, v195
v_and_b32 v5, 0xffff0000, v195
v_fma_f32 v142, v210, v142, v4
v_fma_f32 v143, v211, v143, v5
v_mul_u32_u24 v6, 144, v2
v_lshl_add_u32 v6, v3, 3, v6
s_mul_i32 s3, s32, 2304
s_add_u32 s3, s3, 69632
v_add_u32 v6, s3, v6
v_cvt_pk_bf16_f32 v8, v128, v129
v_cvt_pk_bf16_f32 v9, v130, v131
ds_write_b64 v6, v[8:9] offset:0
v_cvt_pk_bf16_f32 v10, v132, v133
v_cvt_pk_bf16_f32 v11, v134, v135
ds_write_b64 v6, v[10:11] offset:32
v_cvt_pk_bf16_f32 v12, v136, v137
v_cvt_pk_bf16_f32 v13, v138, v139
ds_write_b64 v6, v[12:13] offset:64
v_cvt_pk_bf16_f32 v14, v140, v141
v_cvt_pk_bf16_f32 v15, v142, v143
ds_write_b64 v6, v[14:15] offset:96
v_lshrrev_b32 v7, 3, v186
v_mul_u32_u24 v9, 144, v7
v_and_b32 v10, 7, v186
v_lshl_add_u32 v9, v10, 4, v9
v_add_u32 v9, s3, v9
v_add_u32 v7, s55, v7
v_lshlrev_b32 v7, 11, v7
v_lshl_add_u32 v7, v10, 4, v7
s_lshl_b32 s3, s36, 7
v_add_u32 v7, s3, v7
s_waitcnt lgkmcnt(0)
ds_read_b128 v[16:19], v9
ds_read_b128 v[20:23], v9 offset:1152
v_add_u32 v11, 16384, v7
s_waitcnt lgkmcnt(1)
buffer_store_dwordx4 v[16:19], v7, s[28:31], 0 offen sc1
s_waitcnt lgkmcnt(0)
buffer_store_dwordx4 v[20:23], v11, s[28:31], 0 offen sc1
k6_kernel_fin:
k6_kernel_end:
s_endpgm
.section .rodata,"a"
.p2align 6
.amdhsa_kernel k6_kernel
  .amdhsa_next_free_vgpr 232
  .amdhsa_next_free_sgpr 102
  .amdhsa_accum_offset 232
  .amdhsa_group_segment_fixed_size 0
  .amdhsa_kernarg_size 112
  .amdhsa_user_sgpr_count 2
  .amdhsa_user_sgpr_kernarg_segment_ptr 1
  .amdhsa_system_sgpr_workgroup_id_x 1
.end_amdhsa_kernel
```
